```python
import torch

def _softmax(x, axis=-1):
    return torch.softmax(x, dim=axis)
def _gelu(x):
    return torch.nn.functional.gelu(x, approximate="tanh")
def _silu(x):
    return torch.nn.functional.silu(x)
def _sigmoid(x):
    return torch.sigmoid(x)
def _layernorm(x, axis=-1, eps=1e-5):
    m = x.mean(dim=axis, keepdim=True)
    v = x.var(dim=axis, keepdim=True, unbiased=False)
    return (x - m) / torch.sqrt(v + eps)
def _scatter_add(tgt, idx, src, axis=0):
    return tgt.clone().index_add_(axis, idx, src)
def _segment_sum(src, seg, n):
    out = torch.zeros((n,) + src.shape[1:], dtype=src.dtype)
    return out.index_add_(0, seg, src)
def _pad(x, pw):
    flat = tuple(v for pair in reversed(pw) for v in pair)
    return torch.nn.functional.pad(x, flat)

kernel_name = 'standalone__mha_block_cached__near_ridge'

def setup_inputs():

    _w = (lambda a: (lambda t: t.to(torch.bfloat16) if t.is_floating_point() else t)(torch.as_tensor(a)))
    B, Sq, D = 8, 128, 640
    H, Sk, Dh = 32, 1024, 128
    return {
        "x": _w((lambda *s: torch.randn(*s, dtype=torch.bfloat16) * 0.8)(B, Sq, D)),
        "k_cache": _w((lambda *s: torch.randn(*s, dtype=torch.bfloat16) * 0.8)(B, H, Sk, Dh)),
        "v_cache": _w((lambda *s: torch.randn(*s, dtype=torch.bfloat16) * 0.05)(B, H, Sk, Dh)),
        "wq": _w((lambda *s: torch.randn(*s, dtype=torch.bfloat16) * 0.8)(D, H * Dh) * (D ** -0.5)),
        "wo": _w((lambda *s: torch.randn(*s, dtype=torch.bfloat16) * 0.05)(H * Dh, D) * ((H * Dh) ** -0.5)),
    }

def reference(x, k_cache, v_cache, wq, wo):
    B, Sq, D = x.shape
    H, Dh = 32, 128
    q = (lambda x, *d: x.permute(*d))((x @ wq).reshape(B, Sq, H, Dh), 0, 2, 1, 3)
    scores = torch.einsum("bhqd,bhkd->bhqk", q, k_cache) * (Dh ** -0.5)
    p = _softmax(scores, axis=-1)
    o = torch.einsum("bhqk,bhkd->bhqd", p, v_cache)
    return (lambda x, *d: x.permute(*d))(o, 0, 2, 1, 3).reshape(B, Sq, H * Dh) @ wo
```

```asm
; @launch kernel=attn_kernel grid=(256,1,1) block=(512,1,1) lds=163840
.amdgcn_target "amdgcn-amd-amdhsa--gfx950"
.text
.globl attn_kernel
.p2align 8
.type attn_kernel,@function
attn_kernel:
    s_cmp_ge_u32 s2, 256
    s_cbranch_scc1 K1_END
    s_load_dwordx8 s[4:11], s[0:1], 0
    s_load_dwordx8 s[12:19], s[0:1], 32
    v_lshrrev_b32 v1, 6, v0
    v_and_b32 v255, 63, v0
    v_readfirstlane_b32 s40, v1
    s_and_b32 s56, s2, 3
    s_bfe_u32 s57, s2, 0x30003
    s_lshl_b32 s41, s56, 3
    s_add_u32 s41, s41, s57
    s_bfe_u32 s42, s2, 0x10002
    s_lshl_b32 s42, s42, 2
    s_lshr_b32 s46, s2, 6
    s_add_u32 s42, s42, s46
    s_cmp_ge_u32 s40, 4
    s_cbranch_scc1 K1_LD
    s_getpc_b64 s[20:21]
K1_PC:
    s_lshr_b32 s46, s2, 3
    s_lshl_b32 s46, s46, 2
    s_add_u32 s46, s46, s40
    s_lshl_b32 s46, s46, 9
    s_and_b32 s46, s46, 0xffff
    s_and_b32 s21, s21, 0xffff
    s_mov_b32 s22, K1_END-K1_PC
    s_mov_b32 s23, 0x00020000
    v_lshl_add_u32 v222, v255, 6, s46
    s_mov_b64 exec, 0xff
    buffer_load_dword v223, v222, s[20:23], 0 offen
    s_mov_b64 exec, -1
    s_branch K1_COMP
K1_LD:
    s_sub_u32 s44, s40, 4
    v_lshrrev_b32 v1, 4, v255
    v_and_b32 v2, 15, v255
    v_lshlrev_b32 v7, 2, v1
    v_xor_b32 v7, v7, v2
    s_lshl_b32 s45, s44, 12
    v_lshlrev_b32 v8, 13, v1
    v_lshlrev_b32 v7, 1, v1
    v_xor_b32 v7, v7, v2
    v_lshl_add_u32 v8, v7, 4, v8
    v_xor_b32 v20, 0x80, v8
    v_lshrrev_b32 v5, 3, v255
    v_mul_u32_u24 v5, 1280, v5
    v_and_b32 v6, 7, v255
    v_xor_b32 v6, v6, v1
    v_lshl_add_u32 v16, v6, 4, v5
    v_xor_b32 v6, 4, v6
    v_lshl_add_u32 v17, v6, 4, v5
    s_lshl_b32 s48, s41, 8
    s_lshl_b32 s46, s44, 17
    s_add_u32 s48, s48, s46
    s_lshl_b32 s47, s42, 2
    s_add_u32 s47, s47, s44
    s_mul_i32 s47, s47, 40960
    s_and_b32 s46, s42, 3
    s_mul_i32 s46, s46, 5
    s_add_u32 s46, s46, 1
    s_lshr_b32 s46, s46, 1
    s_add_u32 s53, s46, s57
    s_sub_u32 s46, s53, 10
    s_cmp_ge_u32 s53, 10
    s_cselect_b32 s53, s46, s53
    s_mov_b32 s22, 1310720
    s_mov_b32 s23, 0x00020000
    s_mov_b32 s26, 5242880
    s_mov_b32 s27, 0x00020000
    s_waitcnt lgkmcnt(0)
    s_mov_b32 s20, s4
    s_and_b32 s21, s5, 0xffff
    s_mov_b32 s24, s10
    s_and_b32 s25, s11, 0xffff
    s_lshl_b32 s46, s53, 7
    s_add_u32 s46, s46, s47
    s_lshl_b32 s62, s53, 19
    s_add_u32 s62, s62, s48
    s_add_u32 m0, s45, 147456
    s_nop 0
    buffer_load_dwordx4 v8, s[24:27], s62 offen lds
    s_add_u32 m0, s45, 131072
    s_nop 0
    buffer_load_dwordx4 v16, s[20:23], s46 offen lds
    s_add_u32 s46, s46, 10240
    s_add_u32 s62, s62, 32768
    s_add_u32 m0, s45, 148480
    s_nop 0
    buffer_load_dwordx4 v8, s[24:27], s62 offen lds
    s_add_u32 m0, s45, 132096
    s_nop 0
    buffer_load_dwordx4 v17, s[20:23], s46 offen lds
    s_add_u32 s46, s46, 10240
    s_add_u32 s62, s62, 32768
    s_add_u32 m0, s45, 149504
    s_nop 0
    buffer_load_dwordx4 v20, s[24:27], s62 offen lds
    s_add_u32 m0, s45, 133120
    s_nop 0
    buffer_load_dwordx4 v16, s[20:23], s46 offen lds
    s_add_u32 s46, s46, 10240
    s_add_u32 s62, s62, 32768
    s_add_u32 m0, s45, 150528
    s_nop 0
    buffer_load_dwordx4 v20, s[24:27], s62 offen lds
    s_add_u32 m0, s45, 134144
    s_nop 0
    buffer_load_dwordx4 v17, s[20:23], s46 offen lds
    s_add_u32 s53, s53, 1
    s_cmp_ge_u32 s53, 10
    s_cselect_b32 s53, 0, s53
    s_mov_b32 s72, s14
    s_and_b32 s73, s15, 0xffff
    s_mov_b32 s68, s16
    s_and_b32 s69, s17, 0xffff
    s_mov_b32 s70, 256
    s_mov_b32 s71, 0x00020000
    s_mov_b32 s30, 262144
    s_mov_b32 s31, 0x00020000
    s_mov_b32 s34, 262144
    s_mov_b32 s35, 0x00020000
    s_mov_b32 s36, s18
    s_and_b32 s37, s19, 0xffff
    s_mov_b32 s38, 50331648
    s_mov_b32 s39, 0x00020000
    s_mov_b32 s64, s12
    s_and_b32 s65, s13, 0xffff
    s_mov_b32 s66, 5242880
    s_mov_b32 s67, 0x00020000
    s_mov_b32 s74, 1310720
    s_mov_b32 s75, 0x00020000
    s_lshl_b32 s43, s42, 5
    s_add_u32 s43, s43, s41
    s_lshl_b32 s46, s43, 18
    s_add_u32 s28, s6, s46
    s_addc_u32 s29, s7, 0
    s_and_b32 s29, s29, 0xffff
    s_add_u32 s32, s8, s46
    s_addc_u32 s33, s9, 0
    s_and_b32 s33, s33, 0xffff
    s_lshl_b32 s54, s43, 13
    s_add_u32 s54, s54, 25165824
    s_and_b32 s76, s40, 3
    s_lshr_b32 s77, s40, 2
    s_lshl_b32 s46, s76, 10
    s_add_u32 s78, s54, s46
    s_lshr_b32 s46, s57, 2
    s_xor_b32 s10, s77, s46
    s_lshl_b32 s46, s10, 9
    s_add_u32 s78, s78, s46
    v_lshlrev_b32 v3, 8, v1
    v_lshlrev_b32 v4, 1, v1
    v_xor_b32 v4, v4, v2
    v_lshl_add_u32 v244, v4, 4, v3
    v_add_u32 v14, s45, v244
    v_xor_b32 v9, 128, v14
    v_and_b32 v15, 31, v255
    v_lshlrev_b32 v15, 7, v15
    v_lshrrev_b32 v4, 5, v255
    v_lshl_add_u32 v15, v4, 14, v15
    v_add_u32 v15, s45, v15
    v_add_u32 v4, 0, v1
    v_xor_b32 v4, v4, v2
    v_lshl_add_u32 v240, v4, 4, v3
    v_add_u32 v10, s45, v240
    v_add_u32 v4, 4, v1
    v_xor_b32 v4, v4, v2
    v_lshl_add_u32 v241, v4, 4, v3
    v_add_u32 v11, s45, v241
    v_add_u32 v4, 8, v1
    v_xor_b32 v4, v4, v2
    v_lshl_add_u32 v242, v4, 4, v3
    v_add_u32 v12, s45, v242
    v_add_u32 v4, 12, v1
    v_xor_b32 v4, v4, v2
    v_lshl_add_u32 v243, v4, 4, v3
    v_add_u32 v13, s45, v243
    s_xor_b32 s46, s57, s42
    s_bitcmp1_b32 s46, 0
    s_cbranch_scc1 K1_LATE
    s_lshl_b32 s46, s53, 7
    s_add_u32 s46, s46, s47
    s_lshl_b32 s62, s53, 19
    s_add_u32 s62, s62, s48
    s_add_u32 m0, s45, 81920
    s_nop 0
    buffer_load_dwordx4 v8, s[24:27], s62 offen lds
    s_add_u32 m0, s45, 65536
    s_nop 0
    buffer_load_dwordx4 v16, s[20:23], s46 offen lds
    s_add_u32 s46, s46, 10240
    s_add_u32 s62, s62, 32768
    s_add_u32 m0, s45, 82944
    s_nop 0
    buffer_load_dwordx4 v8, s[24:27], s62 offen lds
    s_add_u32 m0, s45, 66560
    s_nop 0
    buffer_load_dwordx4 v17, s[20:23], s46 offen lds
    s_add_u32 s46, s46, 10240
    s_add_u32 s62, s62, 32768
    s_add_u32 m0, s45, 83968
    s_nop 0
    buffer_load_dwordx4 v20, s[24:27], s62 offen lds
    s_add_u32 m0, s45, 67584
    s_nop 0
    buffer_load_dwordx4 v16, s[20:23], s46 offen lds
    s_add_u32 s46, s46, 10240
    s_add_u32 s62, s62, 32768
    s_add_u32 m0, s45, 84992
    s_nop 0
    buffer_load_dwordx4 v20, s[24:27], s62 offen lds
    s_add_u32 m0, s45, 68608
    s_nop 0
    buffer_load_dwordx4 v17, s[20:23], s46 offen lds
    s_add_u32 s53, s53, 1
    s_cmp_ge_u32 s53, 10
    s_cselect_b32 s53, 0, s53
    v_add_u32 v4, 0, v255
    v_mul_u32_u24 v5, 205, v4
    v_lshrrev_b32 v5, 11, v5
    v_mul_u32_u24 v6, 10, v5
    v_sub_u32 v6, v4, v6
    v_mul_u32_u24 v5, 1280, v5
    v_lshl_add_u32 v235, v6, 4, v5
    v_add_u32 v4, 64, v255
    v_mul_u32_u24 v5, 205, v4
    v_lshrrev_b32 v5, 11, v5
    v_mul_u32_u24 v6, 10, v5
    v_sub_u32 v6, v4, v6
    v_mul_u32_u24 v5, 1280, v5
    v_lshl_add_u32 v236, v6, 4, v5
    v_add_u32 v4, 128, v255
    v_mul_u32_u24 v5, 205, v4
    v_lshrrev_b32 v5, 11, v5
    v_mul_u32_u24 v6, 10, v5
    v_sub_u32 v6, v4, v6
    v_mul_u32_u24 v5, 1280, v5
    v_lshl_add_u32 v237, v6, 4, v5
    v_add_u32 v4, 192, v255
    v_mul_u32_u24 v5, 205, v4
    v_lshrrev_b32 v5, 11, v5
    v_mul_u32_u24 v6, 10, v5
    v_sub_u32 v6, v4, v6
    v_mul_u32_u24 v5, 1280, v5
    v_lshl_add_u32 v238, v6, 4, v5
    v_add_u32 v4, 256, v255
    v_mul_u32_u24 v5, 205, v4
    v_lshrrev_b32 v5, 11, v5
    v_mul_u32_u24 v6, 10, v5
    v_sub_u32 v6, v4, v6
    v_mul_u32_u24 v5, 1280, v5
    v_lshl_add_u32 v239, v6, 4, v5
    s_mul_i32 s63, s56, 1310720
    s_mul_i32 s46, s57, 160
    s_add_u32 s63, s63, s46
    s_xor_b32 s7, s57, 7
    s_lshl_b32 s7, s7, 31
    s_and_b32 s7, s7, 31
    v_lshlrev_b32 v247, 4, v255
    v_add_u32 v247, s45, v247
    v_add_u32 v248, 65536, v247
    s_waitcnt vmcnt(8)
    s_barrier
    s_lshl_b32 s46, s53, 7
    s_add_u32 s46, s46, s47
    s_lshl_b32 s62, s53, 19
    s_add_u32 s62, s62, s48
    s_add_u32 m0, s45, 114688
    s_nop 0
    buffer_load_dwordx4 v8, s[24:27], s62 offen lds
    s_add_u32 m0, s45, 98304
    s_nop 0
    buffer_load_dwordx4 v16, s[20:23], s46 offen lds
    s_add_u32 s46, s46, 10240
    s_add_u32 s62, s62, 32768
    s_add_u32 m0, s45, 115712
    s_nop 0
    buffer_load_dwordx4 v8, s[24:27], s62 offen lds
    s_add_u32 m0, s45, 99328
    s_nop 0
    buffer_load_dwordx4 v17, s[20:23], s46 offen lds
    s_add_u32 s46, s46, 10240
    s_add_u32 s62, s62, 32768
    s_add_u32 m0, s45, 116736
    s_nop 0
    buffer_load_dwordx4 v20, s[24:27], s62 offen lds
    s_add_u32 m0, s45, 100352
    s_nop 0
    buffer_load_dwordx4 v16, s[20:23], s46 offen lds
    s_add_u32 s46, s46, 10240
    s_add_u32 s62, s62, 32768
    s_add_u32 m0, s45, 117760
    s_nop 0
    buffer_load_dwordx4 v20, s[24:27], s62 offen lds
    s_add_u32 m0, s45, 101376
    s_nop 0
    buffer_load_dwordx4 v17, s[20:23], s46 offen lds
    s_add_u32 s53, s53, 1
    s_cmp_ge_u32 s53, 10
    s_cselect_b32 s53, 0, s53
    s_waitcnt vmcnt(8)
    s_barrier
    s_lshl_b32 s46, s53, 7
    s_add_u32 s46, s46, s47
    s_lshl_b32 s62, s53, 19
    s_add_u32 s62, s62, s48
    s_add_u32 m0, s45, 147456
    s_nop 0
    buffer_load_dwordx4 v8, s[24:27], s62 offen lds
    s_add_u32 m0, s45, 131072
    s_nop 0
    buffer_load_dwordx4 v16, s[20:23], s46 offen lds
    s_add_u32 s46, s46, 10240
    s_add_u32 s62, s62, 32768
    s_add_u32 m0, s45, 148480
    s_nop 0
    buffer_load_dwordx4 v8, s[24:27], s62 offen lds
    s_add_u32 m0, s45, 132096
    s_nop 0
    buffer_load_dwordx4 v17, s[20:23], s46 offen lds
    s_add_u32 s46, s46, 10240
    s_add_u32 s62, s62, 32768
    s_add_u32 m0, s45, 149504
    s_nop 0
    buffer_load_dwordx4 v20, s[24:27], s62 offen lds
    s_add_u32 m0, s45, 133120
    s_nop 0
    buffer_load_dwordx4 v16, s[20:23], s46 offen lds
    s_add_u32 s46, s46, 10240
    s_add_u32 s62, s62, 32768
    s_add_u32 m0, s45, 150528
    s_nop 0
    buffer_load_dwordx4 v20, s[24:27], s62 offen lds
    s_add_u32 m0, s45, 134144
    s_nop 0
    buffer_load_dwordx4 v17, s[20:23], s46 offen lds
    s_add_u32 s53, s53, 1
    s_cmp_ge_u32 s53, 10
    s_cselect_b32 s53, 0, s53
    s_waitcnt vmcnt(8)
    s_barrier
    s_lshl_b32 s46, s53, 7
    s_add_u32 s46, s46, s47
    s_lshl_b32 s62, s53, 19
    s_add_u32 s62, s62, s48
    s_add_u32 m0, s45, 81920
    s_nop 0
    buffer_load_dwordx4 v8, s[24:27], s62 offen lds
    s_add_u32 m0, s45, 65536
    s_nop 0
    buffer_load_dwordx4 v16, s[20:23], s46 offen lds
    s_add_u32 s46, s46, 10240
    s_add_u32 s62, s62, 32768
    s_add_u32 m0, s45, 82944
    s_nop 0
    buffer_load_dwordx4 v8, s[24:27], s62 offen lds
    s_add_u32 m0, s45, 66560
    s_nop 0
    buffer_load_dwordx4 v17, s[20:23], s46 offen lds
    s_add_u32 s46, s46, 10240
    s_add_u32 s62, s62, 32768
    s_add_u32 m0, s45, 83968
    s_nop 0
    buffer_load_dwordx4 v20, s[24:27], s62 offen lds
    s_add_u32 m0, s45, 67584
    s_nop 0
    buffer_load_dwordx4 v16, s[20:23], s46 offen lds
    s_add_u32 s46, s46, 10240
    s_add_u32 s62, s62, 32768
    s_add_u32 m0, s45, 84992
    s_nop 0
    buffer_load_dwordx4 v20, s[24:27], s62 offen lds
    s_add_u32 m0, s45, 68608
    s_nop 0
    buffer_load_dwordx4 v17, s[20:23], s46 offen lds
    s_add_u32 s53, s53, 1
    s_cmp_ge_u32 s53, 10
    s_cselect_b32 s53, 0, s53
    s_waitcnt vmcnt(8)
    s_barrier
    s_lshl_b32 s46, s53, 7
    s_add_u32 s46, s46, s47
    s_lshl_b32 s62, s53, 19
    s_add_u32 s62, s62, s48
    s_add_u32 m0, s45, 114688
    s_nop 0
    buffer_load_dwordx4 v8, s[24:27], s62 offen lds
    s_add_u32 m0, s45, 98304
    s_nop 0
    buffer_load_dwordx4 v16, s[20:23], s46 offen lds
    s_add_u32 s46, s46, 10240
    s_add_u32 s62, s62, 32768
    s_add_u32 m0, s45, 115712
    s_nop 0
    buffer_load_dwordx4 v8, s[24:27], s62 offen lds
    s_add_u32 m0, s45, 99328
    s_nop 0
    buffer_load_dwordx4 v17, s[20:23], s46 offen lds
    s_add_u32 s46, s46, 10240
    s_add_u32 s62, s62, 32768
    s_add_u32 m0, s45, 116736
    s_nop 0
    buffer_load_dwordx4 v20, s[24:27], s62 offen lds
    s_add_u32 m0, s45, 100352
    s_nop 0
    buffer_load_dwordx4 v16, s[20:23], s46 offen lds
    s_add_u32 s46, s46, 10240
    s_add_u32 s62, s62, 32768
    s_add_u32 m0, s45, 117760
    s_nop 0
    buffer_load_dwordx4 v20, s[24:27], s62 offen lds
    s_add_u32 m0, s45, 101376
    s_nop 0
    buffer_load_dwordx4 v17, s[20:23], s46 offen lds
    s_add_u32 s53, s53, 1
    s_cmp_ge_u32 s53, 10
    s_cselect_b32 s53, 0, s53
    s_waitcnt vmcnt(8)
    s_barrier
    s_lshl_b32 s46, s53, 7
    s_add_u32 s46, s46, s47
    s_lshl_b32 s62, s53, 19
    s_add_u32 s62, s62, s48
    s_add_u32 m0, s45, 147456
    s_nop 0
    buffer_load_dwordx4 v8, s[24:27], s62 offen lds
    s_add_u32 m0, s45, 131072
    s_nop 0
    buffer_load_dwordx4 v16, s[20:23], s46 offen lds
    s_add_u32 s46, s46, 10240
    s_add_u32 s62, s62, 32768
    s_add_u32 m0, s45, 148480
    s_nop 0
    buffer_load_dwordx4 v8, s[24:27], s62 offen lds
    s_add_u32 m0, s45, 132096
    s_nop 0
    buffer_load_dwordx4 v17, s[20:23], s46 offen lds
    s_add_u32 s46, s46, 10240
    s_add_u32 s62, s62, 32768
    s_add_u32 m0, s45, 149504
    s_nop 0
    buffer_load_dwordx4 v20, s[24:27], s62 offen lds
    s_add_u32 m0, s45, 133120
    s_nop 0
    buffer_load_dwordx4 v16, s[20:23], s46 offen lds
    s_add_u32 s46, s46, 10240
    s_add_u32 s62, s62, 32768
    s_add_u32 m0, s45, 150528
    s_nop 0
    buffer_load_dwordx4 v20, s[24:27], s62 offen lds
    s_add_u32 m0, s45, 134144
    s_nop 0
    buffer_load_dwordx4 v17, s[20:23], s46 offen lds
    s_add_u32 s53, s53, 1
    s_cmp_ge_u32 s53, 10
    s_cselect_b32 s53, 0, s53
    s_waitcnt vmcnt(8)
    s_barrier
    s_lshl_b32 s46, s53, 7
    s_add_u32 s46, s46, s47
    s_lshl_b32 s62, s53, 19
    s_add_u32 s62, s62, s48
    s_add_u32 m0, s45, 81920
    s_nop 0
    buffer_load_dwordx4 v8, s[24:27], s62 offen lds
    s_add_u32 m0, s45, 65536
    s_nop 0
    buffer_load_dwordx4 v16, s[20:23], s46 offen lds
    s_add_u32 s46, s46, 10240
    s_add_u32 s62, s62, 32768
    s_add_u32 m0, s45, 82944
    s_nop 0
    buffer_load_dwordx4 v8, s[24:27], s62 offen lds
    s_add_u32 m0, s45, 66560
    s_nop 0
    buffer_load_dwordx4 v17, s[20:23], s46 offen lds
    s_add_u32 s46, s46, 10240
    s_add_u32 s62, s62, 32768
    s_add_u32 m0, s45, 83968
    s_nop 0
    buffer_load_dwordx4 v20, s[24:27], s62 offen lds
    s_add_u32 m0, s45, 67584
    s_nop 0
    buffer_load_dwordx4 v16, s[20:23], s46 offen lds
    s_add_u32 s46, s46, 10240
    s_add_u32 s62, s62, 32768
    s_add_u32 m0, s45, 84992
    s_nop 0
    buffer_load_dwordx4 v20, s[24:27], s62 offen lds
    s_add_u32 m0, s45, 68608
    s_nop 0
    buffer_load_dwordx4 v17, s[20:23], s46 offen lds
    s_add_u32 s53, s53, 1
    s_cmp_ge_u32 s53, 10
    s_cselect_b32 s53, 0, s53
    s_mov_b32 s46, 0
    s_add_u32 m0, s45, 0
    s_nop 0
    buffer_load_dwordx4 v10, s[28:31], s46 offen offset:0 nt lds
    buffer_load_dwordx4 v11, s[28:31], s46 offen offset:1024 nt lds
    buffer_load_dwordx4 v12, s[28:31], s46 offen offset:2048 nt lds
    buffer_load_dwordx4 v13, s[28:31], s46 offen offset:3072 nt lds
    s_waitcnt vmcnt(12)
    s_barrier
    s_lshl_b32 s46, s53, 7
    s_add_u32 s46, s46, s47
    s_lshl_b32 s62, s53, 19
    s_add_u32 s62, s62, s48
    s_add_u32 m0, s45, 114688
    s_nop 0
    buffer_load_dwordx4 v8, s[24:27], s62 offen lds
    s_add_u32 m0, s45, 98304
    s_nop 0
    buffer_load_dwordx4 v16, s[20:23], s46 offen lds
    s_add_u32 s46, s46, 10240
    s_add_u32 s62, s62, 32768
    s_add_u32 m0, s45, 115712
    s_nop 0
    buffer_load_dwordx4 v8, s[24:27], s62 offen lds
    s_add_u32 m0, s45, 99328
    s_nop 0
    buffer_load_dwordx4 v17, s[20:23], s46 offen lds
    s_add_u32 s46, s46, 10240
    s_add_u32 s62, s62, 32768
    s_add_u32 m0, s45, 116736
    s_nop 0
    buffer_load_dwordx4 v20, s[24:27], s62 offen lds
    s_add_u32 m0, s45, 100352
    s_nop 0
    buffer_load_dwordx4 v16, s[20:23], s46 offen lds
    s_add_u32 s46, s46, 10240
    s_add_u32 s62, s62, 32768
    s_add_u32 m0, s45, 117760
    s_nop 0
    buffer_load_dwordx4 v20, s[24:27], s62 offen lds
    s_add_u32 m0, s45, 101376
    s_nop 0
    buffer_load_dwordx4 v17, s[20:23], s46 offen lds
    s_add_u32 s53, s53, 1
    s_cmp_ge_u32 s53, 10
    s_cselect_b32 s53, 0, s53
    s_waitcnt vmcnt(12)
    s_barrier
    s_lshl_b32 s46, s53, 7
    s_add_u32 s46, s46, s47
    s_lshl_b32 s62, s53, 19
    s_add_u32 s62, s62, s48
    s_add_u32 m0, s45, 147456
    s_nop 0
    buffer_load_dwordx4 v8, s[24:27], s62 offen lds
    s_add_u32 m0, s45, 131072
    s_nop 0
    buffer_load_dwordx4 v16, s[20:23], s46 offen lds
    s_add_u32 s46, s46, 10240
    s_add_u32 s62, s62, 32768
    s_add_u32 m0, s45, 148480
    s_nop 0
    buffer_load_dwordx4 v8, s[24:27], s62 offen lds
    s_add_u32 m0, s45, 132096
    s_nop 0
    buffer_load_dwordx4 v17, s[20:23], s46 offen lds
    s_add_u32 s46, s46, 10240
    s_add_u32 s62, s62, 32768
    s_add_u32 m0, s45, 149504
    s_nop 0
    buffer_load_dwordx4 v20, s[24:27], s62 offen lds
    s_add_u32 m0, s45, 133120
    s_nop 0
    buffer_load_dwordx4 v16, s[20:23], s46 offen lds
    s_add_u32 s46, s46, 10240
    s_add_u32 s62, s62, 32768
    s_add_u32 m0, s45, 150528
    s_nop 0
    buffer_load_dwordx4 v20, s[24:27], s62 offen lds
    s_add_u32 m0, s45, 134144
    s_nop 0
    buffer_load_dwordx4 v17, s[20:23], s46 offen lds
    s_add_u32 s53, s53, 1
    s_cmp_ge_u32 s53, 10
    s_cselect_b32 s53, 0, s53
    s_mov_b32 s46, 16384
    s_add_u32 m0, s45, 16384
    s_nop 0
    buffer_load_dwordx4 v10, s[28:31], s46 offen offset:0 nt lds
    buffer_load_dwordx4 v11, s[28:31], s46 offen offset:1024 nt lds
    buffer_load_dwordx4 v12, s[28:31], s46 offen offset:2048 nt lds
    buffer_load_dwordx4 v13, s[28:31], s46 offen offset:3072 nt lds
    s_mov_b32 s46, 32768
    s_add_u32 m0, s45, 32768
    s_nop 0
    buffer_load_dwordx4 v10, s[28:31], s46 offen offset:0 nt lds
    buffer_load_dwordx4 v11, s[28:31], s46 offen offset:1024 nt lds
    buffer_load_dwordx4 v12, s[28:31], s46 offen offset:2048 nt lds
    buffer_load_dwordx4 v13, s[28:31], s46 offen offset:3072 nt lds
    s_waitcnt vmcnt(16)
    s_barrier
    s_mov_b32 s46, 0
    s_add_u32 m0, s45, 65536
    s_nop 0
    buffer_load_dwordx4 v14, s[32:35], s46 offen offset:0 nt lds
    buffer_load_dwordx4 v9, s[32:35], s46 offen offset:1024 nt lds
    buffer_load_dwordx4 v14, s[32:35], s46 offen offset:2048 nt lds
    buffer_load_dwordx4 v9, s[32:35], s46 offen offset:3072 nt lds
    s_waitcnt vmcnt(12)
    s_barrier
    s_mov_b32 s46, 16384
    s_add_u32 m0, s45, 81920
    s_nop 0
    buffer_load_dwordx4 v14, s[32:35], s46 offen offset:0 nt lds
    buffer_load_dwordx4 v9, s[32:35], s46 offen offset:1024 nt lds
    buffer_load_dwordx4 v14, s[32:35], s46 offen offset:2048 nt lds
    buffer_load_dwordx4 v9, s[32:35], s46 offen offset:3072 nt lds
    s_barrier
    s_mov_b32 s46, 49152
    s_add_u32 m0, s45, 49152
    s_nop 0
    buffer_load_dwordx4 v10, s[28:31], s46 offen offset:0 nt lds
    buffer_load_dwordx4 v11, s[28:31], s46 offen offset:1024 nt lds
    buffer_load_dwordx4 v12, s[28:31], s46 offen offset:2048 nt lds
    buffer_load_dwordx4 v13, s[28:31], s46 offen offset:3072 nt lds
    s_mov_b32 s46, 32768
    s_add_u32 m0, s45, 98304
    s_nop 0
    buffer_load_dwordx4 v14, s[32:35], s46 offen offset:0 nt lds
    buffer_load_dwordx4 v9, s[32:35], s46 offen offset:1024 nt lds
    buffer_load_dwordx4 v14, s[32:35], s46 offen offset:2048 nt lds
    buffer_load_dwordx4 v9, s[32:35], s46 offen offset:3072 nt lds
    s_cmp_eq_u32 s44, 0
    s_cbranch_scc1 K1_L0
    s_cmp_eq_u32 s44, 1
    s_cbranch_scc1 K1_L1
    s_cmp_eq_u32 s44, 2
    s_cbranch_scc1 K1_L2
    s_branch K1_L3
K1_LATE:
    s_lshl_b32 s46, s53, 7
    s_add_u32 s46, s46, s47
    s_lshl_b32 s62, s53, 19
    s_add_u32 s62, s62, s48
    s_add_u32 m0, s45, 81920
    s_nop 0
    buffer_load_dwordx4 v8, s[24:27], s62 offen lds
    s_add_u32 m0, s45, 65536
    s_nop 0
    buffer_load_dwordx4 v16, s[20:23], s46 offen lds
    s_add_u32 s46, s46, 10240
    s_add_u32 s62, s62, 32768
    s_add_u32 m0, s45, 82944
    s_nop 0
    buffer_load_dwordx4 v8, s[24:27], s62 offen lds
    s_add_u32 m0, s45, 66560
    s_nop 0
    buffer_load_dwordx4 v17, s[20:23], s46 offen lds
    s_add_u32 s46, s46, 10240
    s_add_u32 s62, s62, 32768
    s_add_u32 m0, s45, 83968
    s_nop 0
    buffer_load_dwordx4 v20, s[24:27], s62 offen lds
    s_add_u32 m0, s45, 67584
    s_nop 0
    buffer_load_dwordx4 v16, s[20:23], s46 offen lds
    s_add_u32 s46, s46, 10240
    s_add_u32 s62, s62, 32768
    s_add_u32 m0, s45, 84992
    s_nop 0
    buffer_load_dwordx4 v20, s[24:27], s62 offen lds
    s_add_u32 m0, s45, 68608
    s_nop 0
    buffer_load_dwordx4 v17, s[20:23], s46 offen lds
    s_add_u32 s53, s53, 1
    s_cmp_ge_u32 s53, 10
    s_cselect_b32 s53, 0, s53
    s_mov_b32 s46, 0
    s_add_u32 m0, s45, 0
    s_nop 0
    buffer_load_dwordx4 v10, s[28:31], s46 offen offset:0 nt lds
    buffer_load_dwordx4 v11, s[28:31], s46 offen offset:1024 nt lds
    buffer_load_dwordx4 v12, s[28:31], s46 offen offset:2048 nt lds
    buffer_load_dwordx4 v13, s[28:31], s46 offen offset:3072 nt lds
    s_mov_b32 s46, 16384
    s_add_u32 m0, s45, 16384
    s_nop 0
    buffer_load_dwordx4 v10, s[28:31], s46 offen offset:0 nt lds
    buffer_load_dwordx4 v11, s[28:31], s46 offen offset:1024 nt lds
    buffer_load_dwordx4 v12, s[28:31], s46 offen offset:2048 nt lds
    buffer_load_dwordx4 v13, s[28:31], s46 offen offset:3072 nt lds
    v_add_u32 v4, 0, v255
    v_mul_u32_u24 v5, 205, v4
    v_lshrrev_b32 v5, 11, v5
    v_mul_u32_u24 v6, 10, v5
    v_sub_u32 v6, v4, v6
    v_mul_u32_u24 v5, 1280, v5
    v_lshl_add_u32 v235, v6, 4, v5
    v_add_u32 v4, 64, v255
    v_mul_u32_u24 v5, 205, v4
    v_lshrrev_b32 v5, 11, v5
    v_mul_u32_u24 v6, 10, v5
    v_sub_u32 v6, v4, v6
    v_mul_u32_u24 v5, 1280, v5
    v_lshl_add_u32 v236, v6, 4, v5
    v_add_u32 v4, 128, v255
    v_mul_u32_u24 v5, 205, v4
    v_lshrrev_b32 v5, 11, v5
    v_mul_u32_u24 v6, 10, v5
    v_sub_u32 v6, v4, v6
    v_mul_u32_u24 v5, 1280, v5
    v_lshl_add_u32 v237, v6, 4, v5
    v_add_u32 v4, 192, v255
    v_mul_u32_u24 v5, 205, v4
    v_lshrrev_b32 v5, 11, v5
    v_mul_u32_u24 v6, 10, v5
    v_sub_u32 v6, v4, v6
    v_mul_u32_u24 v5, 1280, v5
    v_lshl_add_u32 v238, v6, 4, v5
    v_add_u32 v4, 256, v255
    v_mul_u32_u24 v5, 205, v4
    v_lshrrev_b32 v5, 11, v5
    v_mul_u32_u24 v6, 10, v5
    v_sub_u32 v6, v4, v6
    v_mul_u32_u24 v5, 1280, v5
    v_lshl_add_u32 v239, v6, 4, v5
    s_mul_i32 s63, s56, 1310720
    s_mul_i32 s46, s57, 160
    s_add_u32 s63, s63, s46
    s_xor_b32 s7, s57, 7
    s_lshl_b32 s7, s7, 31
    s_and_b32 s7, s7, 31
    v_lshlrev_b32 v247, 4, v255
    v_add_u32 v247, s45, v247
    v_add_u32 v248, 65536, v247
    s_waitcnt vmcnt(16)
    s_barrier
    s_mov_b32 s46, 0
    buffer_load_dwordx4 v[24:27], v14, s[32:35], s46 offen offset:0 nt
    buffer_load_dwordx4 v[28:31], v9, s[32:35], s46 offen offset:1024 nt
    buffer_load_dwordx4 v[32:35], v14, s[32:35], s46 offen offset:2048 nt
    buffer_load_dwordx4 v[36:39], v9, s[32:35], s46 offen offset:3072 nt
    s_mov_b32 s46, 32768
    s_add_u32 m0, s45, 32768
    s_nop 0
    buffer_load_dwordx4 v10, s[28:31], s46 offen offset:0 nt lds
    buffer_load_dwordx4 v11, s[28:31], s46 offen offset:1024 nt lds
    buffer_load_dwordx4 v12, s[28:31], s46 offen offset:2048 nt lds
    buffer_load_dwordx4 v13, s[28:31], s46 offen offset:3072 nt lds
    s_waitcnt vmcnt(16)
    s_barrier
    s_mov_b32 s46, 16384
    buffer_load_dwordx4 v[40:43], v14, s[32:35], s46 offen offset:0 nt
    buffer_load_dwordx4 v[44:47], v9, s[32:35], s46 offen offset:1024 nt
    buffer_load_dwordx4 v[48:51], v14, s[32:35], s46 offen offset:2048 nt
    buffer_load_dwordx4 v[52:55], v9, s[32:35], s46 offen offset:3072 nt
    s_mov_b32 s46, 49152
    s_add_u32 m0, s45, 49152
    s_nop 0
    buffer_load_dwordx4 v10, s[28:31], s46 offen offset:0 nt lds
    buffer_load_dwordx4 v11, s[28:31], s46 offen offset:1024 nt lds
    buffer_load_dwordx4 v12, s[28:31], s46 offen offset:2048 nt lds
    buffer_load_dwordx4 v13, s[28:31], s46 offen offset:3072 nt lds
    s_mov_b32 s46, 32768
    buffer_load_dwordx4 v[56:59], v14, s[32:35], s46 offen offset:0 nt
    buffer_load_dwordx4 v[60:63], v9, s[32:35], s46 offen offset:1024 nt
    buffer_load_dwordx4 v[64:67], v14, s[32:35], s46 offen offset:2048 nt
    buffer_load_dwordx4 v[68:71], v9, s[32:35], s46 offen offset:3072 nt
    s_mov_b32 s46, 49152
    buffer_load_dwordx4 v[72:75], v14, s[32:35], s46 offen offset:0 nt
    buffer_load_dwordx4 v[76:79], v9, s[32:35], s46 offen offset:1024 nt
    buffer_load_dwordx4 v[80:83], v14, s[32:35], s46 offen offset:2048 nt
    buffer_load_dwordx4 v[84:87], v9, s[32:35], s46 offen offset:3072 nt
    s_lshl_b32 s46, s53, 7
    s_add_u32 s46, s46, s47
    s_lshl_b32 s62, s53, 19
    s_add_u32 s62, s62, s48
    s_add_u32 m0, s45, 114688
    s_nop 0
    buffer_load_dwordx4 v8, s[24:27], s62 offen lds
    s_add_u32 m0, s45, 98304
    s_nop 0
    buffer_load_dwordx4 v16, s[20:23], s46 offen lds
    s_add_u32 s46, s46, 10240
    s_add_u32 s62, s62, 32768
    s_add_u32 m0, s45, 115712
    s_nop 0
    buffer_load_dwordx4 v8, s[24:27], s62 offen lds
    s_add_u32 m0, s45, 99328
    s_nop 0
    buffer_load_dwordx4 v17, s[20:23], s46 offen lds
    s_add_u32 s46, s46, 10240
    s_add_u32 s62, s62, 32768
    s_add_u32 m0, s45, 116736
    s_nop 0
    buffer_load_dwordx4 v20, s[24:27], s62 offen lds
    s_add_u32 m0, s45, 100352
    s_nop 0
    buffer_load_dwordx4 v16, s[20:23], s46 offen lds
    s_add_u32 s46, s46, 10240
    s_add_u32 s62, s62, 32768
    s_add_u32 m0, s45, 117760
    s_nop 0
    buffer_load_dwordx4 v20, s[24:27], s62 offen lds
    s_add_u32 m0, s45, 101376
    s_nop 0
    buffer_load_dwordx4 v17, s[20:23], s46 offen lds
    s_add_u32 s53, s53, 1
    s_cmp_ge_u32 s53, 10
    s_cselect_b32 s53, 0, s53
    s_lshl_b32 s46, s53, 7
    s_add_u32 s46, s46, s47
    s_lshl_b32 s62, s53, 19
    s_add_u32 s62, s62, s48
    s_add_u32 m0, s45, 147456
    s_nop 0
    buffer_load_dwordx4 v8, s[24:27], s62 offen lds
    s_add_u32 m0, s45, 131072
    s_nop 0
    buffer_load_dwordx4 v16, s[20:23], s46 offen lds
    s_add_u32 s46, s46, 10240
    s_add_u32 s62, s62, 32768
    s_add_u32 m0, s45, 148480
    s_nop 0
    buffer_load_dwordx4 v8, s[24:27], s62 offen lds
    s_add_u32 m0, s45, 132096
    s_nop 0
    buffer_load_dwordx4 v17, s[20:23], s46 offen lds
    s_add_u32 s46, s46, 10240
    s_add_u32 s62, s62, 32768
    s_add_u32 m0, s45, 149504
    s_nop 0
    buffer_load_dwordx4 v20, s[24:27], s62 offen lds
    s_add_u32 m0, s45, 133120
    s_nop 0
    buffer_load_dwordx4 v16, s[20:23], s46 offen lds
    s_add_u32 s46, s46, 10240
    s_add_u32 s62, s62, 32768
    s_add_u32 m0, s45, 150528
    s_nop 0
    buffer_load_dwordx4 v20, s[24:27], s62 offen lds
    s_add_u32 m0, s45, 134144
    s_nop 0
    buffer_load_dwordx4 v17, s[20:23], s46 offen lds
    s_add_u32 s53, s53, 1
    s_cmp_ge_u32 s53, 10
    s_cselect_b32 s53, 0, s53
    s_waitcnt vmcnt(8)
    s_barrier
    s_lshl_b32 s46, s53, 7
    s_add_u32 s46, s46, s47
    s_lshl_b32 s62, s53, 19
    s_add_u32 s62, s62, s48
    s_add_u32 m0, s45, 81920
    s_nop 0
    buffer_load_dwordx4 v8, s[24:27], s62 offen lds
    s_add_u32 m0, s45, 65536
    s_nop 0
    buffer_load_dwordx4 v16, s[20:23], s46 offen lds
    s_add_u32 s46, s46, 10240
    s_add_u32 s62, s62, 32768
    s_add_u32 m0, s45, 82944
    s_nop 0
    buffer_load_dwordx4 v8, s[24:27], s62 offen lds
    s_add_u32 m0, s45, 66560
    s_nop 0
    buffer_load_dwordx4 v17, s[20:23], s46 offen lds
    s_add_u32 s46, s46, 10240
    s_add_u32 s62, s62, 32768
    s_add_u32 m0, s45, 83968
    s_nop 0
    buffer_load_dwordx4 v20, s[24:27], s62 offen lds
    s_add_u32 m0, s45, 67584
    s_nop 0
    buffer_load_dwordx4 v16, s[20:23], s46 offen lds
    s_add_u32 s46, s46, 10240
    s_add_u32 s62, s62, 32768
    s_add_u32 m0, s45, 84992
    s_nop 0
    buffer_load_dwordx4 v20, s[24:27], s62 offen lds
    s_add_u32 m0, s45, 68608
    s_nop 0
    buffer_load_dwordx4 v17, s[20:23], s46 offen lds
    s_add_u32 s53, s53, 1
    s_cmp_ge_u32 s53, 10
    s_cselect_b32 s53, 0, s53
    s_waitcnt vmcnt(8)
    s_barrier
    s_lshl_b32 s46, s53, 7
    s_add_u32 s46, s46, s47
    s_lshl_b32 s62, s53, 19
    s_add_u32 s62, s62, s48
    s_add_u32 m0, s45, 114688
    s_nop 0
    buffer_load_dwordx4 v8, s[24:27], s62 offen lds
    s_add_u32 m0, s45, 98304
    s_nop 0
    buffer_load_dwordx4 v16, s[20:23], s46 offen lds
    s_add_u32 s46, s46, 10240
    s_add_u32 s62, s62, 32768
    s_add_u32 m0, s45, 115712
    s_nop 0
    buffer_load_dwordx4 v8, s[24:27], s62 offen lds
    s_add_u32 m0, s45, 99328
    s_nop 0
    buffer_load_dwordx4 v17, s[20:23], s46 offen lds
    s_add_u32 s46, s46, 10240
    s_add_u32 s62, s62, 32768
    s_add_u32 m0, s45, 116736
    s_nop 0
    buffer_load_dwordx4 v20, s[24:27], s62 offen lds
    s_add_u32 m0, s45, 100352
    s_nop 0
    buffer_load_dwordx4 v16, s[20:23], s46 offen lds
    s_add_u32 s46, s46, 10240
    s_add_u32 s62, s62, 32768
    s_add_u32 m0, s45, 117760
    s_nop 0
    buffer_load_dwordx4 v20, s[24:27], s62 offen lds
    s_add_u32 m0, s45, 101376
    s_nop 0
    buffer_load_dwordx4 v17, s[20:23], s46 offen lds
    s_add_u32 s53, s53, 1
    s_cmp_ge_u32 s53, 10
    s_cselect_b32 s53, 0, s53
    s_waitcnt vmcnt(8)
    s_barrier
    s_lshl_b32 s46, s53, 7
    s_add_u32 s46, s46, s47
    s_lshl_b32 s62, s53, 19
    s_add_u32 s62, s62, s48
    s_add_u32 m0, s45, 147456
    s_nop 0
    buffer_load_dwordx4 v8, s[24:27], s62 offen lds
    s_add_u32 m0, s45, 131072
    s_nop 0
    buffer_load_dwordx4 v16, s[20:23], s46 offen lds
    s_add_u32 s46, s46, 10240
    s_add_u32 s62, s62, 32768
    s_add_u32 m0, s45, 148480
    s_nop 0
    buffer_load_dwordx4 v8, s[24:27], s62 offen lds
    s_add_u32 m0, s45, 132096
    s_nop 0
    buffer_load_dwordx4 v17, s[20:23], s46 offen lds
    s_add_u32 s46, s46, 10240
    s_add_u32 s62, s62, 32768
    s_add_u32 m0, s45, 149504
    s_nop 0
    buffer_load_dwordx4 v20, s[24:27], s62 offen lds
    s_add_u32 m0, s45, 133120
    s_nop 0
    buffer_load_dwordx4 v16, s[20:23], s46 offen lds
    s_add_u32 s46, s46, 10240
    s_add_u32 s62, s62, 32768
    s_add_u32 m0, s45, 150528
    s_nop 0
    buffer_load_dwordx4 v20, s[24:27], s62 offen lds
    s_add_u32 m0, s45, 134144
    s_nop 0
    buffer_load_dwordx4 v17, s[20:23], s46 offen lds
    s_add_u32 s53, s53, 1
    s_cmp_ge_u32 s53, 10
    s_cselect_b32 s53, 0, s53
    s_waitcnt vmcnt(8)
    s_barrier
    s_lshl_b32 s46, s53, 7
    s_add_u32 s46, s46, s47
    s_lshl_b32 s62, s53, 19
    s_add_u32 s62, s62, s48
    s_add_u32 m0, s45, 81920
    s_nop 0
    buffer_load_dwordx4 v8, s[24:27], s62 offen lds
    s_add_u32 m0, s45, 65536
    s_nop 0
    buffer_load_dwordx4 v16, s[20:23], s46 offen lds
    s_add_u32 s46, s46, 10240
    s_add_u32 s62, s62, 32768
    s_add_u32 m0, s45, 82944
    s_nop 0
    buffer_load_dwordx4 v8, s[24:27], s62 offen lds
    s_add_u32 m0, s45, 66560
    s_nop 0
    buffer_load_dwordx4 v17, s[20:23], s46 offen lds
    s_add_u32 s46, s46, 10240
    s_add_u32 s62, s62, 32768
    s_add_u32 m0, s45, 83968
    s_nop 0
    buffer_load_dwordx4 v20, s[24:27], s62 offen lds
    s_add_u32 m0, s45, 67584
    s_nop 0
    buffer_load_dwordx4 v16, s[20:23], s46 offen lds
    s_add_u32 s46, s46, 10240
    s_add_u32 s62, s62, 32768
    s_add_u32 m0, s45, 84992
    s_nop 0
    buffer_load_dwordx4 v20, s[24:27], s62 offen lds
    s_add_u32 m0, s45, 68608
    s_nop 0
    buffer_load_dwordx4 v17, s[20:23], s46 offen lds
    s_add_u32 s53, s53, 1
    s_cmp_ge_u32 s53, 10
    s_cselect_b32 s53, 0, s53
    s_waitcnt vmcnt(8)
    s_barrier
    s_lshl_b32 s46, s53, 7
    s_add_u32 s46, s46, s47
    s_lshl_b32 s62, s53, 19
    s_add_u32 s62, s62, s48
    s_add_u32 m0, s45, 114688
    s_nop 0
    buffer_load_dwordx4 v8, s[24:27], s62 offen lds
    s_add_u32 m0, s45, 98304
    s_nop 0
    buffer_load_dwordx4 v16, s[20:23], s46 offen lds
    s_add_u32 s46, s46, 10240
    s_add_u32 s62, s62, 32768
    s_add_u32 m0, s45, 115712
    s_nop 0
    buffer_load_dwordx4 v8, s[24:27], s62 offen lds
    s_add_u32 m0, s45, 99328
    s_nop 0
    buffer_load_dwordx4 v17, s[20:23], s46 offen lds
    s_add_u32 s46, s46, 10240
    s_add_u32 s62, s62, 32768
    s_add_u32 m0, s45, 116736
    s_nop 0
    buffer_load_dwordx4 v20, s[24:27], s62 offen lds
    s_add_u32 m0, s45, 100352
    s_nop 0
    buffer_load_dwordx4 v16, s[20:23], s46 offen lds
    s_add_u32 s46, s46, 10240
    s_add_u32 s62, s62, 32768
    s_add_u32 m0, s45, 117760
    s_nop 0
    buffer_load_dwordx4 v20, s[24:27], s62 offen lds
    s_add_u32 m0, s45, 101376
    s_nop 0
    buffer_load_dwordx4 v17, s[20:23], s46 offen lds
    s_add_u32 s53, s53, 1
    s_cmp_ge_u32 s53, 10
    s_cselect_b32 s53, 0, s53
    s_waitcnt vmcnt(8)
    s_barrier
    s_lshl_b32 s46, s53, 7
    s_add_u32 s46, s46, s47
    s_lshl_b32 s62, s53, 19
    s_add_u32 s62, s62, s48
    s_add_u32 m0, s45, 147456
    s_nop 0
    buffer_load_dwordx4 v8, s[24:27], s62 offen lds
    s_add_u32 m0, s45, 131072
    s_nop 0
    buffer_load_dwordx4 v16, s[20:23], s46 offen lds
    s_add_u32 s46, s46, 10240
    s_add_u32 s62, s62, 32768
    s_add_u32 m0, s45, 148480
    s_nop 0
    buffer_load_dwordx4 v8, s[24:27], s62 offen lds
    s_add_u32 m0, s45, 132096
    s_nop 0
    buffer_load_dwordx4 v17, s[20:23], s46 offen lds
    s_add_u32 s46, s46, 10240
    s_add_u32 s62, s62, 32768
    s_add_u32 m0, s45, 149504
    s_nop 0
    buffer_load_dwordx4 v20, s[24:27], s62 offen lds
    s_add_u32 m0, s45, 133120
    s_nop 0
    buffer_load_dwordx4 v16, s[20:23], s46 offen lds
    s_add_u32 s46, s46, 10240
    s_add_u32 s62, s62, 32768
    s_add_u32 m0, s45, 150528
    s_nop 0
    buffer_load_dwordx4 v20, s[24:27], s62 offen lds
    s_add_u32 m0, s45, 134144
    s_nop 0
    buffer_load_dwordx4 v17, s[20:23], s46 offen lds
    s_add_u32 s53, s53, 1
    s_cmp_ge_u32 s53, 10
    s_cselect_b32 s53, 0, s53
    s_mov_b32 s46, 65536
    buffer_load_dwordx4 v[88:91], v10, s[28:31], s46 offen offset:0 nt
    buffer_load_dwordx4 v[92:95], v11, s[28:31], s46 offen offset:1024 nt
    buffer_load_dwordx4 v[96:99], v12, s[28:31], s46 offen offset:2048 nt
    buffer_load_dwordx4 v[100:103], v13, s[28:31], s46 offen offset:3072 nt
    s_mov_b32 s46, 65536
    buffer_load_dwordx4 v[104:107], v14, s[32:35], s46 offen offset:0 nt
    buffer_load_dwordx4 v[108:111], v9, s[32:35], s46 offen offset:1024 nt
    buffer_load_dwordx4 v[112:115], v14, s[32:35], s46 offen offset:2048 nt
    buffer_load_dwordx4 v[116:119], v9, s[32:35], s46 offen offset:3072 nt
    s_waitcnt vmcnt(16)
    s_barrier
    ds_write_b128 v248, v[24:27] offset:0
    ds_write_b128 v248, v[28:31] offset:1024
    ds_write_b128 v248, v[32:35] offset:2048
    ds_write_b128 v248, v[36:39] offset:3072
    ds_write_b128 v248, v[40:43] offset:16384
    ds_write_b128 v248, v[44:47] offset:17408
    ds_write_b128 v248, v[48:51] offset:18432
    ds_write_b128 v248, v[52:55] offset:19456
    s_mov_b32 s46, 81920
    buffer_load_dwordx4 v[120:123], v10, s[28:31], s46 offen offset:0 nt
    buffer_load_dwordx4 v[124:127], v11, s[28:31], s46 offen offset:1024 nt
    buffer_load_dwordx4 v[128:131], v12, s[28:31], s46 offen offset:2048 nt
    buffer_load_dwordx4 v[132:135], v13, s[28:31], s46 offen offset:3072 nt
    s_waitcnt vmcnt(12)
    s_waitcnt lgkmcnt(0)
    s_barrier
    ds_write_b128 v248, v[56:59] offset:32768
    ds_write_b128 v248, v[60:63] offset:33792
    ds_write_b128 v248, v[64:67] offset:34816
    ds_write_b128 v248, v[68:71] offset:35840
    ds_write_b128 v248, v[72:75] offset:49152
    ds_write_b128 v248, v[76:79] offset:50176
    ds_write_b128 v248, v[80:83] offset:51200
    ds_write_b128 v248, v[84:87] offset:52224
    s_mov_b32 s46, 81920
    buffer_load_dwordx4 v[136:139], v14, s[32:35], s46 offen offset:0 nt
    buffer_load_dwordx4 v[140:143], v9, s[32:35], s46 offen offset:1024 nt
    buffer_load_dwordx4 v[144:147], v14, s[32:35], s46 offen offset:2048 nt
    buffer_load_dwordx4 v[148:151], v9, s[32:35], s46 offen offset:3072 nt
    s_waitcnt lgkmcnt(0)
    s_barrier
    s_mov_b32 s46, 98304
    buffer_load_dwordx4 v[152:155], v10, s[28:31], s46 offen offset:0 nt
    buffer_load_dwordx4 v[156:159], v11, s[28:31], s46 offen offset:1024 nt
    buffer_load_dwordx4 v[160:163], v12, s[28:31], s46 offen offset:2048 nt
    buffer_load_dwordx4 v[164:167], v13, s[28:31], s46 offen offset:3072 nt
    s_cmp_eq_u32 s44, 0
    s_cbranch_scc1 K1_LL0
    s_cmp_eq_u32 s44, 1
    s_cbranch_scc1 K1_LL1
    s_cmp_eq_u32 s44, 2
    s_cbranch_scc1 K1_LL2
    s_branch K1_LL3
K1_COMP:
    s_waitcnt lgkmcnt(0)
    s_mov_b32 s72, s14
    s_and_b32 s73, s15, 0xffff
    s_mov_b32 s68, s16
    s_and_b32 s69, s17, 0xffff
    s_mov_b32 s70, 256
    s_mov_b32 s71, 0x00020000
    s_mov_b32 s30, 262144
    s_mov_b32 s31, 0x00020000
    s_mov_b32 s34, 262144
    s_mov_b32 s35, 0x00020000
    s_mov_b32 s36, s18
    s_and_b32 s37, s19, 0xffff
    s_mov_b32 s38, 50331648
    s_mov_b32 s39, 0x00020000
    s_mov_b32 s64, s12
    s_and_b32 s65, s13, 0xffff
    s_mov_b32 s66, 5242880
    s_mov_b32 s67, 0x00020000
    s_mov_b32 s74, 1310720
    s_mov_b32 s75, 0x00020000
    s_lshl_b32 s43, s42, 5
    s_add_u32 s43, s43, s41
    s_lshl_b32 s46, s43, 18
    s_add_u32 s28, s6, s46
    s_addc_u32 s29, s7, 0
    s_and_b32 s29, s29, 0xffff
    s_add_u32 s32, s8, s46
    s_addc_u32 s33, s9, 0
    s_and_b32 s33, s33, 0xffff
    s_lshl_b32 s54, s43, 13
    s_add_u32 s54, s54, 25165824
    s_and_b32 s76, s40, 3
    s_lshr_b32 s77, s40, 2
    s_lshl_b32 s46, s76, 10
    s_add_u32 s78, s54, s46
    s_lshr_b32 s46, s57, 2
    s_xor_b32 s10, s77, s46
    s_lshl_b32 s46, s10, 9
    s_add_u32 s78, s78, s46
    s_cmp_lg_u32 s40, 2
    s_cbranch_scc1 K1_NOTC
    s_mov_b64 exec, 1
    s_lshl_b32 s46, s42, 8
    s_add_u32 s46, s46, s41
    s_lshl_b32 s46, s46, 12
    v_mov_b32 v222, s46
    buffer_load_dword v223, v222, s[36:39], 0 offen
    s_lshl_b32 s46, s42, 3
    s_add_u32 s46, s46, s57
    s_lshl_b32 s46, s46, 2
    s_add_u32 s46, s46, s56
    s_mul_i32 s46, s46, 40960
    s_add_u32 s46, s46, 33554432
    v_mov_b32 v222, s46
    buffer_load_dword v223, v222, s[36:39], 0 offen
    s_lshl_b32 s46, s42, 2
    s_add_u32 s46, s46, s56
    s_mul_i32 s46, s46, 40960
    v_mov_b32 v222, s46
    buffer_load_dword v223, v222, s[72:75], 0 offen
    s_mov_b64 exec, -1
K1_NOTC:
    v_and_b32 v208, 31, v255
    v_lshrrev_b32 v209, 5, v255
    s_lshl_b32 s46, s40, 12
    s_add_u32 s46, s46, 65536
    v_bfe_u32 v212, v255, 1, 3
    v_xor_b32 v212, v212, v209
    v_lshlrev_b32 v212, 4, v212
    v_lshl_add_u32 v212, v208, 7, v212
    v_add_u32 v160, s46, v212
    v_xor_b32 v161, 32, v160
    v_xor_b32 v162, 64, v160
    v_xor_b32 v163, 96, v160
    v_add_u32 v164, 0x10000, v160
    v_add_u32 v165, 0x10000, v161
    v_add_u32 v166, 0x10000, v162
    v_add_u32 v167, 0x10000, v163
    v_and_b32 v211, 15, v255
    v_xor_b32 v212, v209, v211
    v_lshlrev_b32 v212, 4, v212
    v_lshl_add_u32 v240, v208, 8, v212
    v_bfe_u32 v210, v255, 4, 1
    v_and_b32 v211, 1, v255
    v_bfe_u32 v213, v255, 1, 1
    v_lshlrev_b32 v212, 5, v210
    v_lshl_add_u32 v212, v211, 4, v212
    v_lshl_add_u32 v212, v213, 3, v212
    v_lshlrev_b32 v215, 5, v213
    v_lshl_add_u32 v215, v210, 3, v215
    v_lshl_add_u32 v215, v211, 4, v215
    v_bfe_u32 v213, v255, 2, 2
    v_lshl_add_u32 v212, v213, 8, v212
    v_lshl_add_u32 v215, v213, 8, v215
    v_xor_b32 v214, 0, v213
    v_lshl_add_u32 v210, v214, 6, v212
    v_lshl_add_u32 v225, v209, 11, v210
    v_add_u32 v225, 81920, v225
    v_add_u32 v168, 0x10000, v225
    v_lshl_add_u32 v210, v214, 6, v215
    v_lshl_add_u32 v248, v209, 10, v210
    v_add_u32 v248, 65536, v248
    v_xor_b32 v214, 1, v213
    v_lshl_add_u32 v210, v214, 6, v212
    v_lshl_add_u32 v226, v209, 11, v210
    v_add_u32 v226, 81920, v226
    v_add_u32 v169, 0x10000, v226
    v_lshl_add_u32 v210, v214, 6, v215
    v_lshl_add_u32 v249, v209, 10, v210
    v_add_u32 v249, 65536, v249
    v_xor_b32 v214, 2, v213
    v_lshl_add_u32 v210, v214, 6, v212
    v_lshl_add_u32 v227, v209, 11, v210
    v_add_u32 v227, 81920, v227
    v_add_u32 v170, 0x10000, v227
    v_lshl_add_u32 v210, v214, 6, v215
    v_lshl_add_u32 v250, v209, 10, v210
    v_add_u32 v250, 65536, v250
    v_xor_b32 v214, 3, v213
    v_lshl_add_u32 v210, v214, 6, v212
    v_lshl_add_u32 v228, v209, 11, v210
    v_add_u32 v228, 81920, v228
    v_add_u32 v171, 0x10000, v228
    v_lshl_add_u32 v210, v214, 6, v215
    v_lshl_add_u32 v251, v209, 10, v210
    v_add_u32 v251, 65536, v251
    v_and_b32 v208, 15, v255
    v_lshrrev_b32 v209, 4, v255
    v_bfe_u32 v210, v255, 1, 3
    v_xor_b32 v210, v210, v209
    v_lshlrev_b32 v210, 4, v210
    v_lshl_add_u32 v210, v208, 7, v210
    s_lshl_b32 s46, s40, 12
    s_add_u32 s46, s46, 65536
    v_add_u32 v160, s46, v210
    v_xor_b32 v161, 64, v160
    v_add_u32 v162, 0x10000, v160
    v_add_u32 v163, 0x10000, v161
    v_bfe_u32 v208, v255, 2, 2
    v_lshl_add_u32 v210, v209, 3, v208
    v_bfe_u32 v208, v255, 2, 3
    v_lshlrev_b32 v208, 5, v208
    v_lshl_add_u32 v208, v210, 8, v208
    v_and_b32 v210, 3, v255
    v_lshl_add_u32 v208, v210, 3, v208
    v_add_u32 v176, 81920, v208
    v_xor_b32 v177, 32, v176
    v_xor_b32 v178, 64, v176
    v_xor_b32 v179, 96, v176
    v_xor_b32 v180, 128, v176
    v_xor_b32 v181, 160, v176
    v_xor_b32 v182, 192, v176
    v_xor_b32 v183, 224, v176
    v_add_u32 v184, 0x10000, v176
    v_add_u32 v185, 0x10000, v177
    v_add_u32 v186, 0x10000, v178
    v_add_u32 v187, 0x10000, v179
    v_add_u32 v188, 0x10000, v180
    v_add_u32 v189, 0x10000, v181
    v_add_u32 v190, 0x10000, v182
    v_add_u32 v191, 0x10000, v183
    v_and_b32 v211, 15, v255
    v_bfe_u32 v209, v255, 4, 1
    v_lshrrev_b32 v210, 5, v255
    v_lshl_or_b32 v209, v209, 1, v210
    v_xor_b32 v209, v209, v211
    v_lshlrev_b32 v209, 4, v209
    v_lshl_add_u32 v240, v211, 8, v209
    v_lshrrev_b32 v208, 2, v255
    v_and_b32 v209, 7, v208
    v_lshlrev_b32 v209, 5, v209
    v_lshl_add_u32 v209, v208, 8, v209
    v_and_b32 v210, 3, v255
    v_lshl_add_u32 v209, v210, 3, v209
    v_add_u32 v244, 65536, v209
    v_xor_b32 v241, 64, v240
    v_xor_b32 v242, 128, v240
    v_xor_b32 v243, 192, v240
    v_xor_b32 v245, 32, v244
    v_xor_b32 v246, 64, v244
    v_xor_b32 v247, 96, v244
    v_xor_b32 v248, 128, v244
    v_xor_b32 v249, 160, v244
    v_xor_b32 v250, 192, v244
    v_xor_b32 v251, 224, v244
    s_mov_b32 s50, 0x3e0293ee
    s_mov_b32 s51, 0xbe0293ee
    v_mov_b32 v0, 0
    v_mov_b32 v1, 0
    v_mov_b32 v2, 0
    v_mov_b32 v3, 0
    v_mov_b32 v4, 0
    v_mov_b32 v5, 0
    v_mov_b32 v6, 0
    v_mov_b32 v7, 0
    v_mov_b32 v8, 0
    v_mov_b32 v9, 0
    v_mov_b32 v10, 0
    v_mov_b32 v11, 0
    v_mov_b32 v12, 0
    v_mov_b32 v13, 0
    v_mov_b32 v14, 0
    v_mov_b32 v15, 0
    v_mov_b32 v16, 0
    v_mov_b32 v17, 0
    v_mov_b32 v18, 0
    v_mov_b32 v19, 0
    v_mov_b32 v20, 0
    v_mov_b32 v21, 0
    v_mov_b32 v22, 0
    v_mov_b32 v23, 0
    v_mov_b32 v24, 0
    v_mov_b32 v25, 0
    v_mov_b32 v26, 0
    v_mov_b32 v27, 0
    v_mov_b32 v28, 0
    v_mov_b32 v29, 0
    v_mov_b32 v30, 0
    v_mov_b32 v31, 0
    v_mov_b32 v32, 0
    v_mov_b32 v33, 0
    v_mov_b32 v34, 0
    v_mov_b32 v35, 0
    v_mov_b32 v36, 0
    v_mov_b32 v37, 0
    v_mov_b32 v38, 0
    v_mov_b32 v39, 0
    v_mov_b32 v40, 0
    v_mov_b32 v41, 0
    v_mov_b32 v42, 0
    v_mov_b32 v43, 0
    v_mov_b32 v44, 0
    v_mov_b32 v45, 0
    v_mov_b32 v46, 0
    v_mov_b32 v47, 0
    v_mov_b32 v48, 0
    v_mov_b32 v49, 0
    v_mov_b32 v50, 0
    v_mov_b32 v51, 0
    v_mov_b32 v52, 0
    v_mov_b32 v53, 0
    v_mov_b32 v54, 0
    v_mov_b32 v55, 0
    v_mov_b32 v56, 0
    v_mov_b32 v57, 0
    v_mov_b32 v58, 0
    v_mov_b32 v59, 0
    v_mov_b32 v60, 0
    v_mov_b32 v61, 0
    v_mov_b32 v62, 0
    v_mov_b32 v63, 0
    s_barrier
    ds_read_b128 v[144:147], v162 offset:0
    ds_read_b128 v[148:151], v162 offset:2048
    ds_read_b64_tr_b16 v[96:97], v184 offset:0
    ds_read_b64_tr_b16 v[98:99], v184 offset:1024
    ds_read_b64_tr_b16 v[100:101], v185 offset:0
    ds_read_b64_tr_b16 v[102:103], v185 offset:1024
    ds_read_b64_tr_b16 v[104:105], v186 offset:0
    ds_read_b64_tr_b16 v[106:107], v186 offset:1024
    ds_read_b64_tr_b16 v[108:109], v187 offset:0
    ds_read_b64_tr_b16 v[110:111], v187 offset:1024
    ds_read_b64_tr_b16 v[112:113], v188 offset:0
    ds_read_b64_tr_b16 v[114:115], v188 offset:1024
    ds_read_b64_tr_b16 v[116:117], v189 offset:0
    ds_read_b64_tr_b16 v[118:119], v189 offset:1024
    ds_read_b64_tr_b16 v[120:121], v190 offset:0
    s_waitcnt lgkmcnt(14)
    ds_read_b64_tr_b16 v[122:123], v190 offset:1024
    s_waitcnt lgkmcnt(14)
    ds_read_b64_tr_b16 v[124:125], v191 offset:0
    s_waitcnt lgkmcnt(14)
    ds_read_b64_tr_b16 v[126:127], v191 offset:1024
    s_waitcnt lgkmcnt(14)
    v_mfma_f32_16x16x32_bf16 v[0:3], v[96:99], v[144:147], v[0:3]
    ds_read_b128 v[152:155], v163 offset:0
    v_mfma_f32_16x16x32_bf16 v[4:7], v[96:99], v[148:151], v[4:7]
    s_waitcnt lgkmcnt(14)
    ds_read_b128 v[156:159], v163 offset:2048
    s_waitcnt lgkmcnt(14)
    v_mfma_f32_16x16x32_bf16 v[8:11], v[100:103], v[144:147], v[8:11]
    ds_read_b64_tr_b16 v[128:129], v184 offset:8192
    v_mfma_f32_16x16x32_bf16 v[12:15], v[100:103], v[148:151], v[12:15]
    s_waitcnt lgkmcnt(14)
    ds_read_b64_tr_b16 v[130:131], v184 offset:9216
    s_waitcnt lgkmcnt(14)
    ds_read_b64_tr_b16 v[132:133], v185 offset:8192
    v_mfma_f32_16x16x32_bf16 v[16:19], v[104:107], v[144:147], v[16:19]
    s_waitcnt lgkmcnt(14)
    ds_read_b64_tr_b16 v[134:135], v185 offset:9216
    v_mfma_f32_16x16x32_bf16 v[20:23], v[104:107], v[148:151], v[20:23]
    s_waitcnt lgkmcnt(14)
    ds_read_b64_tr_b16 v[136:137], v186 offset:8192
    v_mfma_f32_16x16x32_bf16 v[24:27], v[108:111], v[144:147], v[24:27]
    s_waitcnt lgkmcnt(14)
    ds_read_b64_tr_b16 v[138:139], v186 offset:9216
    v_mfma_f32_16x16x32_bf16 v[28:31], v[108:111], v[148:151], v[28:31]
    s_waitcnt lgkmcnt(14)
    ds_read_b64_tr_b16 v[140:141], v187 offset:8192
    s_waitcnt lgkmcnt(14)
    ds_read_b64_tr_b16 v[142:143], v187 offset:9216
    v_mfma_f32_16x16x32_bf16 v[32:35], v[112:115], v[144:147], v[32:35]
    s_waitcnt lgkmcnt(14)
    ds_read_b64_tr_b16 v[96:97], v188 offset:8192
    v_mfma_f32_16x16x32_bf16 v[36:39], v[112:115], v[148:151], v[36:39]
    s_waitcnt lgkmcnt(14)
    ds_read_b64_tr_b16 v[98:99], v188 offset:9216
    v_mfma_f32_16x16x32_bf16 v[40:43], v[116:119], v[144:147], v[40:43]
    s_waitcnt lgkmcnt(14)
    ds_read_b64_tr_b16 v[100:101], v189 offset:8192
    v_mfma_f32_16x16x32_bf16 v[44:47], v[116:119], v[148:151], v[44:47]
    s_waitcnt lgkmcnt(14)
    ds_read_b64_tr_b16 v[102:103], v189 offset:9216
    v_mfma_f32_16x16x32_bf16 v[48:51], v[120:123], v[144:147], v[48:51]
    s_waitcnt lgkmcnt(14)
    ds_read_b64_tr_b16 v[104:105], v190 offset:8192
    v_mfma_f32_16x16x32_bf16 v[52:55], v[120:123], v[148:151], v[52:55]
    s_waitcnt lgkmcnt(14)
    ds_read_b64_tr_b16 v[106:107], v190 offset:9216
    v_mfma_f32_16x16x32_bf16 v[56:59], v[124:127], v[144:147], v[56:59]
    s_waitcnt lgkmcnt(14)
    ds_read_b64_tr_b16 v[108:109], v191 offset:8192
    v_mfma_f32_16x16x32_bf16 v[60:63], v[124:127], v[148:151], v[60:63]
    s_waitcnt lgkmcnt(14)
    ds_read_b64_tr_b16 v[110:111], v191 offset:9216
    s_waitcnt lgkmcnt(14)
    v_mfma_f32_16x16x32_bf16 v[0:3], v[128:131], v[152:155], v[0:3]
    s_waitcnt lgkmcnt(0)
    s_barrier
    ds_read_b128 v[144:147], v160 offset:0
    v_mfma_f32_16x16x32_bf16 v[4:7], v[128:131], v[156:159], v[4:7]
    ds_read_b128 v[148:151], v160 offset:2048
    v_mfma_f32_16x16x32_bf16 v[8:11], v[132:135], v[152:155], v[8:11]
    ds_read_b64_tr_b16 v[112:113], v176 offset:0
    v_mfma_f32_16x16x32_bf16 v[12:15], v[132:135], v[156:159], v[12:15]
    ds_read_b64_tr_b16 v[114:115], v176 offset:1024
    ds_read_b64_tr_b16 v[116:117], v177 offset:0
    v_mfma_f32_16x16x32_bf16 v[16:19], v[136:139], v[152:155], v[16:19]
    ds_read_b64_tr_b16 v[118:119], v177 offset:1024
    v_mfma_f32_16x16x32_bf16 v[20:23], v[136:139], v[156:159], v[20:23]
    ds_read_b64_tr_b16 v[120:121], v178 offset:0
    v_mfma_f32_16x16x32_bf16 v[24:27], v[140:143], v[152:155], v[24:27]
    ds_read_b64_tr_b16 v[122:123], v178 offset:1024
    v_mfma_f32_16x16x32_bf16 v[28:31], v[140:143], v[156:159], v[28:31]
    ds_read_b64_tr_b16 v[124:125], v179 offset:0
    ds_read_b64_tr_b16 v[126:127], v179 offset:1024
    v_mfma_f32_16x16x32_bf16 v[32:35], v[96:99], v[152:155], v[32:35]
    ds_read_b64_tr_b16 v[128:129], v180 offset:0
    v_mfma_f32_16x16x32_bf16 v[36:39], v[96:99], v[156:159], v[36:39]
    ds_read_b64_tr_b16 v[130:131], v180 offset:1024
    v_mfma_f32_16x16x32_bf16 v[40:43], v[100:103], v[152:155], v[40:43]
    ds_read_b64_tr_b16 v[132:133], v181 offset:0
    v_mfma_f32_16x16x32_bf16 v[44:47], v[100:103], v[156:159], v[44:47]
    ds_read_b64_tr_b16 v[134:135], v181 offset:1024
    v_mfma_f32_16x16x32_bf16 v[48:51], v[104:107], v[152:155], v[48:51]
    ds_read_b64_tr_b16 v[136:137], v182 offset:0
    v_mfma_f32_16x16x32_bf16 v[52:55], v[104:107], v[156:159], v[52:55]
    s_waitcnt lgkmcnt(14)
    ds_read_b64_tr_b16 v[138:139], v182 offset:1024
    v_mfma_f32_16x16x32_bf16 v[56:59], v[108:111], v[152:155], v[56:59]
    s_waitcnt lgkmcnt(14)
    ds_read_b64_tr_b16 v[140:141], v183 offset:0
    v_mfma_f32_16x16x32_bf16 v[60:63], v[108:111], v[156:159], v[60:63]
    s_waitcnt lgkmcnt(14)
    ds_read_b64_tr_b16 v[142:143], v183 offset:1024
    s_waitcnt lgkmcnt(14)
    v_mfma_f32_16x16x32_bf16 v[0:3], v[112:115], v[144:147], v[0:3]
    ds_read_b128 v[152:155], v161 offset:0
    v_mfma_f32_16x16x32_bf16 v[4:7], v[112:115], v[148:151], v[4:7]
    s_waitcnt lgkmcnt(14)
    ds_read_b128 v[156:159], v161 offset:2048
    s_waitcnt lgkmcnt(14)
    v_mfma_f32_16x16x32_bf16 v[8:11], v[116:119], v[144:147], v[8:11]
    ds_read_b64_tr_b16 v[96:97], v176 offset:8192
    v_mfma_f32_16x16x32_bf16 v[12:15], v[116:119], v[148:151], v[12:15]
    s_waitcnt lgkmcnt(14)
    ds_read_b64_tr_b16 v[98:99], v176 offset:9216
    s_waitcnt lgkmcnt(14)
    ds_read_b64_tr_b16 v[100:101], v177 offset:8192
    v_mfma_f32_16x16x32_bf16 v[16:19], v[120:123], v[144:147], v[16:19]
    s_waitcnt lgkmcnt(14)
    ds_read_b64_tr_b16 v[102:103], v177 offset:9216
    v_mfma_f32_16x16x32_bf16 v[20:23], v[120:123], v[148:151], v[20:23]
    s_waitcnt lgkmcnt(14)
    ds_read_b64_tr_b16 v[104:105], v178 offset:8192
    v_mfma_f32_16x16x32_bf16 v[24:27], v[124:127], v[144:147], v[24:27]
    s_waitcnt lgkmcnt(14)
    ds_read_b64_tr_b16 v[106:107], v178 offset:9216
    v_mfma_f32_16x16x32_bf16 v[28:31], v[124:127], v[148:151], v[28:31]
    s_waitcnt lgkmcnt(14)
    ds_read_b64_tr_b16 v[108:109], v179 offset:8192
    s_waitcnt lgkmcnt(14)
    ds_read_b64_tr_b16 v[110:111], v179 offset:9216
    v_mfma_f32_16x16x32_bf16 v[32:35], v[128:131], v[144:147], v[32:35]
    s_waitcnt lgkmcnt(14)
    ds_read_b64_tr_b16 v[112:113], v180 offset:8192
    v_mfma_f32_16x16x32_bf16 v[36:39], v[128:131], v[148:151], v[36:39]
    s_waitcnt lgkmcnt(14)
    ds_read_b64_tr_b16 v[114:115], v180 offset:9216
    v_mfma_f32_16x16x32_bf16 v[40:43], v[132:135], v[144:147], v[40:43]
    s_waitcnt lgkmcnt(14)
    ds_read_b64_tr_b16 v[116:117], v181 offset:8192
    v_mfma_f32_16x16x32_bf16 v[44:47], v[132:135], v[148:151], v[44:47]
    s_waitcnt lgkmcnt(14)
    ds_read_b64_tr_b16 v[118:119], v181 offset:9216
    v_mfma_f32_16x16x32_bf16 v[48:51], v[136:139], v[144:147], v[48:51]
    s_waitcnt lgkmcnt(14)
    ds_read_b64_tr_b16 v[120:121], v182 offset:8192
    v_mfma_f32_16x16x32_bf16 v[52:55], v[136:139], v[148:151], v[52:55]
    s_waitcnt lgkmcnt(14)
    ds_read_b64_tr_b16 v[122:123], v182 offset:9216
    v_mfma_f32_16x16x32_bf16 v[56:59], v[140:143], v[144:147], v[56:59]
    s_waitcnt lgkmcnt(14)
    ds_read_b64_tr_b16 v[124:125], v183 offset:8192
    v_mfma_f32_16x16x32_bf16 v[60:63], v[140:143], v[148:151], v[60:63]
    s_waitcnt lgkmcnt(14)
    ds_read_b64_tr_b16 v[126:127], v183 offset:9216
    s_waitcnt lgkmcnt(14)
    v_mfma_f32_16x16x32_bf16 v[0:3], v[96:99], v[152:155], v[0:3]
    s_waitcnt lgkmcnt(0)
    s_barrier
    ds_read_b128 v[144:147], v160 offset:32768
    v_mfma_f32_16x16x32_bf16 v[4:7], v[96:99], v[156:159], v[4:7]
    ds_read_b128 v[148:151], v160 offset:34816
    v_mfma_f32_16x16x32_bf16 v[8:11], v[100:103], v[152:155], v[8:11]
    ds_read_b64_tr_b16 v[128:129], v176 offset:32768
    v_mfma_f32_16x16x32_bf16 v[12:15], v[100:103], v[156:159], v[12:15]
    ds_read_b64_tr_b16 v[130:131], v176 offset:33792
    ds_read_b64_tr_b16 v[132:133], v177 offset:32768
    v_mfma_f32_16x16x32_bf16 v[16:19], v[104:107], v[152:155], v[16:19]
    ds_read_b64_tr_b16 v[134:135], v177 offset:33792
    v_mfma_f32_16x16x32_bf16 v[20:23], v[104:107], v[156:159], v[20:23]
    ds_read_b64_tr_b16 v[136:137], v178 offset:32768
    v_mfma_f32_16x16x32_bf16 v[24:27], v[108:111], v[152:155], v[24:27]
    ds_read_b64_tr_b16 v[138:139], v178 offset:33792
    v_mfma_f32_16x16x32_bf16 v[28:31], v[108:111], v[156:159], v[28:31]
    ds_read_b64_tr_b16 v[140:141], v179 offset:32768
    ds_read_b64_tr_b16 v[142:143], v179 offset:33792
    v_mfma_f32_16x16x32_bf16 v[32:35], v[112:115], v[152:155], v[32:35]
    ds_read_b64_tr_b16 v[96:97], v180 offset:32768
    v_mfma_f32_16x16x32_bf16 v[36:39], v[112:115], v[156:159], v[36:39]
    ds_read_b64_tr_b16 v[98:99], v180 offset:33792
    v_mfma_f32_16x16x32_bf16 v[40:43], v[116:119], v[152:155], v[40:43]
    ds_read_b64_tr_b16 v[100:101], v181 offset:32768
    v_mfma_f32_16x16x32_bf16 v[44:47], v[116:119], v[156:159], v[44:47]
    ds_read_b64_tr_b16 v[102:103], v181 offset:33792
    v_mfma_f32_16x16x32_bf16 v[48:51], v[120:123], v[152:155], v[48:51]
    ds_read_b64_tr_b16 v[104:105], v182 offset:32768
    v_mfma_f32_16x16x32_bf16 v[52:55], v[120:123], v[156:159], v[52:55]
    s_waitcnt lgkmcnt(14)
    ds_read_b64_tr_b16 v[106:107], v182 offset:33792
    v_mfma_f32_16x16x32_bf16 v[56:59], v[124:127], v[152:155], v[56:59]
    s_waitcnt lgkmcnt(14)
    ds_read_b64_tr_b16 v[108:109], v183 offset:32768
    v_mfma_f32_16x16x32_bf16 v[60:63], v[124:127], v[156:159], v[60:63]
    s_waitcnt lgkmcnt(14)
    ds_read_b64_tr_b16 v[110:111], v183 offset:33792
    s_waitcnt lgkmcnt(14)
    v_mfma_f32_16x16x32_bf16 v[0:3], v[128:131], v[144:147], v[0:3]
    ds_read_b128 v[152:155], v161 offset:32768
    v_mfma_f32_16x16x32_bf16 v[4:7], v[128:131], v[148:151], v[4:7]
    s_waitcnt lgkmcnt(14)
    ds_read_b128 v[156:159], v161 offset:34816
    s_waitcnt lgkmcnt(14)
    v_mfma_f32_16x16x32_bf16 v[8:11], v[132:135], v[144:147], v[8:11]
    ds_read_b64_tr_b16 v[112:113], v176 offset:40960
    v_mfma_f32_16x16x32_bf16 v[12:15], v[132:135], v[148:151], v[12:15]
    s_waitcnt lgkmcnt(14)
    ds_read_b64_tr_b16 v[114:115], v176 offset:41984
    s_waitcnt lgkmcnt(14)
    ds_read_b64_tr_b16 v[116:117], v177 offset:40960
    v_mfma_f32_16x16x32_bf16 v[16:19], v[136:139], v[144:147], v[16:19]
    s_waitcnt lgkmcnt(14)
    ds_read_b64_tr_b16 v[118:119], v177 offset:41984
    v_mfma_f32_16x16x32_bf16 v[20:23], v[136:139], v[148:151], v[20:23]
    s_waitcnt lgkmcnt(14)
    ds_read_b64_tr_b16 v[120:121], v178 offset:40960
    v_mfma_f32_16x16x32_bf16 v[24:27], v[140:143], v[144:147], v[24:27]
    s_waitcnt lgkmcnt(14)
    ds_read_b64_tr_b16 v[122:123], v178 offset:41984
    v_mfma_f32_16x16x32_bf16 v[28:31], v[140:143], v[148:151], v[28:31]
    s_waitcnt lgkmcnt(14)
    ds_read_b64_tr_b16 v[124:125], v179 offset:40960
    s_waitcnt lgkmcnt(14)
    ds_read_b64_tr_b16 v[126:127], v179 offset:41984
    v_mfma_f32_16x16x32_bf16 v[32:35], v[96:99], v[144:147], v[32:35]
    s_waitcnt lgkmcnt(14)
    ds_read_b64_tr_b16 v[128:129], v180 offset:40960
    v_mfma_f32_16x16x32_bf16 v[36:39], v[96:99], v[148:151], v[36:39]
    s_waitcnt lgkmcnt(14)
    ds_read_b64_tr_b16 v[130:131], v180 offset:41984
    v_mfma_f32_16x16x32_bf16 v[40:43], v[100:103], v[144:147], v[40:43]
    s_waitcnt lgkmcnt(14)
    ds_read_b64_tr_b16 v[132:133], v181 offset:40960
    v_mfma_f32_16x16x32_bf16 v[44:47], v[100:103], v[148:151], v[44:47]
    s_waitcnt lgkmcnt(14)
    ds_read_b64_tr_b16 v[134:135], v181 offset:41984
    v_mfma_f32_16x16x32_bf16 v[48:51], v[104:107], v[144:147], v[48:51]
    s_waitcnt lgkmcnt(14)
    ds_read_b64_tr_b16 v[136:137], v182 offset:40960
    v_mfma_f32_16x16x32_bf16 v[52:55], v[104:107], v[148:151], v[52:55]
    s_waitcnt lgkmcnt(14)
    ds_read_b64_tr_b16 v[138:139], v182 offset:41984
    v_mfma_f32_16x16x32_bf16 v[56:59], v[108:111], v[144:147], v[56:59]
    s_waitcnt lgkmcnt(14)
    ds_read_b64_tr_b16 v[140:141], v183 offset:40960
    v_mfma_f32_16x16x32_bf16 v[60:63], v[108:111], v[148:151], v[60:63]
    s_waitcnt lgkmcnt(14)
    ds_read_b64_tr_b16 v[142:143], v183 offset:41984
    s_waitcnt lgkmcnt(14)
    v_mfma_f32_16x16x32_bf16 v[0:3], v[112:115], v[152:155], v[0:3]
    s_waitcnt lgkmcnt(0)
    s_barrier
    ds_read_b128 v[144:147], v162 offset:0
    v_mfma_f32_16x16x32_bf16 v[4:7], v[112:115], v[156:159], v[4:7]
    ds_read_b128 v[148:151], v162 offset:2048
    v_mfma_f32_16x16x32_bf16 v[8:11], v[116:119], v[152:155], v[8:11]
    ds_read_b64_tr_b16 v[96:97], v184 offset:0
    v_mfma_f32_16x16x32_bf16 v[12:15], v[116:119], v[156:159], v[12:15]
    ds_read_b64_tr_b16 v[98:99], v184 offset:1024
    ds_read_b64_tr_b16 v[100:101], v185 offset:0
    v_mfma_f32_16x16x32_bf16 v[16:19], v[120:123], v[152:155], v[16:19]
    ds_read_b64_tr_b16 v[102:103], v185 offset:1024
    v_mfma_f32_16x16x32_bf16 v[20:23], v[120:123], v[156:159], v[20:23]
    ds_read_b64_tr_b16 v[104:105], v186 offset:0
    v_mfma_f32_16x16x32_bf16 v[24:27], v[124:127], v[152:155], v[24:27]
    ds_read_b64_tr_b16 v[106:107], v186 offset:1024
    v_mfma_f32_16x16x32_bf16 v[28:31], v[124:127], v[156:159], v[28:31]
    ds_read_b64_tr_b16 v[108:109], v187 offset:0
    ds_read_b64_tr_b16 v[110:111], v187 offset:1024
    v_mfma_f32_16x16x32_bf16 v[32:35], v[128:131], v[152:155], v[32:35]
    ds_read_b64_tr_b16 v[112:113], v188 offset:0
    v_mfma_f32_16x16x32_bf16 v[36:39], v[128:131], v[156:159], v[36:39]
    ds_read_b64_tr_b16 v[114:115], v188 offset:1024
    v_mfma_f32_16x16x32_bf16 v[40:43], v[132:135], v[152:155], v[40:43]
    ds_read_b64_tr_b16 v[116:117], v189 offset:0
    v_mfma_f32_16x16x32_bf16 v[44:47], v[132:135], v[156:159], v[44:47]
    ds_read_b64_tr_b16 v[118:119], v189 offset:1024
    v_mfma_f32_16x16x32_bf16 v[48:51], v[136:139], v[152:155], v[48:51]
    ds_read_b64_tr_b16 v[120:121], v190 offset:0
    v_mfma_f32_16x16x32_bf16 v[52:55], v[136:139], v[156:159], v[52:55]
    s_waitcnt lgkmcnt(14)
    ds_read_b64_tr_b16 v[122:123], v190 offset:1024
    v_mfma_f32_16x16x32_bf16 v[56:59], v[140:143], v[152:155], v[56:59]
    s_waitcnt lgkmcnt(14)
    ds_read_b64_tr_b16 v[124:125], v191 offset:0
    v_mfma_f32_16x16x32_bf16 v[60:63], v[140:143], v[156:159], v[60:63]
    s_waitcnt lgkmcnt(14)
    ds_read_b64_tr_b16 v[126:127], v191 offset:1024
    s_waitcnt lgkmcnt(14)
    v_mfma_f32_16x16x32_bf16 v[0:3], v[96:99], v[144:147], v[0:3]
    ds_read_b128 v[152:155], v163 offset:0
    v_mfma_f32_16x16x32_bf16 v[4:7], v[96:99], v[148:151], v[4:7]
    s_waitcnt lgkmcnt(14)
    ds_read_b128 v[156:159], v163 offset:2048
    s_waitcnt lgkmcnt(14)
    v_mfma_f32_16x16x32_bf16 v[8:11], v[100:103], v[144:147], v[8:11]
    ds_read_b64_tr_b16 v[128:129], v184 offset:8192
    v_mfma_f32_16x16x32_bf16 v[12:15], v[100:103], v[148:151], v[12:15]
    s_waitcnt lgkmcnt(14)
    ds_read_b64_tr_b16 v[130:131], v184 offset:9216
    s_waitcnt lgkmcnt(14)
    ds_read_b64_tr_b16 v[132:133], v185 offset:8192
    v_mfma_f32_16x16x32_bf16 v[16:19], v[104:107], v[144:147], v[16:19]
    s_waitcnt lgkmcnt(14)
    ds_read_b64_tr_b16 v[134:135], v185 offset:9216
    v_mfma_f32_16x16x32_bf16 v[20:23], v[104:107], v[148:151], v[20:23]
    s_waitcnt lgkmcnt(14)
    ds_read_b64_tr_b16 v[136:137], v186 offset:8192
    v_mfma_f32_16x16x32_bf16 v[24:27], v[108:111], v[144:147], v[24:27]
    s_waitcnt lgkmcnt(14)
    ds_read_b64_tr_b16 v[138:139], v186 offset:9216
    v_mfma_f32_16x16x32_bf16 v[28:31], v[108:111], v[148:151], v[28:31]
    s_waitcnt lgkmcnt(14)
    ds_read_b64_tr_b16 v[140:141], v187 offset:8192
    s_waitcnt lgkmcnt(14)
    ds_read_b64_tr_b16 v[142:143], v187 offset:9216
    v_mfma_f32_16x16x32_bf16 v[32:35], v[112:115], v[144:147], v[32:35]
    s_waitcnt lgkmcnt(14)
    ds_read_b64_tr_b16 v[96:97], v188 offset:8192
    v_mfma_f32_16x16x32_bf16 v[36:39], v[112:115], v[148:151], v[36:39]
    s_waitcnt lgkmcnt(14)
    ds_read_b64_tr_b16 v[98:99], v188 offset:9216
    v_mfma_f32_16x16x32_bf16 v[40:43], v[116:119], v[144:147], v[40:43]
    s_waitcnt lgkmcnt(14)
    ds_read_b64_tr_b16 v[100:101], v189 offset:8192
    v_mfma_f32_16x16x32_bf16 v[44:47], v[116:119], v[148:151], v[44:47]
    s_waitcnt lgkmcnt(14)
    ds_read_b64_tr_b16 v[102:103], v189 offset:9216
    v_mfma_f32_16x16x32_bf16 v[48:51], v[120:123], v[144:147], v[48:51]
    s_waitcnt lgkmcnt(14)
    ds_read_b64_tr_b16 v[104:105], v190 offset:8192
    v_mfma_f32_16x16x32_bf16 v[52:55], v[120:123], v[148:151], v[52:55]
    s_waitcnt lgkmcnt(14)
    ds_read_b64_tr_b16 v[106:107], v190 offset:9216
    v_mfma_f32_16x16x32_bf16 v[56:59], v[124:127], v[144:147], v[56:59]
    s_waitcnt lgkmcnt(14)
    ds_read_b64_tr_b16 v[108:109], v191 offset:8192
    v_mfma_f32_16x16x32_bf16 v[60:63], v[124:127], v[148:151], v[60:63]
    s_waitcnt lgkmcnt(14)
    ds_read_b64_tr_b16 v[110:111], v191 offset:9216
    s_waitcnt lgkmcnt(14)
    v_mfma_f32_16x16x32_bf16 v[0:3], v[128:131], v[152:155], v[0:3]
    s_waitcnt lgkmcnt(0)
    s_barrier
    ds_read_b128 v[144:147], v160 offset:0
    v_mfma_f32_16x16x32_bf16 v[4:7], v[128:131], v[156:159], v[4:7]
    ds_read_b128 v[148:151], v160 offset:2048
    v_mfma_f32_16x16x32_bf16 v[8:11], v[132:135], v[152:155], v[8:11]
    ds_read_b64_tr_b16 v[112:113], v176 offset:0
    v_mfma_f32_16x16x32_bf16 v[12:15], v[132:135], v[156:159], v[12:15]
    ds_read_b64_tr_b16 v[114:115], v176 offset:1024
    ds_read_b64_tr_b16 v[116:117], v177 offset:0
    v_mfma_f32_16x16x32_bf16 v[16:19], v[136:139], v[152:155], v[16:19]
    ds_read_b64_tr_b16 v[118:119], v177 offset:1024
    v_mfma_f32_16x16x32_bf16 v[20:23], v[136:139], v[156:159], v[20:23]
    ds_read_b64_tr_b16 v[120:121], v178 offset:0
    v_mfma_f32_16x16x32_bf16 v[24:27], v[140:143], v[152:155], v[24:27]
    ds_read_b64_tr_b16 v[122:123], v178 offset:1024
    v_mfma_f32_16x16x32_bf16 v[28:31], v[140:143], v[156:159], v[28:31]
    ds_read_b64_tr_b16 v[124:125], v179 offset:0
    ds_read_b64_tr_b16 v[126:127], v179 offset:1024
    v_mfma_f32_16x16x32_bf16 v[32:35], v[96:99], v[152:155], v[32:35]
    ds_read_b64_tr_b16 v[128:129], v180 offset:0
    v_mfma_f32_16x16x32_bf16 v[36:39], v[96:99], v[156:159], v[36:39]
    ds_read_b64_tr_b16 v[130:131], v180 offset:1024
    v_mfma_f32_16x16x32_bf16 v[40:43], v[100:103], v[152:155], v[40:43]
    ds_read_b64_tr_b16 v[132:133], v181 offset:0
    v_mfma_f32_16x16x32_bf16 v[44:47], v[100:103], v[156:159], v[44:47]
    ds_read_b64_tr_b16 v[134:135], v181 offset:1024
    v_mfma_f32_16x16x32_bf16 v[48:51], v[104:107], v[152:155], v[48:51]
    ds_read_b64_tr_b16 v[136:137], v182 offset:0
    v_mfma_f32_16x16x32_bf16 v[52:55], v[104:107], v[156:159], v[52:55]
    s_waitcnt lgkmcnt(14)
    ds_read_b64_tr_b16 v[138:139], v182 offset:1024
    v_mfma_f32_16x16x32_bf16 v[56:59], v[108:111], v[152:155], v[56:59]
    s_waitcnt lgkmcnt(14)
    ds_read_b64_tr_b16 v[140:141], v183 offset:0
    v_mfma_f32_16x16x32_bf16 v[60:63], v[108:111], v[156:159], v[60:63]
    s_waitcnt lgkmcnt(14)
    ds_read_b64_tr_b16 v[142:143], v183 offset:1024
    s_waitcnt lgkmcnt(14)
    v_mfma_f32_16x16x32_bf16 v[0:3], v[112:115], v[144:147], v[0:3]
    ds_read_b128 v[152:155], v161 offset:0
    v_mfma_f32_16x16x32_bf16 v[4:7], v[112:115], v[148:151], v[4:7]
    s_waitcnt lgkmcnt(14)
    ds_read_b128 v[156:159], v161 offset:2048
    s_waitcnt lgkmcnt(14)
    v_mfma_f32_16x16x32_bf16 v[8:11], v[116:119], v[144:147], v[8:11]
    ds_read_b64_tr_b16 v[96:97], v176 offset:8192
    v_mfma_f32_16x16x32_bf16 v[12:15], v[116:119], v[148:151], v[12:15]
    s_waitcnt lgkmcnt(14)
    ds_read_b64_tr_b16 v[98:99], v176 offset:9216
    s_waitcnt lgkmcnt(14)
    ds_read_b64_tr_b16 v[100:101], v177 offset:8192
    v_mfma_f32_16x16x32_bf16 v[16:19], v[120:123], v[144:147], v[16:19]
    s_waitcnt lgkmcnt(14)
    ds_read_b64_tr_b16 v[102:103], v177 offset:9216
    v_mfma_f32_16x16x32_bf16 v[20:23], v[120:123], v[148:151], v[20:23]
    s_waitcnt lgkmcnt(14)
    ds_read_b64_tr_b16 v[104:105], v178 offset:8192
    v_mfma_f32_16x16x32_bf16 v[24:27], v[124:127], v[144:147], v[24:27]
    s_waitcnt lgkmcnt(14)
    ds_read_b64_tr_b16 v[106:107], v178 offset:9216
    v_mfma_f32_16x16x32_bf16 v[28:31], v[124:127], v[148:151], v[28:31]
    s_waitcnt lgkmcnt(14)
    ds_read_b64_tr_b16 v[108:109], v179 offset:8192
    s_waitcnt lgkmcnt(14)
    ds_read_b64_tr_b16 v[110:111], v179 offset:9216
    v_mfma_f32_16x16x32_bf16 v[32:35], v[128:131], v[144:147], v[32:35]
    s_waitcnt lgkmcnt(14)
    ds_read_b64_tr_b16 v[112:113], v180 offset:8192
    v_mfma_f32_16x16x32_bf16 v[36:39], v[128:131], v[148:151], v[36:39]
    s_waitcnt lgkmcnt(14)
    ds_read_b64_tr_b16 v[114:115], v180 offset:9216
    v_mfma_f32_16x16x32_bf16 v[40:43], v[132:135], v[144:147], v[40:43]
    s_waitcnt lgkmcnt(14)
    ds_read_b64_tr_b16 v[116:117], v181 offset:8192
    v_mfma_f32_16x16x32_bf16 v[44:47], v[132:135], v[148:151], v[44:47]
    s_waitcnt lgkmcnt(14)
    ds_read_b64_tr_b16 v[118:119], v181 offset:9216
    v_mfma_f32_16x16x32_bf16 v[48:51], v[136:139], v[144:147], v[48:51]
    s_waitcnt lgkmcnt(14)
    ds_read_b64_tr_b16 v[120:121], v182 offset:8192
    v_mfma_f32_16x16x32_bf16 v[52:55], v[136:139], v[148:151], v[52:55]
    s_waitcnt lgkmcnt(14)
    ds_read_b64_tr_b16 v[122:123], v182 offset:9216
    v_mfma_f32_16x16x32_bf16 v[56:59], v[140:143], v[144:147], v[56:59]
    s_waitcnt lgkmcnt(14)
    ds_read_b64_tr_b16 v[124:125], v183 offset:8192
    v_mfma_f32_16x16x32_bf16 v[60:63], v[140:143], v[148:151], v[60:63]
    s_waitcnt lgkmcnt(14)
    ds_read_b64_tr_b16 v[126:127], v183 offset:9216
    s_waitcnt lgkmcnt(14)
    v_mfma_f32_16x16x32_bf16 v[0:3], v[96:99], v[152:155], v[0:3]
    s_waitcnt lgkmcnt(0)
    s_barrier
    ds_read_b128 v[144:147], v160 offset:32768
    v_mfma_f32_16x16x32_bf16 v[4:7], v[96:99], v[156:159], v[4:7]
    ds_read_b128 v[148:151], v160 offset:34816
    v_mfma_f32_16x16x32_bf16 v[8:11], v[100:103], v[152:155], v[8:11]
    ds_read_b64_tr_b16 v[128:129], v176 offset:32768
    v_mfma_f32_16x16x32_bf16 v[12:15], v[100:103], v[156:159], v[12:15]
    ds_read_b64_tr_b16 v[130:131], v176 offset:33792
    ds_read_b64_tr_b16 v[132:133], v177 offset:32768
    v_mfma_f32_16x16x32_bf16 v[16:19], v[104:107], v[152:155], v[16:19]
    ds_read_b64_tr_b16 v[134:135], v177 offset:33792
    v_mfma_f32_16x16x32_bf16 v[20:23], v[104:107], v[156:159], v[20:23]
    ds_read_b64_tr_b16 v[136:137], v178 offset:32768
    v_mfma_f32_16x16x32_bf16 v[24:27], v[108:111], v[152:155], v[24:27]
    ds_read_b64_tr_b16 v[138:139], v178 offset:33792
    v_mfma_f32_16x16x32_bf16 v[28:31], v[108:111], v[156:159], v[28:31]
    ds_read_b64_tr_b16 v[140:141], v179 offset:32768
    ds_read_b64_tr_b16 v[142:143], v179 offset:33792
    v_mfma_f32_16x16x32_bf16 v[32:35], v[112:115], v[152:155], v[32:35]
    ds_read_b64_tr_b16 v[96:97], v180 offset:32768
    v_mfma_f32_16x16x32_bf16 v[36:39], v[112:115], v[156:159], v[36:39]
    ds_read_b64_tr_b16 v[98:99], v180 offset:33792
    v_mfma_f32_16x16x32_bf16 v[40:43], v[116:119], v[152:155], v[40:43]
    ds_read_b64_tr_b16 v[100:101], v181 offset:32768
    v_mfma_f32_16x16x32_bf16 v[44:47], v[116:119], v[156:159], v[44:47]
    ds_read_b64_tr_b16 v[102:103], v181 offset:33792
    v_mfma_f32_16x16x32_bf16 v[48:51], v[120:123], v[152:155], v[48:51]
    ds_read_b64_tr_b16 v[104:105], v182 offset:32768
    v_mfma_f32_16x16x32_bf16 v[52:55], v[120:123], v[156:159], v[52:55]
    s_waitcnt lgkmcnt(14)
    ds_read_b64_tr_b16 v[106:107], v182 offset:33792
    v_mfma_f32_16x16x32_bf16 v[56:59], v[124:127], v[152:155], v[56:59]
    s_waitcnt lgkmcnt(14)
    ds_read_b64_tr_b16 v[108:109], v183 offset:32768
    v_mfma_f32_16x16x32_bf16 v[60:63], v[124:127], v[156:159], v[60:63]
    s_waitcnt lgkmcnt(14)
    ds_read_b64_tr_b16 v[110:111], v183 offset:33792
    s_waitcnt lgkmcnt(14)
    v_mfma_f32_16x16x32_bf16 v[0:3], v[128:131], v[144:147], v[0:3]
    ds_read_b128 v[152:155], v161 offset:32768
    v_mfma_f32_16x16x32_bf16 v[4:7], v[128:131], v[148:151], v[4:7]
    s_waitcnt lgkmcnt(14)
    ds_read_b128 v[156:159], v161 offset:34816
    s_waitcnt lgkmcnt(14)
    v_mfma_f32_16x16x32_bf16 v[8:11], v[132:135], v[144:147], v[8:11]
    ds_read_b64_tr_b16 v[112:113], v176 offset:40960
    v_mfma_f32_16x16x32_bf16 v[12:15], v[132:135], v[148:151], v[12:15]
    s_waitcnt lgkmcnt(14)
    ds_read_b64_tr_b16 v[114:115], v176 offset:41984
    s_waitcnt lgkmcnt(14)
    ds_read_b64_tr_b16 v[116:117], v177 offset:40960
    v_mfma_f32_16x16x32_bf16 v[16:19], v[136:139], v[144:147], v[16:19]
    s_waitcnt lgkmcnt(14)
    ds_read_b64_tr_b16 v[118:119], v177 offset:41984
    v_mfma_f32_16x16x32_bf16 v[20:23], v[136:139], v[148:151], v[20:23]
    s_waitcnt lgkmcnt(14)
    ds_read_b64_tr_b16 v[120:121], v178 offset:40960
    v_mfma_f32_16x16x32_bf16 v[24:27], v[140:143], v[144:147], v[24:27]
    s_waitcnt lgkmcnt(14)
    ds_read_b64_tr_b16 v[122:123], v178 offset:41984
    v_mfma_f32_16x16x32_bf16 v[28:31], v[140:143], v[148:151], v[28:31]
    s_waitcnt lgkmcnt(14)
    ds_read_b64_tr_b16 v[124:125], v179 offset:40960
    s_waitcnt lgkmcnt(14)
    ds_read_b64_tr_b16 v[126:127], v179 offset:41984
    v_mfma_f32_16x16x32_bf16 v[32:35], v[96:99], v[144:147], v[32:35]
    s_waitcnt lgkmcnt(14)
    ds_read_b64_tr_b16 v[128:129], v180 offset:40960
    v_mfma_f32_16x16x32_bf16 v[36:39], v[96:99], v[148:151], v[36:39]
    s_waitcnt lgkmcnt(14)
    ds_read_b64_tr_b16 v[130:131], v180 offset:41984
    v_mfma_f32_16x16x32_bf16 v[40:43], v[100:103], v[144:147], v[40:43]
    s_waitcnt lgkmcnt(14)
    ds_read_b64_tr_b16 v[132:133], v181 offset:40960
    v_mfma_f32_16x16x32_bf16 v[44:47], v[100:103], v[148:151], v[44:47]
    s_waitcnt lgkmcnt(14)
    ds_read_b64_tr_b16 v[134:135], v181 offset:41984
    v_mfma_f32_16x16x32_bf16 v[48:51], v[104:107], v[144:147], v[48:51]
    s_waitcnt lgkmcnt(14)
    ds_read_b64_tr_b16 v[136:137], v182 offset:40960
    v_mfma_f32_16x16x32_bf16 v[52:55], v[104:107], v[148:151], v[52:55]
    s_waitcnt lgkmcnt(14)
    ds_read_b64_tr_b16 v[138:139], v182 offset:41984
    v_mfma_f32_16x16x32_bf16 v[56:59], v[108:111], v[144:147], v[56:59]
    s_waitcnt lgkmcnt(14)
    ds_read_b64_tr_b16 v[140:141], v183 offset:40960
    v_mfma_f32_16x16x32_bf16 v[60:63], v[108:111], v[148:151], v[60:63]
    s_waitcnt lgkmcnt(14)
    ds_read_b64_tr_b16 v[142:143], v183 offset:41984
    s_waitcnt lgkmcnt(14)
    v_mfma_f32_16x16x32_bf16 v[0:3], v[112:115], v[152:155], v[0:3]
    s_waitcnt lgkmcnt(0)
    s_barrier
    ds_read_b128 v[144:147], v162 offset:0
    v_mfma_f32_16x16x32_bf16 v[4:7], v[112:115], v[156:159], v[4:7]
    ds_read_b128 v[148:151], v162 offset:2048
    v_mfma_f32_16x16x32_bf16 v[8:11], v[116:119], v[152:155], v[8:11]
    ds_read_b64_tr_b16 v[96:97], v184 offset:0
    v_mfma_f32_16x16x32_bf16 v[12:15], v[116:119], v[156:159], v[12:15]
    ds_read_b64_tr_b16 v[98:99], v184 offset:1024
    ds_read_b64_tr_b16 v[100:101], v185 offset:0
    v_mfma_f32_16x16x32_bf16 v[16:19], v[120:123], v[152:155], v[16:19]
    ds_read_b64_tr_b16 v[102:103], v185 offset:1024
    v_mfma_f32_16x16x32_bf16 v[20:23], v[120:123], v[156:159], v[20:23]
    ds_read_b64_tr_b16 v[104:105], v186 offset:0
    v_mfma_f32_16x16x32_bf16 v[24:27], v[124:127], v[152:155], v[24:27]
    ds_read_b64_tr_b16 v[106:107], v186 offset:1024
    v_mfma_f32_16x16x32_bf16 v[28:31], v[124:127], v[156:159], v[28:31]
    ds_read_b64_tr_b16 v[108:109], v187 offset:0
    ds_read_b64_tr_b16 v[110:111], v187 offset:1024
    v_mfma_f32_16x16x32_bf16 v[32:35], v[128:131], v[152:155], v[32:35]
    ds_read_b64_tr_b16 v[112:113], v188 offset:0
    v_mfma_f32_16x16x32_bf16 v[36:39], v[128:131], v[156:159], v[36:39]
    ds_read_b64_tr_b16 v[114:115], v188 offset:1024
    v_mfma_f32_16x16x32_bf16 v[40:43], v[132:135], v[152:155], v[40:43]
    ds_read_b64_tr_b16 v[116:117], v189 offset:0
    v_mfma_f32_16x16x32_bf16 v[44:47], v[132:135], v[156:159], v[44:47]
    ds_read_b64_tr_b16 v[118:119], v189 offset:1024
    v_mfma_f32_16x16x32_bf16 v[48:51], v[136:139], v[152:155], v[48:51]
    ds_read_b64_tr_b16 v[120:121], v190 offset:0
    v_mfma_f32_16x16x32_bf16 v[52:55], v[136:139], v[156:159], v[52:55]
    s_waitcnt lgkmcnt(14)
    ds_read_b64_tr_b16 v[122:123], v190 offset:1024
    v_mfma_f32_16x16x32_bf16 v[56:59], v[140:143], v[152:155], v[56:59]
    s_waitcnt lgkmcnt(14)
    ds_read_b64_tr_b16 v[124:125], v191 offset:0
    v_mfma_f32_16x16x32_bf16 v[60:63], v[140:143], v[156:159], v[60:63]
    s_waitcnt lgkmcnt(14)
    ds_read_b64_tr_b16 v[126:127], v191 offset:1024
    s_waitcnt lgkmcnt(14)
    v_mfma_f32_16x16x32_bf16 v[0:3], v[96:99], v[144:147], v[0:3]
    ds_read_b128 v[152:155], v163 offset:0
    v_mfma_f32_16x16x32_bf16 v[4:7], v[96:99], v[148:151], v[4:7]
    s_waitcnt lgkmcnt(14)
    ds_read_b128 v[156:159], v163 offset:2048
    s_waitcnt lgkmcnt(14)
    v_mfma_f32_16x16x32_bf16 v[8:11], v[100:103], v[144:147], v[8:11]
    ds_read_b64_tr_b16 v[128:129], v184 offset:8192
    v_mfma_f32_16x16x32_bf16 v[12:15], v[100:103], v[148:151], v[12:15]
    s_waitcnt lgkmcnt(14)
    ds_read_b64_tr_b16 v[130:131], v184 offset:9216
    s_waitcnt lgkmcnt(14)
    ds_read_b64_tr_b16 v[132:133], v185 offset:8192
    v_mfma_f32_16x16x32_bf16 v[16:19], v[104:107], v[144:147], v[16:19]
    s_waitcnt lgkmcnt(14)
    ds_read_b64_tr_b16 v[134:135], v185 offset:9216
    v_mfma_f32_16x16x32_bf16 v[20:23], v[104:107], v[148:151], v[20:23]
    s_waitcnt lgkmcnt(14)
    ds_read_b64_tr_b16 v[136:137], v186 offset:8192
    v_mfma_f32_16x16x32_bf16 v[24:27], v[108:111], v[144:147], v[24:27]
    s_waitcnt lgkmcnt(14)
    ds_read_b64_tr_b16 v[138:139], v186 offset:9216
    v_mfma_f32_16x16x32_bf16 v[28:31], v[108:111], v[148:151], v[28:31]
    s_waitcnt lgkmcnt(14)
    ds_read_b64_tr_b16 v[140:141], v187 offset:8192
    s_waitcnt lgkmcnt(14)
    ds_read_b64_tr_b16 v[142:143], v187 offset:9216
    v_mfma_f32_16x16x32_bf16 v[32:35], v[112:115], v[144:147], v[32:35]
    s_waitcnt lgkmcnt(14)
    ds_read_b64_tr_b16 v[96:97], v188 offset:8192
    v_mfma_f32_16x16x32_bf16 v[36:39], v[112:115], v[148:151], v[36:39]
    s_waitcnt lgkmcnt(14)
    ds_read_b64_tr_b16 v[98:99], v188 offset:9216
    v_mfma_f32_16x16x32_bf16 v[40:43], v[116:119], v[144:147], v[40:43]
    s_waitcnt lgkmcnt(14)
    ds_read_b64_tr_b16 v[100:101], v189 offset:8192
    v_mfma_f32_16x16x32_bf16 v[44:47], v[116:119], v[148:151], v[44:47]
    s_waitcnt lgkmcnt(14)
    ds_read_b64_tr_b16 v[102:103], v189 offset:9216
    v_mfma_f32_16x16x32_bf16 v[48:51], v[120:123], v[144:147], v[48:51]
    s_waitcnt lgkmcnt(14)
    ds_read_b64_tr_b16 v[104:105], v190 offset:8192
    v_mfma_f32_16x16x32_bf16 v[52:55], v[120:123], v[148:151], v[52:55]
    s_waitcnt lgkmcnt(14)
    ds_read_b64_tr_b16 v[106:107], v190 offset:9216
    v_mfma_f32_16x16x32_bf16 v[56:59], v[124:127], v[144:147], v[56:59]
    s_waitcnt lgkmcnt(14)
    ds_read_b64_tr_b16 v[108:109], v191 offset:8192
    v_mfma_f32_16x16x32_bf16 v[60:63], v[124:127], v[148:151], v[60:63]
    s_waitcnt lgkmcnt(14)
    ds_read_b64_tr_b16 v[110:111], v191 offset:9216
    s_waitcnt lgkmcnt(14)
    v_mfma_f32_16x16x32_bf16 v[0:3], v[128:131], v[152:155], v[0:3]
    s_waitcnt lgkmcnt(0)
    s_barrier
    ds_read_b128 v[144:147], v160 offset:0
    v_mfma_f32_16x16x32_bf16 v[4:7], v[128:131], v[156:159], v[4:7]
    ds_read_b128 v[148:151], v160 offset:2048
    v_mfma_f32_16x16x32_bf16 v[8:11], v[132:135], v[152:155], v[8:11]
    ds_read_b64_tr_b16 v[112:113], v176 offset:0
    v_mfma_f32_16x16x32_bf16 v[12:15], v[132:135], v[156:159], v[12:15]
    ds_read_b64_tr_b16 v[114:115], v176 offset:1024
    ds_read_b64_tr_b16 v[116:117], v177 offset:0
    v_mfma_f32_16x16x32_bf16 v[16:19], v[136:139], v[152:155], v[16:19]
    ds_read_b64_tr_b16 v[118:119], v177 offset:1024
    v_mfma_f32_16x16x32_bf16 v[20:23], v[136:139], v[156:159], v[20:23]
    ds_read_b64_tr_b16 v[120:121], v178 offset:0
    v_mfma_f32_16x16x32_bf16 v[24:27], v[140:143], v[152:155], v[24:27]
    ds_read_b64_tr_b16 v[122:123], v178 offset:1024
    v_mfma_f32_16x16x32_bf16 v[28:31], v[140:143], v[156:159], v[28:31]
    ds_read_b64_tr_b16 v[124:125], v179 offset:0
    ds_read_b64_tr_b16 v[126:127], v179 offset:1024
    v_mfma_f32_16x16x32_bf16 v[32:35], v[96:99], v[152:155], v[32:35]
    ds_read_b64_tr_b16 v[128:129], v180 offset:0
    v_mfma_f32_16x16x32_bf16 v[36:39], v[96:99], v[156:159], v[36:39]
    ds_read_b64_tr_b16 v[130:131], v180 offset:1024
    v_mfma_f32_16x16x32_bf16 v[40:43], v[100:103], v[152:155], v[40:43]
    ds_read_b64_tr_b16 v[132:133], v181 offset:0
    v_mfma_f32_16x16x32_bf16 v[44:47], v[100:103], v[156:159], v[44:47]
    ds_read_b64_tr_b16 v[134:135], v181 offset:1024
    v_mfma_f32_16x16x32_bf16 v[48:51], v[104:107], v[152:155], v[48:51]
    ds_read_b64_tr_b16 v[136:137], v182 offset:0
    v_mfma_f32_16x16x32_bf16 v[52:55], v[104:107], v[156:159], v[52:55]
    s_waitcnt lgkmcnt(14)
    ds_read_b64_tr_b16 v[138:139], v182 offset:1024
    v_mfma_f32_16x16x32_bf16 v[56:59], v[108:111], v[152:155], v[56:59]
    s_waitcnt lgkmcnt(14)
    ds_read_b64_tr_b16 v[140:141], v183 offset:0
    v_mfma_f32_16x16x32_bf16 v[60:63], v[108:111], v[156:159], v[60:63]
    s_waitcnt lgkmcnt(14)
    ds_read_b64_tr_b16 v[142:143], v183 offset:1024
    s_waitcnt lgkmcnt(14)
    v_mfma_f32_16x16x32_bf16 v[0:3], v[112:115], v[144:147], v[0:3]
    ds_read_b128 v[152:155], v161 offset:0
    v_mfma_f32_16x16x32_bf16 v[4:7], v[112:115], v[148:151], v[4:7]
    s_waitcnt lgkmcnt(14)
    ds_read_b128 v[156:159], v161 offset:2048
    s_waitcnt lgkmcnt(14)
    v_mfma_f32_16x16x32_bf16 v[8:11], v[116:119], v[144:147], v[8:11]
    ds_read_b64_tr_b16 v[96:97], v176 offset:8192
    v_mfma_f32_16x16x32_bf16 v[12:15], v[116:119], v[148:151], v[12:15]
    s_waitcnt lgkmcnt(14)
    ds_read_b64_tr_b16 v[98:99], v176 offset:9216
    s_waitcnt lgkmcnt(14)
    ds_read_b64_tr_b16 v[100:101], v177 offset:8192
    v_mfma_f32_16x16x32_bf16 v[16:19], v[120:123], v[144:147], v[16:19]
    s_waitcnt lgkmcnt(14)
    ds_read_b64_tr_b16 v[102:103], v177 offset:9216
    v_mfma_f32_16x16x32_bf16 v[20:23], v[120:123], v[148:151], v[20:23]
    s_waitcnt lgkmcnt(14)
    ds_read_b64_tr_b16 v[104:105], v178 offset:8192
    v_mfma_f32_16x16x32_bf16 v[24:27], v[124:127], v[144:147], v[24:27]
    s_waitcnt lgkmcnt(14)
    ds_read_b64_tr_b16 v[106:107], v178 offset:9216
    v_mfma_f32_16x16x32_bf16 v[28:31], v[124:127], v[148:151], v[28:31]
    s_waitcnt lgkmcnt(14)
    ds_read_b64_tr_b16 v[108:109], v179 offset:8192
    s_waitcnt lgkmcnt(14)
    ds_read_b64_tr_b16 v[110:111], v179 offset:9216
    v_mfma_f32_16x16x32_bf16 v[32:35], v[128:131], v[144:147], v[32:35]
    s_waitcnt lgkmcnt(14)
    ds_read_b64_tr_b16 v[112:113], v180 offset:8192
    v_mfma_f32_16x16x32_bf16 v[36:39], v[128:131], v[148:151], v[36:39]
    s_waitcnt lgkmcnt(14)
    ds_read_b64_tr_b16 v[114:115], v180 offset:9216
    v_mfma_f32_16x16x32_bf16 v[40:43], v[132:135], v[144:147], v[40:43]
    s_waitcnt lgkmcnt(14)
    ds_read_b64_tr_b16 v[116:117], v181 offset:8192
    v_mfma_f32_16x16x32_bf16 v[44:47], v[132:135], v[148:151], v[44:47]
    s_waitcnt lgkmcnt(14)
    ds_read_b64_tr_b16 v[118:119], v181 offset:9216
    v_mfma_f32_16x16x32_bf16 v[48:51], v[136:139], v[144:147], v[48:51]
    s_waitcnt lgkmcnt(14)
    ds_read_b64_tr_b16 v[120:121], v182 offset:8192
    v_mfma_f32_16x16x32_bf16 v[52:55], v[136:139], v[148:151], v[52:55]
    s_waitcnt lgkmcnt(14)
    ds_read_b64_tr_b16 v[122:123], v182 offset:9216
    v_mfma_f32_16x16x32_bf16 v[56:59], v[140:143], v[144:147], v[56:59]
    s_waitcnt lgkmcnt(14)
    ds_read_b64_tr_b16 v[124:125], v183 offset:8192
    v_mfma_f32_16x16x32_bf16 v[60:63], v[140:143], v[148:151], v[60:63]
    s_waitcnt lgkmcnt(14)
    ds_read_b64_tr_b16 v[126:127], v183 offset:9216
    s_waitcnt lgkmcnt(14)
    v_mfma_f32_16x16x32_bf16 v[0:3], v[96:99], v[152:155], v[0:3]
    s_waitcnt lgkmcnt(0)
    s_barrier
    ds_read_b128 v[144:147], v160 offset:32768
    v_mfma_f32_16x16x32_bf16 v[4:7], v[96:99], v[156:159], v[4:7]
    ds_read_b128 v[148:151], v160 offset:34816
    v_mfma_f32_16x16x32_bf16 v[8:11], v[100:103], v[152:155], v[8:11]
    ds_read_b64_tr_b16 v[128:129], v176 offset:32768
    v_mfma_f32_16x16x32_bf16 v[12:15], v[100:103], v[156:159], v[12:15]
    ds_read_b64_tr_b16 v[130:131], v176 offset:33792
    ds_read_b64_tr_b16 v[132:133], v177 offset:32768
    v_mfma_f32_16x16x32_bf16 v[16:19], v[104:107], v[152:155], v[16:19]
    ds_read_b64_tr_b16 v[134:135], v177 offset:33792
    v_mfma_f32_16x16x32_bf16 v[20:23], v[104:107], v[156:159], v[20:23]
    ds_read_b64_tr_b16 v[136:137], v178 offset:32768
    v_mfma_f32_16x16x32_bf16 v[24:27], v[108:111], v[152:155], v[24:27]
    ds_read_b64_tr_b16 v[138:139], v178 offset:33792
    v_mfma_f32_16x16x32_bf16 v[28:31], v[108:111], v[156:159], v[28:31]
    ds_read_b64_tr_b16 v[140:141], v179 offset:32768
    ds_read_b64_tr_b16 v[142:143], v179 offset:33792
    v_mfma_f32_16x16x32_bf16 v[32:35], v[112:115], v[152:155], v[32:35]
    ds_read_b64_tr_b16 v[96:97], v180 offset:32768
    v_mfma_f32_16x16x32_bf16 v[36:39], v[112:115], v[156:159], v[36:39]
    ds_read_b64_tr_b16 v[98:99], v180 offset:33792
    v_mfma_f32_16x16x32_bf16 v[40:43], v[116:119], v[152:155], v[40:43]
    ds_read_b64_tr_b16 v[100:101], v181 offset:32768
    v_mfma_f32_16x16x32_bf16 v[44:47], v[116:119], v[156:159], v[44:47]
    ds_read_b64_tr_b16 v[102:103], v181 offset:33792
    v_mfma_f32_16x16x32_bf16 v[48:51], v[120:123], v[152:155], v[48:51]
    ds_read_b64_tr_b16 v[104:105], v182 offset:32768
    v_mfma_f32_16x16x32_bf16 v[52:55], v[120:123], v[156:159], v[52:55]
    s_waitcnt lgkmcnt(14)
    ds_read_b64_tr_b16 v[106:107], v182 offset:33792
    v_mfma_f32_16x16x32_bf16 v[56:59], v[124:127], v[152:155], v[56:59]
    s_waitcnt lgkmcnt(14)
    ds_read_b64_tr_b16 v[108:109], v183 offset:32768
    v_mfma_f32_16x16x32_bf16 v[60:63], v[124:127], v[156:159], v[60:63]
    s_waitcnt lgkmcnt(14)
    ds_read_b64_tr_b16 v[110:111], v183 offset:33792
    s_waitcnt lgkmcnt(14)
    v_mfma_f32_16x16x32_bf16 v[0:3], v[128:131], v[144:147], v[0:3]
    ds_read_b128 v[152:155], v161 offset:32768
    v_mfma_f32_16x16x32_bf16 v[4:7], v[128:131], v[148:151], v[4:7]
    s_waitcnt lgkmcnt(14)
    ds_read_b128 v[156:159], v161 offset:34816
    s_waitcnt lgkmcnt(14)
    v_mfma_f32_16x16x32_bf16 v[8:11], v[132:135], v[144:147], v[8:11]
    ds_read_b64_tr_b16 v[112:113], v176 offset:40960
    v_mfma_f32_16x16x32_bf16 v[12:15], v[132:135], v[148:151], v[12:15]
    s_waitcnt lgkmcnt(14)
    ds_read_b64_tr_b16 v[114:115], v176 offset:41984
    s_waitcnt lgkmcnt(14)
    ds_read_b64_tr_b16 v[116:117], v177 offset:40960
    v_mfma_f32_16x16x32_bf16 v[16:19], v[136:139], v[144:147], v[16:19]
    s_waitcnt lgkmcnt(14)
    ds_read_b64_tr_b16 v[118:119], v177 offset:41984
    v_mfma_f32_16x16x32_bf16 v[20:23], v[136:139], v[148:151], v[20:23]
    s_waitcnt lgkmcnt(14)
    ds_read_b64_tr_b16 v[120:121], v178 offset:40960
    v_mfma_f32_16x16x32_bf16 v[24:27], v[140:143], v[144:147], v[24:27]
    s_waitcnt lgkmcnt(14)
    ds_read_b64_tr_b16 v[122:123], v178 offset:41984
    v_mfma_f32_16x16x32_bf16 v[28:31], v[140:143], v[148:151], v[28:31]
    s_waitcnt lgkmcnt(14)
    ds_read_b64_tr_b16 v[124:125], v179 offset:40960
    s_waitcnt lgkmcnt(14)
    ds_read_b64_tr_b16 v[126:127], v179 offset:41984
    v_mfma_f32_16x16x32_bf16 v[32:35], v[96:99], v[144:147], v[32:35]
    s_waitcnt lgkmcnt(14)
    ds_read_b64_tr_b16 v[128:129], v180 offset:40960
    v_mfma_f32_16x16x32_bf16 v[36:39], v[96:99], v[148:151], v[36:39]
    s_waitcnt lgkmcnt(14)
    ds_read_b64_tr_b16 v[130:131], v180 offset:41984
    v_mfma_f32_16x16x32_bf16 v[40:43], v[100:103], v[144:147], v[40:43]
    s_waitcnt lgkmcnt(14)
    ds_read_b64_tr_b16 v[132:133], v181 offset:40960
    v_mfma_f32_16x16x32_bf16 v[44:47], v[100:103], v[148:151], v[44:47]
    s_waitcnt lgkmcnt(14)
    ds_read_b64_tr_b16 v[134:135], v181 offset:41984
    v_mfma_f32_16x16x32_bf16 v[48:51], v[104:107], v[144:147], v[48:51]
    s_waitcnt lgkmcnt(14)
    ds_read_b64_tr_b16 v[136:137], v182 offset:40960
    v_mfma_f32_16x16x32_bf16 v[52:55], v[104:107], v[148:151], v[52:55]
    s_waitcnt lgkmcnt(14)
    ds_read_b64_tr_b16 v[138:139], v182 offset:41984
    v_mfma_f32_16x16x32_bf16 v[56:59], v[108:111], v[144:147], v[56:59]
    s_waitcnt lgkmcnt(14)
    ds_read_b64_tr_b16 v[140:141], v183 offset:40960
    v_mfma_f32_16x16x32_bf16 v[60:63], v[108:111], v[148:151], v[60:63]
    s_waitcnt lgkmcnt(14)
    ds_read_b64_tr_b16 v[142:143], v183 offset:41984
    s_waitcnt lgkmcnt(14)
    v_mfma_f32_16x16x32_bf16 v[0:3], v[112:115], v[152:155], v[0:3]
    s_waitcnt lgkmcnt(0)
    s_barrier
    ds_read_b128 v[144:147], v162 offset:0
    v_mfma_f32_16x16x32_bf16 v[4:7], v[112:115], v[156:159], v[4:7]
    ds_read_b128 v[148:151], v162 offset:2048
    v_mfma_f32_16x16x32_bf16 v[8:11], v[116:119], v[152:155], v[8:11]
    ds_read_b64_tr_b16 v[96:97], v184 offset:0
    v_mfma_f32_16x16x32_bf16 v[12:15], v[116:119], v[156:159], v[12:15]
    ds_read_b64_tr_b16 v[98:99], v184 offset:1024
    ds_read_b64_tr_b16 v[100:101], v185 offset:0
    v_mfma_f32_16x16x32_bf16 v[16:19], v[120:123], v[152:155], v[16:19]
    ds_read_b64_tr_b16 v[102:103], v185 offset:1024
    v_mfma_f32_16x16x32_bf16 v[20:23], v[120:123], v[156:159], v[20:23]
    ds_read_b64_tr_b16 v[104:105], v186 offset:0
    v_mfma_f32_16x16x32_bf16 v[24:27], v[124:127], v[152:155], v[24:27]
    ds_read_b64_tr_b16 v[106:107], v186 offset:1024
    v_mfma_f32_16x16x32_bf16 v[28:31], v[124:127], v[156:159], v[28:31]
    ds_read_b64_tr_b16 v[108:109], v187 offset:0
    ds_read_b64_tr_b16 v[110:111], v187 offset:1024
    v_mfma_f32_16x16x32_bf16 v[32:35], v[128:131], v[152:155], v[32:35]
    ds_read_b64_tr_b16 v[112:113], v188 offset:0
    v_mfma_f32_16x16x32_bf16 v[36:39], v[128:131], v[156:159], v[36:39]
    ds_read_b64_tr_b16 v[114:115], v188 offset:1024
    v_mfma_f32_16x16x32_bf16 v[40:43], v[132:135], v[152:155], v[40:43]
    ds_read_b64_tr_b16 v[116:117], v189 offset:0
    v_mfma_f32_16x16x32_bf16 v[44:47], v[132:135], v[156:159], v[44:47]
    ds_read_b64_tr_b16 v[118:119], v189 offset:1024
    v_mfma_f32_16x16x32_bf16 v[48:51], v[136:139], v[152:155], v[48:51]
    ds_read_b64_tr_b16 v[120:121], v190 offset:0
    v_mfma_f32_16x16x32_bf16 v[52:55], v[136:139], v[156:159], v[52:55]
    s_waitcnt lgkmcnt(14)
    ds_read_b64_tr_b16 v[122:123], v190 offset:1024
    v_mfma_f32_16x16x32_bf16 v[56:59], v[140:143], v[152:155], v[56:59]
    s_waitcnt lgkmcnt(14)
    ds_read_b64_tr_b16 v[124:125], v191 offset:0
    v_mfma_f32_16x16x32_bf16 v[60:63], v[140:143], v[156:159], v[60:63]
    s_waitcnt lgkmcnt(14)
    ds_read_b64_tr_b16 v[126:127], v191 offset:1024
    s_waitcnt lgkmcnt(14)
    v_mfma_f32_16x16x32_bf16 v[0:3], v[96:99], v[144:147], v[0:3]
    ds_read_b128 v[152:155], v163 offset:0
    v_mfma_f32_16x16x32_bf16 v[4:7], v[96:99], v[148:151], v[4:7]
    s_waitcnt lgkmcnt(14)
    ds_read_b128 v[156:159], v163 offset:2048
    s_waitcnt lgkmcnt(14)
    v_mfma_f32_16x16x32_bf16 v[8:11], v[100:103], v[144:147], v[8:11]
    ds_read_b64_tr_b16 v[128:129], v184 offset:8192
    v_mfma_f32_16x16x32_bf16 v[12:15], v[100:103], v[148:151], v[12:15]
    s_waitcnt lgkmcnt(14)
    ds_read_b64_tr_b16 v[130:131], v184 offset:9216
    s_waitcnt lgkmcnt(14)
    ds_read_b64_tr_b16 v[132:133], v185 offset:8192
    v_mfma_f32_16x16x32_bf16 v[16:19], v[104:107], v[144:147], v[16:19]
    s_waitcnt lgkmcnt(14)
    ds_read_b64_tr_b16 v[134:135], v185 offset:9216
    v_mfma_f32_16x16x32_bf16 v[20:23], v[104:107], v[148:151], v[20:23]
    s_waitcnt lgkmcnt(14)
    ds_read_b64_tr_b16 v[136:137], v186 offset:8192
    v_mfma_f32_16x16x32_bf16 v[24:27], v[108:111], v[144:147], v[24:27]
    s_waitcnt lgkmcnt(14)
    ds_read_b64_tr_b16 v[138:139], v186 offset:9216
    v_mfma_f32_16x16x32_bf16 v[28:31], v[108:111], v[148:151], v[28:31]
    s_waitcnt lgkmcnt(14)
    ds_read_b64_tr_b16 v[140:141], v187 offset:8192
    s_waitcnt lgkmcnt(14)
    ds_read_b64_tr_b16 v[142:143], v187 offset:9216
    v_mfma_f32_16x16x32_bf16 v[32:35], v[112:115], v[144:147], v[32:35]
    s_waitcnt lgkmcnt(14)
    ds_read_b64_tr_b16 v[96:97], v188 offset:8192
    v_mfma_f32_16x16x32_bf16 v[36:39], v[112:115], v[148:151], v[36:39]
    s_waitcnt lgkmcnt(14)
    ds_read_b64_tr_b16 v[98:99], v188 offset:9216
    v_mfma_f32_16x16x32_bf16 v[40:43], v[116:119], v[144:147], v[40:43]
    s_waitcnt lgkmcnt(14)
    ds_read_b64_tr_b16 v[100:101], v189 offset:8192
    v_mfma_f32_16x16x32_bf16 v[44:47], v[116:119], v[148:151], v[44:47]
    s_waitcnt lgkmcnt(14)
    ds_read_b64_tr_b16 v[102:103], v189 offset:9216
    v_mfma_f32_16x16x32_bf16 v[48:51], v[120:123], v[144:147], v[48:51]
    s_waitcnt lgkmcnt(14)
    ds_read_b64_tr_b16 v[104:105], v190 offset:8192
    v_mfma_f32_16x16x32_bf16 v[52:55], v[120:123], v[148:151], v[52:55]
    s_waitcnt lgkmcnt(14)
    ds_read_b64_tr_b16 v[106:107], v190 offset:9216
    v_mfma_f32_16x16x32_bf16 v[56:59], v[124:127], v[144:147], v[56:59]
    s_waitcnt lgkmcnt(14)
    ds_read_b64_tr_b16 v[108:109], v191 offset:8192
    v_mfma_f32_16x16x32_bf16 v[60:63], v[124:127], v[148:151], v[60:63]
    s_waitcnt lgkmcnt(14)
    ds_read_b64_tr_b16 v[110:111], v191 offset:9216
    s_waitcnt lgkmcnt(14)
    v_mfma_f32_16x16x32_bf16 v[0:3], v[128:131], v[152:155], v[0:3]
    s_waitcnt lgkmcnt(0)
    s_barrier
    v_mfma_f32_16x16x32_bf16 v[4:7], v[128:131], v[156:159], v[4:7]
    v_mfma_f32_16x16x32_bf16 v[8:11], v[132:135], v[152:155], v[8:11]
    v_mfma_f32_16x16x32_bf16 v[12:15], v[132:135], v[156:159], v[12:15]
    v_mfma_f32_16x16x32_bf16 v[16:19], v[136:139], v[152:155], v[16:19]
    v_mfma_f32_16x16x32_bf16 v[20:23], v[136:139], v[156:159], v[20:23]
    v_mfma_f32_16x16x32_bf16 v[24:27], v[140:143], v[152:155], v[24:27]
    v_mfma_f32_16x16x32_bf16 v[28:31], v[140:143], v[156:159], v[28:31]
    v_mfma_f32_16x16x32_bf16 v[32:35], v[96:99], v[152:155], v[32:35]
    v_mfma_f32_16x16x32_bf16 v[36:39], v[96:99], v[156:159], v[36:39]
    v_mfma_f32_16x16x32_bf16 v[40:43], v[100:103], v[152:155], v[40:43]
    v_mfma_f32_16x16x32_bf16 v[44:47], v[100:103], v[156:159], v[44:47]
    v_mfma_f32_16x16x32_bf16 v[48:51], v[104:107], v[152:155], v[48:51]
    v_mfma_f32_16x16x32_bf16 v[52:55], v[104:107], v[156:159], v[52:55]
    v_mfma_f32_16x16x32_bf16 v[56:59], v[108:111], v[152:155], v[56:59]
    v_mfma_f32_16x16x32_bf16 v[60:63], v[108:111], v[156:159], v[60:63]
K1_PAJ:
    v_mul_f32 v0, s50, v0
    v_mul_f32 v1, s50, v1
    v_cvt_pk_bf16_f32 v64, v0, v1
    v_mul_f32 v2, s50, v2
    v_mul_f32 v3, s50, v3
    v_cvt_pk_bf16_f32 v65, v2, v3
    v_mul_f32 v8, s50, v8
    v_mul_f32 v9, s50, v9
    v_cvt_pk_bf16_f32 v66, v8, v9
    v_mul_f32 v10, s50, v10
    v_mul_f32 v11, s50, v11
    v_cvt_pk_bf16_f32 v67, v10, v11
    v_mul_f32 v4, s50, v4
    v_mul_f32 v5, s50, v5
    v_cvt_pk_bf16_f32 v68, v4, v5
    v_mul_f32 v6, s50, v6
    v_mul_f32 v7, s50, v7
    v_cvt_pk_bf16_f32 v69, v6, v7
    v_mul_f32 v12, s50, v12
    v_mul_f32 v13, s50, v13
    v_cvt_pk_bf16_f32 v70, v12, v13
    v_mul_f32 v14, s50, v14
    v_mul_f32 v15, s50, v15
    v_cvt_pk_bf16_f32 v71, v14, v15
    v_mul_f32 v16, s50, v16
    v_mul_f32 v17, s50, v17
    v_cvt_pk_bf16_f32 v72, v16, v17
    v_mul_f32 v18, s50, v18
    v_mul_f32 v19, s50, v19
    v_cvt_pk_bf16_f32 v73, v18, v19
    v_mul_f32 v24, s50, v24
    v_mul_f32 v25, s50, v25
    v_cvt_pk_bf16_f32 v74, v24, v25
    v_mul_f32 v26, s50, v26
    v_mul_f32 v27, s50, v27
    v_cvt_pk_bf16_f32 v75, v26, v27
    v_permlane16_swap_b32 v64, v66
    v_permlane16_swap_b32 v65, v67
    v_mul_f32 v20, s50, v20
    v_mul_f32 v21, s50, v21
    v_cvt_pk_bf16_f32 v76, v20, v21
    v_mul_f32 v22, s50, v22
    v_mul_f32 v23, s50, v23
    v_cvt_pk_bf16_f32 v77, v22, v23
    v_mul_f32 v28, s50, v28
    v_mul_f32 v29, s50, v29
    v_cvt_pk_bf16_f32 v78, v28, v29
    v_mul_f32 v30, s50, v30
    v_mul_f32 v31, s50, v31
    v_cvt_pk_bf16_f32 v79, v30, v31
    v_permlane16_swap_b32 v68, v70
    v_permlane16_swap_b32 v69, v71
    v_mul_f32 v32, s50, v32
    v_mul_f32 v33, s50, v33
    v_cvt_pk_bf16_f32 v80, v32, v33
    v_mul_f32 v34, s50, v34
    v_mul_f32 v35, s50, v35
    v_cvt_pk_bf16_f32 v81, v34, v35
    v_mul_f32 v40, s50, v40
    v_mul_f32 v41, s50, v41
    v_cvt_pk_bf16_f32 v82, v40, v41
    v_mul_f32 v42, s50, v42
    v_mul_f32 v43, s50, v43
    v_cvt_pk_bf16_f32 v83, v42, v43
    v_permlane16_swap_b32 v72, v74
    v_permlane16_swap_b32 v73, v75
    v_mul_f32 v36, s50, v36
    v_mul_f32 v37, s50, v37
    v_cvt_pk_bf16_f32 v84, v36, v37
    v_mul_f32 v38, s50, v38
    v_mul_f32 v39, s50, v39
    v_cvt_pk_bf16_f32 v85, v38, v39
    v_mul_f32 v44, s50, v44
    v_mul_f32 v45, s50, v45
    v_cvt_pk_bf16_f32 v86, v44, v45
    v_mul_f32 v46, s50, v46
    v_mul_f32 v47, s50, v47
    v_cvt_pk_bf16_f32 v87, v46, v47
    v_permlane16_swap_b32 v76, v78
    v_permlane16_swap_b32 v77, v79
    v_mul_f32 v48, s50, v48
    v_mul_f32 v49, s50, v49
    v_cvt_pk_bf16_f32 v88, v48, v49
    v_mul_f32 v50, s50, v50
    v_mul_f32 v51, s50, v51
    v_cvt_pk_bf16_f32 v89, v50, v51
    v_mul_f32 v56, s50, v56
    v_mul_f32 v57, s50, v57
    v_cvt_pk_bf16_f32 v90, v56, v57
    v_mul_f32 v58, s50, v58
    v_mul_f32 v59, s50, v59
    v_cvt_pk_bf16_f32 v91, v58, v59
    v_permlane16_swap_b32 v80, v82
    v_permlane16_swap_b32 v81, v83
    v_mul_f32 v52, s50, v52
    v_mul_f32 v53, s50, v53
    v_cvt_pk_bf16_f32 v92, v52, v53
    v_mul_f32 v54, s50, v54
    v_mul_f32 v55, s50, v55
    v_cvt_pk_bf16_f32 v93, v54, v55
    v_mul_f32 v60, s50, v60
    v_mul_f32 v61, s50, v61
    v_cvt_pk_bf16_f32 v94, v60, v61
    v_mul_f32 v62, s50, v62
    v_mul_f32 v63, s50, v63
    v_cvt_pk_bf16_f32 v95, v62, v63
    v_permlane16_swap_b32 v84, v86
    v_permlane16_swap_b32 v85, v87
    v_permlane16_swap_b32 v88, v90
    v_permlane16_swap_b32 v89, v91
    v_permlane16_swap_b32 v92, v94
    v_permlane16_swap_b32 v93, v95
    s_waitcnt vmcnt(0)
    v_mov_b32 v252, 0
    v_mov_b32 v253, 0
    s_mov_b32 s44, 0
    s_mov_b32 s51, 0x41000000
    v_and_b32 v254, 3, v255
    v_mul_u32_u24 v254, 1056, v254
    s_lshl_b32 s46, s40, 3
    s_add_u32 s46, s46, 131072
    v_add_u32 v254, s46, v254
    ds_read_b128 v[160:163], v240 offset:0
    ds_read_b128 v[164:167], v241 offset:0
    ds_read_b128 v[168:171], v242 offset:0
    ds_read_b128 v[172:175], v243 offset:0
    ds_read_b128 v[176:179], v240 offset:4096
    ds_read_b128 v[180:183], v241 offset:4096
    ds_read_b128 v[184:187], v242 offset:4096
    ds_read_b128 v[188:191], v243 offset:4096
    v_mov_b32 v0, 0
    v_mov_b32 v1, 0
    v_mov_b32 v2, 0
    v_mov_b32 v3, 0
    v_mov_b32 v4, 0
    v_mov_b32 v5, 0
    v_mov_b32 v6, 0
    v_mov_b32 v7, 0
    v_mov_b32 v8, 0
    v_mov_b32 v9, 0
    v_mov_b32 v10, 0
    v_mov_b32 v11, 0
    s_waitcnt lgkmcnt(7)
    v_mfma_f32_16x16x32_bf16 v[96:99], v[160:163], v[64:67], 0
    v_mov_b32 v12, 0
    v_mov_b32 v13, 0
    v_mfma_f32_16x16x32_bf16 v[104:107], v[160:163], v[68:71], 0
    ds_read_b128 v[160:163], v240 offset:8192
    v_mov_b32 v14, 0
    v_mov_b32 v15, 0
    s_waitcnt lgkmcnt(7)
    v_mfma_f32_16x16x32_bf16 v[96:99], v[164:167], v[72:75], v[96:99]
    v_mov_b32 v16, 0
    v_mov_b32 v17, 0
    v_mfma_f32_16x16x32_bf16 v[104:107], v[164:167], v[76:79], v[104:107]
    ds_read_b128 v[164:167], v241 offset:8192
    v_mov_b32 v18, 0
    v_mov_b32 v19, 0
    s_waitcnt lgkmcnt(7)
    v_mfma_f32_16x16x32_bf16 v[96:99], v[168:171], v[80:83], v[96:99]
    v_mov_b32 v20, 0
    v_mov_b32 v21, 0
    v_mfma_f32_16x16x32_bf16 v[104:107], v[168:171], v[84:87], v[104:107]
    ds_read_b128 v[168:171], v242 offset:8192
    v_mov_b32 v22, 0
    v_mov_b32 v23, 0
    s_waitcnt lgkmcnt(7)
    v_mfma_f32_16x16x32_bf16 v[96:99], v[172:175], v[88:91], v[96:99]
    v_mov_b32 v24, 0
    v_mov_b32 v25, 0
    v_mfma_f32_16x16x32_bf16 v[104:107], v[172:175], v[92:95], v[104:107]
    ds_read_b128 v[172:175], v243 offset:8192
    v_mov_b32 v26, 0
    v_mov_b32 v27, 0
    s_waitcnt lgkmcnt(7)
    v_mfma_f32_16x16x32_bf16 v[100:103], v[176:179], v[64:67], 0
    v_mov_b32 v28, 0
    v_mov_b32 v29, 0
    v_mfma_f32_16x16x32_bf16 v[108:111], v[176:179], v[68:71], 0
    ds_read_b128 v[176:179], v240 offset:12288
    v_mov_b32 v30, 0
    v_mov_b32 v31, 0
    s_waitcnt lgkmcnt(7)
    v_mfma_f32_16x16x32_bf16 v[100:103], v[180:183], v[72:75], v[100:103]
    v_mov_b32 v32, 0
    v_mov_b32 v33, 0
    v_mfma_f32_16x16x32_bf16 v[108:111], v[180:183], v[76:79], v[108:111]
    ds_read_b128 v[180:183], v241 offset:12288
    v_mov_b32 v34, 0
    v_mov_b32 v35, 0
    s_waitcnt lgkmcnt(7)
    v_mfma_f32_16x16x32_bf16 v[100:103], v[184:187], v[80:83], v[100:103]
    v_mov_b32 v36, 0
    v_mov_b32 v37, 0
    v_mfma_f32_16x16x32_bf16 v[108:111], v[184:187], v[84:87], v[108:111]
    ds_read_b128 v[184:187], v242 offset:12288
    v_mov_b32 v38, 0
    v_mov_b32 v39, 0
    s_waitcnt lgkmcnt(7)
    v_mfma_f32_16x16x32_bf16 v[100:103], v[188:191], v[88:91], v[100:103]
    v_mov_b32 v40, 0
    v_mov_b32 v41, 0
    v_mfma_f32_16x16x32_bf16 v[108:111], v[188:191], v[92:95], v[108:111]
    ds_read_b128 v[188:191], v243 offset:12288
    v_mov_b32 v42, 0
    v_mov_b32 v43, 0
    s_waitcnt lgkmcnt(7)
    v_mfma_f32_16x16x32_bf16 v[112:115], v[160:163], v[64:67], 0
    v_mov_b32 v44, 0
    v_mov_b32 v45, 0
    v_mfma_f32_16x16x32_bf16 v[120:123], v[160:163], v[68:71], 0
    v_mov_b32 v46, 0
    v_mov_b32 v47, 0
    s_waitcnt lgkmcnt(6)
    v_mfma_f32_16x16x32_bf16 v[112:115], v[164:167], v[72:75], v[112:115]
    v_mov_b32 v48, 0
    v_mov_b32 v49, 0
    v_mfma_f32_16x16x32_bf16 v[120:123], v[164:167], v[76:79], v[120:123]
    v_mov_b32 v50, 0
    v_mov_b32 v51, 0
    s_waitcnt lgkmcnt(5)
    v_mfma_f32_16x16x32_bf16 v[112:115], v[168:171], v[80:83], v[112:115]
    v_mov_b32 v52, 0
    v_mov_b32 v53, 0
    v_mfma_f32_16x16x32_bf16 v[120:123], v[168:171], v[84:87], v[120:123]
    v_mov_b32 v54, 0
    v_mov_b32 v55, 0
    s_waitcnt lgkmcnt(4)
    v_mfma_f32_16x16x32_bf16 v[112:115], v[172:175], v[88:91], v[112:115]
    v_mov_b32 v56, 0
    v_mov_b32 v57, 0
    v_mfma_f32_16x16x32_bf16 v[120:123], v[172:175], v[92:95], v[120:123]
    v_mov_b32 v58, 0
    v_mov_b32 v59, 0
    s_waitcnt lgkmcnt(3)
    v_mfma_f32_16x16x32_bf16 v[116:119], v[176:179], v[64:67], 0
    v_mov_b32 v60, 0
    v_mov_b32 v61, 0
    v_mfma_f32_16x16x32_bf16 v[124:127], v[176:179], v[68:71], 0
    v_mov_b32 v62, 0
    v_mov_b32 v63, 0
    s_waitcnt lgkmcnt(2)
    v_mfma_f32_16x16x32_bf16 v[116:119], v[180:183], v[72:75], v[116:119]
    v_mov_b32 v232, 0
    v_mov_b32 v233, 0
    v_mfma_f32_16x16x32_bf16 v[124:127], v[180:183], v[76:79], v[124:127]
    v_mov_b32 v234, 0
    v_mov_b32 v235, 0
    s_waitcnt lgkmcnt(1)
    v_mfma_f32_16x16x32_bf16 v[116:119], v[184:187], v[80:83], v[116:119]
    v_mov_b32 v236, 0
    v_mov_b32 v237, 0
    v_mfma_f32_16x16x32_bf16 v[124:127], v[184:187], v[84:87], v[124:127]
    v_mov_b32 v238, 0
    v_mov_b32 v239, 0
    s_waitcnt lgkmcnt(0)
    v_mfma_f32_16x16x32_bf16 v[116:119], v[188:191], v[88:91], v[116:119]
    v_mov_b32 v220, 0x3f803f80
    v_mov_b32 v221, 0x3f803f80
    v_mfma_f32_16x16x32_bf16 v[124:127], v[188:191], v[92:95], v[124:127]
    v_mov_b32 v222, 0x3f803f80
    v_mov_b32 v223, 0x3f803f80
    v_max3_f32 v136, v96, v97, v98
    v_max3_f32 v137, v104, v105, v106
    v_max3_f32 v136, v136, v99, v100
    v_max3_f32 v137, v137, v107, v108
    v_max3_f32 v136, v136, v101, v102
    v_max3_f32 v137, v137, v109, v110
    v_max3_f32 v136, v136, v103, v112
    v_max3_f32 v137, v137, v111, v120
    v_max3_f32 v136, v136, v113, v114
    v_max3_f32 v137, v137, v121, v122
    v_max3_f32 v136, v136, v115, v116
    v_max3_f32 v137, v137, v123, v124
    v_max3_f32 v136, v136, v117, v118
    v_max3_f32 v137, v137, v125, v126
    v_max_f32 v136, v136, v119
    v_max_f32 v137, v137, v127
    v_mov_b32 v138, v136
    v_mov_b32 v139, v137
    s_nop 0
    v_permlane32_swap_b32 v136, v138
    v_permlane32_swap_b32 v137, v139
    v_max_f32 v136, v136, v138
    v_max_f32 v137, v137, v139
    v_mov_b32 v138, v136
    v_mov_b32 v139, v137
    s_nop 0
    v_permlane16_swap_b32 v136, v138
    v_permlane16_swap_b32 v137, v139
    v_max_f32 v136, v136, v138
    v_max_f32 v137, v137, v139
    v_sub_f32 v224, 0, v136
    v_sub_f32 v225, 0, v136
    v_sub_f32 v226, 0, v136
    v_sub_f32 v227, 0, v136
    v_sub_f32 v228, 0, v137
    v_sub_f32 v229, 0, v137
    v_sub_f32 v230, 0, v137
    v_sub_f32 v231, 0, v137
    v_sub_f32 v96, v96, v136
    v_sub_f32 v97, v97, v136
    v_sub_f32 v98, v98, v136
    v_sub_f32 v99, v99, v136
    v_sub_f32 v100, v100, v136
    v_sub_f32 v101, v101, v136
    v_sub_f32 v102, v102, v136
    v_sub_f32 v103, v103, v136
    v_sub_f32 v112, v112, v136
    v_sub_f32 v113, v113, v136
    v_sub_f32 v114, v114, v136
    v_sub_f32 v115, v115, v136
    v_sub_f32 v116, v116, v136
    v_sub_f32 v117, v117, v136
    v_sub_f32 v118, v118, v136
    v_sub_f32 v119, v119, v136
    v_sub_f32 v104, v104, v137
    v_sub_f32 v105, v105, v137
    v_sub_f32 v106, v106, v137
    v_sub_f32 v107, v107, v137
    v_sub_f32 v108, v108, v137
    v_sub_f32 v109, v109, v137
    v_sub_f32 v110, v110, v137
    v_sub_f32 v111, v111, v137
    v_sub_f32 v120, v120, v137
    v_sub_f32 v121, v121, v137
    v_sub_f32 v122, v122, v137
    v_sub_f32 v123, v123, v137
    v_sub_f32 v124, v124, v137
    v_sub_f32 v125, v125, v137
    v_sub_f32 v126, v126, v137
    v_sub_f32 v127, v127, v137
    v_exp_f32 v96, v96
    v_exp_f32 v97, v97
    v_exp_f32 v98, v98
    v_exp_f32 v99, v99
    v_exp_f32 v100, v100
    v_exp_f32 v101, v101
    v_exp_f32 v102, v102
    v_exp_f32 v103, v103
    v_cvt_pk_bf16_f32 v96, v96, v97
    v_cvt_pk_bf16_f32 v97, v98, v99
    v_cvt_pk_bf16_f32 v98, v100, v101
    v_cvt_pk_bf16_f32 v99, v102, v103
    v_exp_f32 v104, v104
    v_exp_f32 v105, v105
    v_exp_f32 v106, v106
    v_exp_f32 v107, v107
    v_exp_f32 v108, v108
    v_exp_f32 v109, v109
    v_exp_f32 v110, v110
    v_exp_f32 v111, v111
    v_cvt_pk_bf16_f32 v104, v104, v105
    v_cvt_pk_bf16_f32 v105, v106, v107
    v_cvt_pk_bf16_f32 v106, v108, v109
    v_cvt_pk_bf16_f32 v107, v110, v111
    s_barrier
    ds_read_b128 v[160:163], v240 offset:16384
    ds_read_b128 v[164:167], v241 offset:16384
    ds_read_b128 v[168:171], v242 offset:16384
    ds_read_b128 v[172:175], v243 offset:16384
    ds_read_b128 v[176:179], v240 offset:20480
    ds_read_b128 v[180:183], v241 offset:20480
    ds_read_b128 v[184:187], v242 offset:20480
    ds_read_b128 v[188:191], v243 offset:20480
K1_LOOP:
    s_waitcnt lgkmcnt(6)
    v_mfma_f32_16x16x32_bf16 v[128:131], v[160:163], v[64:67], v[224:227]
    v_exp_f32 v112, v112
    v_mfma_f32_16x16x32_bf16 v[136:139], v[160:163], v[68:71], v[228:231]
    ds_read_b64_tr_b16 v[160:161], v244 offset:0
    ds_read_b64_tr_b16 v[162:163], v244 offset:4096
    v_exp_f32 v113, v113
    v_mfma_f32_16x16x32_bf16 v[128:131], v[164:167], v[72:75], v[128:131]
    v_exp_f32 v114, v114
    v_mfma_f32_16x16x32_bf16 v[136:139], v[164:167], v[76:79], v[136:139]
    ds_read_b64_tr_b16 v[192:193], v245 offset:0
    ds_read_b64_tr_b16 v[194:195], v245 offset:4096
    s_waitcnt lgkmcnt(8)
    v_mfma_f32_16x16x32_bf16 v[128:131], v[168:171], v[80:83], v[128:131]
    v_exp_f32 v115, v115
    v_mfma_f32_16x16x32_bf16 v[136:139], v[168:171], v[84:87], v[136:139]
    ds_read_b64_tr_b16 v[196:197], v246 offset:0
    ds_read_b64_tr_b16 v[198:199], v246 offset:4096
    v_mfma_f32_16x16x32_bf16 v[128:131], v[172:175], v[88:91], v[128:131]
    v_exp_f32 v116, v116
    v_mfma_f32_16x16x32_bf16 v[136:139], v[172:175], v[92:95], v[136:139]
    ds_read_b64_tr_b16 v[200:201], v247 offset:0
    ds_read_b64_tr_b16 v[202:203], v247 offset:4096
    v_cvt_pk_bf16_f32 v112, v112, v113
    s_waitcnt lgkmcnt(10)
    v_mfma_f32_16x16x32_bf16 v[132:135], v[176:179], v[64:67], v[224:227]
    v_exp_f32 v117, v117
    v_mfma_f32_16x16x32_bf16 v[140:143], v[176:179], v[68:71], v[228:231]
    ds_read_b64_tr_b16 v[204:205], v248 offset:0
    ds_read_b64_tr_b16 v[206:207], v248 offset:4096
    v_mfma_f32_16x16x32_bf16 v[132:135], v[180:183], v[72:75], v[132:135]
    v_exp_f32 v118, v118
    v_cvt_pk_bf16_f32 v113, v114, v115
    v_mfma_f32_16x16x32_bf16 v[140:143], v[180:183], v[76:79], v[140:143]
    ds_read_b64_tr_b16 v[208:209], v249 offset:0
    ds_read_b64_tr_b16 v[210:211], v249 offset:4096
    s_waitcnt lgkmcnt(12)
    v_mfma_f32_16x16x32_bf16 v[132:135], v[184:187], v[80:83], v[132:135]
    v_exp_f32 v119, v119
    v_mfma_f32_16x16x32_bf16 v[140:143], v[184:187], v[84:87], v[140:143]
    ds_read_b64_tr_b16 v[212:213], v250 offset:0
    ds_read_b64_tr_b16 v[214:215], v250 offset:4096
    v_cvt_pk_bf16_f32 v114, v116, v117
    v_mfma_f32_16x16x32_bf16 v[132:135], v[188:191], v[88:91], v[132:135]
    v_exp_f32 v120, v120
    v_mfma_f32_16x16x32_bf16 v[140:143], v[188:191], v[92:95], v[140:143]
    ds_read_b64_tr_b16 v[216:217], v251 offset:0
    s_waitcnt lgkmcnt(14)
    ds_read_b64_tr_b16 v[218:219], v251 offset:4096
    v_mfma_f32_16x16x32_bf16 v[236:239], v[220:223], v[96:99], v[236:239]
    v_exp_f32 v121, v121
    v_cvt_pk_bf16_f32 v115, v118, v119
    v_mfma_f32_16x16x32_bf16 v[232:235], v[220:223], v[104:107], v[232:235]
    v_cvt_pk_bf16_f32 v120, v120, v121
    s_waitcnt lgkmcnt(12)
    v_mfma_f32_16x16x32_bf16 v[0:3], v[160:163], v[96:99], v[0:3]
    v_exp_f32 v122, v122
    v_mfma_f32_16x16x32_bf16 v[4:7], v[160:163], v[104:107], v[4:7]
    ds_read_b128 v[160:163], v240 offset:24576
    v_max3_f32 v148, v128, v129, v130
    v_max3_f32 v149, v132, v133, v134
    v_mfma_f32_16x16x32_bf16 v[8:11], v[192:195], v[96:99], v[8:11]
    ds_read_b128 v[164:167], v241 offset:24576
    v_max3_f32 v148, v148, v131, v136
    v_mfma_f32_16x16x32_bf16 v[12:15], v[192:195], v[104:107], v[12:15]
    v_max3_f32 v149, v149, v135, v140
    s_waitcnt lgkmcnt(10)
    v_mfma_f32_16x16x32_bf16 v[16:19], v[196:199], v[96:99], v[16:19]
    ds_read_b128 v[168:171], v242 offset:24576
    v_max3_f32 v148, v148, v137, v138
    v_max3_f32 v149, v149, v141, v142
    v_mfma_f32_16x16x32_bf16 v[20:23], v[196:199], v[104:107], v[20:23]
    ds_read_b128 v[172:175], v243 offset:24576
    v_max3_f32 v148, v148, v139, v143
    v_mfma_f32_16x16x32_bf16 v[24:27], v[200:203], v[96:99], v[24:27]
    v_exp_f32 v123, v123
    v_mfma_f32_16x16x32_bf16 v[28:31], v[200:203], v[104:107], v[28:31]
    ds_read_b128 v[176:179], v240 offset:28672
    v_cvt_pk_bf16_f32 v121, v122, v123
    s_waitcnt lgkmcnt(9)
    v_mfma_f32_16x16x32_bf16 v[32:35], v[204:207], v[96:99], v[32:35]
    ds_read_b128 v[180:183], v241 offset:28672
    v_max_f32 v148, v148, v149
    v_mfma_f32_16x16x32_bf16 v[36:39], v[204:207], v[104:107], v[36:39]
    v_exp_f32 v124, v124
    v_mfma_f32_16x16x32_bf16 v[40:43], v[208:211], v[96:99], v[40:43]
    ds_read_b128 v[184:187], v242 offset:28672
    v_cmp_lt_f32 vcc, s51, v148
    v_exp_f32 v125, v125
    v_mfma_f32_16x16x32_bf16 v[44:47], v[208:211], v[104:107], v[44:47]
    ds_read_b128 v[188:191], v243 offset:28672
    s_waitcnt lgkmcnt(8)
    v_mfma_f32_16x16x32_bf16 v[48:51], v[212:215], v[96:99], v[48:51]
    v_exp_f32 v126, v126
    v_mfma_f32_16x16x32_bf16 v[52:55], v[212:215], v[104:107], v[52:55]
    v_exp_f32 v127, v127
    v_mfma_f32_16x16x32_bf16 v[56:59], v[216:219], v[96:99], v[56:59]
    v_cvt_pk_bf16_f32 v122, v124, v125
    v_cvt_pk_bf16_f32 v123, v126, v127
    v_mfma_f32_16x16x32_bf16 v[60:63], v[216:219], v[104:107], v[60:63]
    s_cbranch_vccz K1_NF0
    s_call_b64 s[90:91], K1_FIX0
K1_NF0:
    s_waitcnt lgkmcnt(6)
    v_mfma_f32_16x16x32_bf16 v[144:147], v[160:163], v[64:67], v[224:227]
    v_exp_f32 v128, v128
    v_exp_f32 v129, v129
    v_mfma_f32_16x16x32_bf16 v[152:155], v[160:163], v[68:71], v[228:231]
    ds_read_b64_tr_b16 v[160:161], v244 offset:8192
    ds_read_b64_tr_b16 v[162:163], v244 offset:12288
    v_mfma_f32_16x16x32_bf16 v[144:147], v[164:167], v[72:75], v[144:147]
    v_exp_f32 v130, v130
    v_mfma_f32_16x16x32_bf16 v[152:155], v[164:167], v[76:79], v[152:155]
    ds_read_b64_tr_b16 v[192:193], v245 offset:8192
    ds_read_b64_tr_b16 v[194:195], v245 offset:12288
    s_waitcnt lgkmcnt(8)
    v_mfma_f32_16x16x32_bf16 v[144:147], v[168:171], v[80:83], v[144:147]
    v_exp_f32 v131, v131
    v_cvt_pk_bf16_f32 v128, v128, v129
    v_mfma_f32_16x16x32_bf16 v[152:155], v[168:171], v[84:87], v[152:155]
    ds_read_b64_tr_b16 v[196:197], v246 offset:8192
    ds_read_b64_tr_b16 v[198:199], v246 offset:12288
    v_mfma_f32_16x16x32_bf16 v[144:147], v[172:175], v[88:91], v[144:147]
    v_exp_f32 v132, v132
    v_cvt_pk_bf16_f32 v129, v130, v131
    v_mfma_f32_16x16x32_bf16 v[152:155], v[172:175], v[92:95], v[152:155]
    ds_read_b64_tr_b16 v[200:201], v247 offset:8192
    ds_read_b64_tr_b16 v[202:203], v247 offset:12288
    s_waitcnt lgkmcnt(10)
    v_mfma_f32_16x16x32_bf16 v[148:151], v[176:179], v[64:67], v[224:227]
    v_exp_f32 v133, v133
    v_exp_f32 v134, v134
    v_mfma_f32_16x16x32_bf16 v[156:159], v[176:179], v[68:71], v[228:231]
    ds_read_b64_tr_b16 v[204:205], v248 offset:8192
    ds_read_b64_tr_b16 v[206:207], v248 offset:12288
    v_mfma_f32_16x16x32_bf16 v[148:151], v[180:183], v[72:75], v[148:151]
    v_exp_f32 v135, v135
    v_mfma_f32_16x16x32_bf16 v[156:159], v[180:183], v[76:79], v[156:159]
    ds_read_b64_tr_b16 v[208:209], v249 offset:8192
    ds_read_b64_tr_b16 v[210:211], v249 offset:12288
    s_waitcnt lgkmcnt(12)
    v_mfma_f32_16x16x32_bf16 v[148:151], v[184:187], v[80:83], v[148:151]
    v_exp_f32 v136, v136
    v_cvt_pk_bf16_f32 v130, v132, v133
    v_mfma_f32_16x16x32_bf16 v[156:159], v[184:187], v[84:87], v[156:159]
    ds_read_b64_tr_b16 v[212:213], v250 offset:8192
    ds_read_b64_tr_b16 v[214:215], v250 offset:12288
    v_mfma_f32_16x16x32_bf16 v[148:151], v[188:191], v[88:91], v[148:151]
    v_exp_f32 v137, v137
    v_cvt_pk_bf16_f32 v131, v134, v135
    v_mfma_f32_16x16x32_bf16 v[156:159], v[188:191], v[92:95], v[156:159]
    ds_read_b64_tr_b16 v[216:217], v251 offset:8192
    s_waitcnt lgkmcnt(14)
    ds_read_b64_tr_b16 v[218:219], v251 offset:12288
    v_mfma_f32_16x16x32_bf16 v[236:239], v[220:223], v[112:115], v[236:239]
    v_exp_f32 v138, v138
    v_mfma_f32_16x16x32_bf16 v[232:235], v[220:223], v[120:123], v[232:235]
    v_cvt_pk_bf16_f32 v136, v136, v137
    v_max3_f32 v100, v144, v145, v146
    s_waitcnt lgkmcnt(12)
    v_mfma_f32_16x16x32_bf16 v[0:3], v[160:163], v[112:115], v[0:3]
    v_exp_f32 v139, v139
    v_mfma_f32_16x16x32_bf16 v[4:7], v[160:163], v[120:123], v[4:7]
    v_exp_f32 v140, v140
    v_cvt_pk_bf16_f32 v137, v138, v139
    v_mfma_f32_16x16x32_bf16 v[8:11], v[192:195], v[112:115], v[8:11]
    ds_read_b32 v102, v254
    v_max3_f32 v101, v148, v149, v150
    v_mfma_f32_16x16x32_bf16 v[12:15], v[192:195], v[120:123], v[12:15]
    v_max3_f32 v100, v100, v147, v152
    v_max3_f32 v101, v101, v151, v156
    s_waitcnt lgkmcnt(9)
    v_mfma_f32_16x16x32_bf16 v[16:19], v[196:199], v[112:115], v[16:19]
    s_add_u32 s44, s44, 1
    v_mov_b32 v103, s44
    v_mfma_f32_16x16x32_bf16 v[20:23], v[196:199], v[120:123], v[20:23]
    v_max3_f32 v100, v100, v153, v154
    v_max3_f32 v101, v101, v157, v158
    s_waitcnt lgkmcnt(0)
    v_mfma_f32_16x16x32_bf16 v[24:27], v[200:203], v[112:115], v[24:27]
    ds_write_b32 v254, v103 offset:4
    v_cmp_gt_u32 vcc, s44, v102
    v_mfma_f32_16x16x32_bf16 v[28:31], v[200:203], v[120:123], v[28:31]
    s_cbranch_vccz K1_NW0
    s_call_b64 s[90:91], K1_WR0
K1_NW0:
    ds_read_b128 v[160:163], v240 offset:32768
    v_max3_f32 v100, v100, v155, v159
    v_mfma_f32_16x16x32_bf16 v[32:35], v[204:207], v[112:115], v[32:35]
    ds_read_b128 v[164:167], v241 offset:32768
    v_max_f32 v100, v100, v101
    v_mfma_f32_16x16x32_bf16 v[36:39], v[204:207], v[120:123], v[36:39]
    ds_read_b128 v[168:171], v242 offset:32768
    v_cmp_lt_f32 vcc, s51, v100
    v_exp_f32 v141, v141
    v_mfma_f32_16x16x32_bf16 v[40:43], v[208:211], v[112:115], v[40:43]
    ds_read_b128 v[172:175], v243 offset:32768
    v_cvt_pk_bf16_f32 v138, v140, v141
    v_mfma_f32_16x16x32_bf16 v[44:47], v[208:211], v[120:123], v[44:47]
    ds_read_b128 v[176:179], v240 offset:36864
    v_exp_f32 v142, v142
    v_mfma_f32_16x16x32_bf16 v[48:51], v[212:215], v[112:115], v[48:51]
    ds_read_b128 v[180:183], v241 offset:36864
    v_exp_f32 v143, v143
    v_mfma_f32_16x16x32_bf16 v[52:55], v[212:215], v[120:123], v[52:55]
    ds_read_b128 v[184:187], v242 offset:36864
    v_cvt_pk_bf16_f32 v139, v142, v143
    v_mfma_f32_16x16x32_bf16 v[56:59], v[216:219], v[112:115], v[56:59]
    ds_read_b128 v[188:191], v243 offset:36864
    v_mfma_f32_16x16x32_bf16 v[60:63], v[216:219], v[120:123], v[60:63]
    s_cbranch_vccz K1_NF1
    s_call_b64 s[90:91], K1_FIX1
K1_NF1:
    s_waitcnt lgkmcnt(6)
    v_mfma_f32_16x16x32_bf16 v[96:99], v[160:163], v[64:67], v[224:227]
    v_exp_f32 v144, v144
    v_mfma_f32_16x16x32_bf16 v[104:107], v[160:163], v[68:71], v[228:231]
    ds_read_b64_tr_b16 v[160:161], v244 offset:16384
    ds_read_b64_tr_b16 v[162:163], v244 offset:20480
    v_exp_f32 v145, v145
    v_mfma_f32_16x16x32_bf16 v[96:99], v[164:167], v[72:75], v[96:99]
    v_exp_f32 v146, v146
    v_mfma_f32_16x16x32_bf16 v[104:107], v[164:167], v[76:79], v[104:107]
    ds_read_b64_tr_b16 v[192:193], v245 offset:16384
    ds_read_b64_tr_b16 v[194:195], v245 offset:20480
    s_waitcnt lgkmcnt(8)
    v_mfma_f32_16x16x32_bf16 v[96:99], v[168:171], v[80:83], v[96:99]
    v_exp_f32 v147, v147
    v_mfma_f32_16x16x32_bf16 v[104:107], v[168:171], v[84:87], v[104:107]
    ds_read_b64_tr_b16 v[196:197], v246 offset:16384
    ds_read_b64_tr_b16 v[198:199], v246 offset:20480
    v_mfma_f32_16x16x32_bf16 v[96:99], v[172:175], v[88:91], v[96:99]
    v_exp_f32 v148, v148
    v_mfma_f32_16x16x32_bf16 v[104:107], v[172:175], v[92:95], v[104:107]
    ds_read_b64_tr_b16 v[200:201], v247 offset:16384
    ds_read_b64_tr_b16 v[202:203], v247 offset:20480
    v_cvt_pk_bf16_f32 v144, v144, v145
    s_waitcnt lgkmcnt(10)
    v_mfma_f32_16x16x32_bf16 v[100:103], v[176:179], v[64:67], v[224:227]
    v_exp_f32 v149, v149
    v_mfma_f32_16x16x32_bf16 v[108:111], v[176:179], v[68:71], v[228:231]
    ds_read_b64_tr_b16 v[204:205], v248 offset:16384
    ds_read_b64_tr_b16 v[206:207], v248 offset:20480
    v_mfma_f32_16x16x32_bf16 v[100:103], v[180:183], v[72:75], v[100:103]
    v_exp_f32 v150, v150
    v_cvt_pk_bf16_f32 v145, v146, v147
    v_mfma_f32_16x16x32_bf16 v[108:111], v[180:183], v[76:79], v[108:111]
    ds_read_b64_tr_b16 v[208:209], v249 offset:16384
    ds_read_b64_tr_b16 v[210:211], v249 offset:20480
    s_waitcnt lgkmcnt(12)
    v_mfma_f32_16x16x32_bf16 v[100:103], v[184:187], v[80:83], v[100:103]
    v_exp_f32 v151, v151
    v_mfma_f32_16x16x32_bf16 v[108:111], v[184:187], v[84:87], v[108:111]
    ds_read_b64_tr_b16 v[212:213], v250 offset:16384
    ds_read_b64_tr_b16 v[214:215], v250 offset:20480
    v_cvt_pk_bf16_f32 v146, v148, v149
    v_mfma_f32_16x16x32_bf16 v[100:103], v[188:191], v[88:91], v[100:103]
    v_exp_f32 v152, v152
    v_mfma_f32_16x16x32_bf16 v[108:111], v[188:191], v[92:95], v[108:111]
    ds_read_b64_tr_b16 v[216:217], v251 offset:16384
    s_waitcnt lgkmcnt(14)
    ds_read_b64_tr_b16 v[218:219], v251 offset:20480
    v_mfma_f32_16x16x32_bf16 v[236:239], v[220:223], v[128:131], v[236:239]
    v_exp_f32 v153, v153
    v_cvt_pk_bf16_f32 v147, v150, v151
    v_mfma_f32_16x16x32_bf16 v[232:235], v[220:223], v[136:139], v[232:235]
    v_cvt_pk_bf16_f32 v152, v152, v153
    s_waitcnt lgkmcnt(12)
    v_mfma_f32_16x16x32_bf16 v[0:3], v[160:163], v[128:131], v[0:3]
    v_exp_f32 v154, v154
    v_mfma_f32_16x16x32_bf16 v[4:7], v[160:163], v[136:139], v[4:7]
    ds_read_b128 v[160:163], v240 offset:40960
    v_max3_f32 v116, v96, v97, v98
    v_max3_f32 v117, v100, v101, v102
    v_mfma_f32_16x16x32_bf16 v[8:11], v[192:195], v[128:131], v[8:11]
    ds_read_b128 v[164:167], v241 offset:40960
    v_max3_f32 v116, v116, v99, v104
    v_mfma_f32_16x16x32_bf16 v[12:15], v[192:195], v[136:139], v[12:15]
    v_max3_f32 v117, v117, v103, v108
    s_waitcnt lgkmcnt(10)
    v_mfma_f32_16x16x32_bf16 v[16:19], v[196:199], v[128:131], v[16:19]
    ds_read_b128 v[168:171], v242 offset:40960
    v_max3_f32 v116, v116, v105, v106
    v_max3_f32 v117, v117, v109, v110
    v_mfma_f32_16x16x32_bf16 v[20:23], v[196:199], v[136:139], v[20:23]
    ds_read_b128 v[172:175], v243 offset:40960
    v_max3_f32 v116, v116, v107, v111
    v_mfma_f32_16x16x32_bf16 v[24:27], v[200:203], v[128:131], v[24:27]
    v_exp_f32 v155, v155
    v_mfma_f32_16x16x32_bf16 v[28:31], v[200:203], v[136:139], v[28:31]
    ds_read_b128 v[176:179], v240 offset:45056
    v_cvt_pk_bf16_f32 v153, v154, v155
    s_waitcnt lgkmcnt(9)
    v_mfma_f32_16x16x32_bf16 v[32:35], v[204:207], v[128:131], v[32:35]
    ds_read_b128 v[180:183], v241 offset:45056
    v_max_f32 v116, v116, v117
    v_mfma_f32_16x16x32_bf16 v[36:39], v[204:207], v[136:139], v[36:39]
    v_exp_f32 v156, v156
    v_mfma_f32_16x16x32_bf16 v[40:43], v[208:211], v[128:131], v[40:43]
    ds_read_b128 v[184:187], v242 offset:45056
    v_cmp_lt_f32 vcc, s51, v116
    v_exp_f32 v157, v157
    v_mfma_f32_16x16x32_bf16 v[44:47], v[208:211], v[136:139], v[44:47]
    ds_read_b128 v[188:191], v243 offset:45056
    s_waitcnt lgkmcnt(8)
    v_mfma_f32_16x16x32_bf16 v[48:51], v[212:215], v[128:131], v[48:51]
    v_exp_f32 v158, v158
    v_mfma_f32_16x16x32_bf16 v[52:55], v[212:215], v[136:139], v[52:55]
    v_exp_f32 v159, v159
    v_mfma_f32_16x16x32_bf16 v[56:59], v[216:219], v[128:131], v[56:59]
    v_cvt_pk_bf16_f32 v154, v156, v157
    v_cvt_pk_bf16_f32 v155, v158, v159
    v_mfma_f32_16x16x32_bf16 v[60:63], v[216:219], v[136:139], v[60:63]
    s_cbranch_vccz K1_NF2
    s_call_b64 s[90:91], K1_FIX2
K1_NF2:
    s_waitcnt lgkmcnt(6)
    v_mfma_f32_16x16x32_bf16 v[112:115], v[160:163], v[64:67], v[224:227]
    v_exp_f32 v96, v96
    v_exp_f32 v97, v97
    v_mfma_f32_16x16x32_bf16 v[120:123], v[160:163], v[68:71], v[228:231]
    ds_read_b64_tr_b16 v[160:161], v244 offset:24576
    ds_read_b64_tr_b16 v[162:163], v244 offset:28672
    v_mfma_f32_16x16x32_bf16 v[112:115], v[164:167], v[72:75], v[112:115]
    v_exp_f32 v98, v98
    v_mfma_f32_16x16x32_bf16 v[120:123], v[164:167], v[76:79], v[120:123]
    ds_read_b64_tr_b16 v[192:193], v245 offset:24576
    ds_read_b64_tr_b16 v[194:195], v245 offset:28672
    s_waitcnt lgkmcnt(8)
    v_mfma_f32_16x16x32_bf16 v[112:115], v[168:171], v[80:83], v[112:115]
    v_exp_f32 v99, v99
    v_cvt_pk_bf16_f32 v96, v96, v97
    v_mfma_f32_16x16x32_bf16 v[120:123], v[168:171], v[84:87], v[120:123]
    ds_read_b64_tr_b16 v[196:197], v246 offset:24576
    ds_read_b64_tr_b16 v[198:199], v246 offset:28672
    v_mfma_f32_16x16x32_bf16 v[112:115], v[172:175], v[88:91], v[112:115]
    v_exp_f32 v100, v100
    v_cvt_pk_bf16_f32 v97, v98, v99
    v_mfma_f32_16x16x32_bf16 v[120:123], v[172:175], v[92:95], v[120:123]
    ds_read_b64_tr_b16 v[200:201], v247 offset:24576
    ds_read_b64_tr_b16 v[202:203], v247 offset:28672
    s_waitcnt lgkmcnt(10)
    v_mfma_f32_16x16x32_bf16 v[116:119], v[176:179], v[64:67], v[224:227]
    v_exp_f32 v101, v101
    v_exp_f32 v102, v102
    v_mfma_f32_16x16x32_bf16 v[124:127], v[176:179], v[68:71], v[228:231]
    ds_read_b64_tr_b16 v[204:205], v248 offset:24576
    ds_read_b64_tr_b16 v[206:207], v248 offset:28672
    v_mfma_f32_16x16x32_bf16 v[116:119], v[180:183], v[72:75], v[116:119]
    v_exp_f32 v103, v103
    v_mfma_f32_16x16x32_bf16 v[124:127], v[180:183], v[76:79], v[124:127]
    ds_read_b64_tr_b16 v[208:209], v249 offset:24576
    ds_read_b64_tr_b16 v[210:211], v249 offset:28672
    s_waitcnt lgkmcnt(12)
    v_mfma_f32_16x16x32_bf16 v[116:119], v[184:187], v[80:83], v[116:119]
    v_exp_f32 v104, v104
    v_cvt_pk_bf16_f32 v98, v100, v101
    v_mfma_f32_16x16x32_bf16 v[124:127], v[184:187], v[84:87], v[124:127]
    ds_read_b64_tr_b16 v[212:213], v250 offset:24576
    ds_read_b64_tr_b16 v[214:215], v250 offset:28672
    v_mfma_f32_16x16x32_bf16 v[116:119], v[188:191], v[88:91], v[116:119]
    v_exp_f32 v105, v105
    v_cvt_pk_bf16_f32 v99, v102, v103
    v_mfma_f32_16x16x32_bf16 v[124:127], v[188:191], v[92:95], v[124:127]
    ds_read_b64_tr_b16 v[216:217], v251 offset:24576
    s_waitcnt lgkmcnt(14)
    ds_read_b64_tr_b16 v[218:219], v251 offset:28672
    v_mfma_f32_16x16x32_bf16 v[236:239], v[220:223], v[144:147], v[236:239]
    v_exp_f32 v106, v106
    v_mfma_f32_16x16x32_bf16 v[232:235], v[220:223], v[152:155], v[232:235]
    v_cvt_pk_bf16_f32 v104, v104, v105
    v_max3_f32 v132, v112, v113, v114
    s_waitcnt lgkmcnt(12)
    v_mfma_f32_16x16x32_bf16 v[0:3], v[160:163], v[144:147], v[0:3]
    v_exp_f32 v107, v107
    v_mfma_f32_16x16x32_bf16 v[4:7], v[160:163], v[152:155], v[4:7]
    v_exp_f32 v108, v108
    v_cvt_pk_bf16_f32 v105, v106, v107
    v_mfma_f32_16x16x32_bf16 v[8:11], v[192:195], v[144:147], v[8:11]
    ds_read_b32 v134, v254
    v_max3_f32 v133, v116, v117, v118
    v_mfma_f32_16x16x32_bf16 v[12:15], v[192:195], v[152:155], v[12:15]
    v_max3_f32 v132, v132, v115, v120
    v_max3_f32 v133, v133, v119, v124
    s_waitcnt lgkmcnt(9)
    v_mfma_f32_16x16x32_bf16 v[16:19], v[196:199], v[144:147], v[16:19]
    s_add_u32 s44, s44, 1
    v_mov_b32 v135, s44
    v_mfma_f32_16x16x32_bf16 v[20:23], v[196:199], v[152:155], v[20:23]
    v_max3_f32 v132, v132, v121, v122
    v_max3_f32 v133, v133, v125, v126
    s_waitcnt lgkmcnt(0)
    v_mfma_f32_16x16x32_bf16 v[24:27], v[200:203], v[144:147], v[24:27]
    ds_write_b32 v254, v135 offset:4
    v_cmp_gt_u32 vcc, s44, v134
    v_mfma_f32_16x16x32_bf16 v[28:31], v[200:203], v[152:155], v[28:31]
    s_cbranch_vccz K1_NW1
    s_call_b64 s[90:91], K1_WR1
K1_NW1:
    ds_read_b128 v[160:163], v240 offset:49152
    v_max3_f32 v132, v132, v123, v127
    v_mfma_f32_16x16x32_bf16 v[32:35], v[204:207], v[144:147], v[32:35]
    ds_read_b128 v[164:167], v241 offset:49152
    v_max_f32 v132, v132, v133
    v_mfma_f32_16x16x32_bf16 v[36:39], v[204:207], v[152:155], v[36:39]
    ds_read_b128 v[168:171], v242 offset:49152
    v_cmp_lt_f32 vcc, s51, v132
    v_exp_f32 v109, v109
    v_mfma_f32_16x16x32_bf16 v[40:43], v[208:211], v[144:147], v[40:43]
    ds_read_b128 v[172:175], v243 offset:49152
    v_cvt_pk_bf16_f32 v106, v108, v109
    v_mfma_f32_16x16x32_bf16 v[44:47], v[208:211], v[152:155], v[44:47]
    ds_read_b128 v[176:179], v240 offset:53248
    v_exp_f32 v110, v110
    v_mfma_f32_16x16x32_bf16 v[48:51], v[212:215], v[144:147], v[48:51]
    ds_read_b128 v[180:183], v241 offset:53248
    v_exp_f32 v111, v111
    v_mfma_f32_16x16x32_bf16 v[52:55], v[212:215], v[152:155], v[52:55]
    ds_read_b128 v[184:187], v242 offset:53248
    v_cvt_pk_bf16_f32 v107, v110, v111
    v_mfma_f32_16x16x32_bf16 v[56:59], v[216:219], v[144:147], v[56:59]
    ds_read_b128 v[188:191], v243 offset:53248
    v_mfma_f32_16x16x32_bf16 v[60:63], v[216:219], v[152:155], v[60:63]
    s_cbranch_vccz K1_NF3
    s_call_b64 s[90:91], K1_FIX3
K1_NF3:
    s_waitcnt lgkmcnt(6)
    v_mfma_f32_16x16x32_bf16 v[128:131], v[160:163], v[64:67], v[224:227]
    v_exp_f32 v112, v112
    v_mfma_f32_16x16x32_bf16 v[136:139], v[160:163], v[68:71], v[228:231]
    ds_read_b64_tr_b16 v[160:161], v244 offset:32768
    ds_read_b64_tr_b16 v[162:163], v244 offset:36864
    v_exp_f32 v113, v113
    v_mfma_f32_16x16x32_bf16 v[128:131], v[164:167], v[72:75], v[128:131]
    v_exp_f32 v114, v114
    v_mfma_f32_16x16x32_bf16 v[136:139], v[164:167], v[76:79], v[136:139]
    ds_read_b64_tr_b16 v[192:193], v245 offset:32768
    ds_read_b64_tr_b16 v[194:195], v245 offset:36864
    s_waitcnt lgkmcnt(8)
    v_mfma_f32_16x16x32_bf16 v[128:131], v[168:171], v[80:83], v[128:131]
    v_exp_f32 v115, v115
    v_mfma_f32_16x16x32_bf16 v[136:139], v[168:171], v[84:87], v[136:139]
    ds_read_b64_tr_b16 v[196:197], v246 offset:32768
    ds_read_b64_tr_b16 v[198:199], v246 offset:36864
    v_mfma_f32_16x16x32_bf16 v[128:131], v[172:175], v[88:91], v[128:131]
    v_exp_f32 v116, v116
    v_mfma_f32_16x16x32_bf16 v[136:139], v[172:175], v[92:95], v[136:139]
    ds_read_b64_tr_b16 v[200:201], v247 offset:32768
    ds_read_b64_tr_b16 v[202:203], v247 offset:36864
    v_cvt_pk_bf16_f32 v112, v112, v113
    s_waitcnt lgkmcnt(10)
    v_mfma_f32_16x16x32_bf16 v[132:135], v[176:179], v[64:67], v[224:227]
    v_exp_f32 v117, v117
    v_mfma_f32_16x16x32_bf16 v[140:143], v[176:179], v[68:71], v[228:231]
    ds_read_b64_tr_b16 v[204:205], v248 offset:32768
    ds_read_b64_tr_b16 v[206:207], v248 offset:36864
    v_mfma_f32_16x16x32_bf16 v[132:135], v[180:183], v[72:75], v[132:135]
    v_exp_f32 v118, v118
    v_cvt_pk_bf16_f32 v113, v114, v115
    v_mfma_f32_16x16x32_bf16 v[140:143], v[180:183], v[76:79], v[140:143]
    ds_read_b64_tr_b16 v[208:209], v249 offset:32768
    ds_read_b64_tr_b16 v[210:211], v249 offset:36864
    s_waitcnt lgkmcnt(12)
    v_mfma_f32_16x16x32_bf16 v[132:135], v[184:187], v[80:83], v[132:135]
    v_exp_f32 v119, v119
    v_mfma_f32_16x16x32_bf16 v[140:143], v[184:187], v[84:87], v[140:143]
    ds_read_b64_tr_b16 v[212:213], v250 offset:32768
    ds_read_b64_tr_b16 v[214:215], v250 offset:36864
    v_cvt_pk_bf16_f32 v114, v116, v117
    v_mfma_f32_16x16x32_bf16 v[132:135], v[188:191], v[88:91], v[132:135]
    v_exp_f32 v120, v120
    v_mfma_f32_16x16x32_bf16 v[140:143], v[188:191], v[92:95], v[140:143]
    ds_read_b64_tr_b16 v[216:217], v251 offset:32768
    s_waitcnt lgkmcnt(14)
    ds_read_b64_tr_b16 v[218:219], v251 offset:36864
    v_mfma_f32_16x16x32_bf16 v[236:239], v[220:223], v[96:99], v[236:239]
    v_exp_f32 v121, v121
    v_cvt_pk_bf16_f32 v115, v118, v119
    v_mfma_f32_16x16x32_bf16 v[232:235], v[220:223], v[104:107], v[232:235]
    v_cvt_pk_bf16_f32 v120, v120, v121
    s_waitcnt lgkmcnt(12)
    v_mfma_f32_16x16x32_bf16 v[0:3], v[160:163], v[96:99], v[0:3]
    v_exp_f32 v122, v122
    v_mfma_f32_16x16x32_bf16 v[4:7], v[160:163], v[104:107], v[4:7]
    ds_read_b128 v[160:163], v240 offset:57344
    v_max3_f32 v148, v128, v129, v130
    v_max3_f32 v149, v132, v133, v134
    v_mfma_f32_16x16x32_bf16 v[8:11], v[192:195], v[96:99], v[8:11]
    ds_read_b128 v[164:167], v241 offset:57344
    v_max3_f32 v148, v148, v131, v136
    v_mfma_f32_16x16x32_bf16 v[12:15], v[192:195], v[104:107], v[12:15]
    v_max3_f32 v149, v149, v135, v140
    s_waitcnt lgkmcnt(10)
    v_mfma_f32_16x16x32_bf16 v[16:19], v[196:199], v[96:99], v[16:19]
    ds_read_b128 v[168:171], v242 offset:57344
    v_max3_f32 v148, v148, v137, v138
    v_max3_f32 v149, v149, v141, v142
    v_mfma_f32_16x16x32_bf16 v[20:23], v[196:199], v[104:107], v[20:23]
    ds_read_b128 v[172:175], v243 offset:57344
    v_max3_f32 v148, v148, v139, v143
    v_mfma_f32_16x16x32_bf16 v[24:27], v[200:203], v[96:99], v[24:27]
    v_exp_f32 v123, v123
    v_mfma_f32_16x16x32_bf16 v[28:31], v[200:203], v[104:107], v[28:31]
    ds_read_b128 v[176:179], v240 offset:61440
    v_cvt_pk_bf16_f32 v121, v122, v123
    s_waitcnt lgkmcnt(9)
    v_mfma_f32_16x16x32_bf16 v[32:35], v[204:207], v[96:99], v[32:35]
    ds_read_b128 v[180:183], v241 offset:61440
    v_max_f32 v148, v148, v149
    v_mfma_f32_16x16x32_bf16 v[36:39], v[204:207], v[104:107], v[36:39]
    v_exp_f32 v124, v124
    v_mfma_f32_16x16x32_bf16 v[40:43], v[208:211], v[96:99], v[40:43]
    ds_read_b128 v[184:187], v242 offset:61440
    v_cmp_lt_f32 vcc, s51, v148
    v_exp_f32 v125, v125
    v_mfma_f32_16x16x32_bf16 v[44:47], v[208:211], v[104:107], v[44:47]
    ds_read_b128 v[188:191], v243 offset:61440
    s_waitcnt lgkmcnt(8)
    v_mfma_f32_16x16x32_bf16 v[48:51], v[212:215], v[96:99], v[48:51]
    v_exp_f32 v126, v126
    v_mfma_f32_16x16x32_bf16 v[52:55], v[212:215], v[104:107], v[52:55]
    v_exp_f32 v127, v127
    v_mfma_f32_16x16x32_bf16 v[56:59], v[216:219], v[96:99], v[56:59]
    v_cvt_pk_bf16_f32 v122, v124, v125
    v_cvt_pk_bf16_f32 v123, v126, v127
    v_mfma_f32_16x16x32_bf16 v[60:63], v[216:219], v[104:107], v[60:63]
    s_cbranch_vccz K1_NF4
    s_call_b64 s[90:91], K1_FIX0
K1_NF4:
    s_waitcnt lgkmcnt(6)
    v_mfma_f32_16x16x32_bf16 v[144:147], v[160:163], v[64:67], v[224:227]
    v_exp_f32 v128, v128
    v_exp_f32 v129, v129
    v_mfma_f32_16x16x32_bf16 v[152:155], v[160:163], v[68:71], v[228:231]
    ds_read_b64_tr_b16 v[160:161], v244 offset:40960
    ds_read_b64_tr_b16 v[162:163], v244 offset:45056
    v_mfma_f32_16x16x32_bf16 v[144:147], v[164:167], v[72:75], v[144:147]
    v_exp_f32 v130, v130
    v_mfma_f32_16x16x32_bf16 v[152:155], v[164:167], v[76:79], v[152:155]
    ds_read_b64_tr_b16 v[192:193], v245 offset:40960
    ds_read_b64_tr_b16 v[194:195], v245 offset:45056
    s_waitcnt lgkmcnt(8)
    v_mfma_f32_16x16x32_bf16 v[144:147], v[168:171], v[80:83], v[144:147]
    v_exp_f32 v131, v131
    v_cvt_pk_bf16_f32 v128, v128, v129
    v_mfma_f32_16x16x32_bf16 v[152:155], v[168:171], v[84:87], v[152:155]
    ds_read_b64_tr_b16 v[196:197], v246 offset:40960
    ds_read_b64_tr_b16 v[198:199], v246 offset:45056
    v_mfma_f32_16x16x32_bf16 v[144:147], v[172:175], v[88:91], v[144:147]
    v_exp_f32 v132, v132
    v_cvt_pk_bf16_f32 v129, v130, v131
    v_mfma_f32_16x16x32_bf16 v[152:155], v[172:175], v[92:95], v[152:155]
    ds_read_b64_tr_b16 v[200:201], v247 offset:40960
    ds_read_b64_tr_b16 v[202:203], v247 offset:45056
    s_waitcnt lgkmcnt(10)
    v_mfma_f32_16x16x32_bf16 v[148:151], v[176:179], v[64:67], v[224:227]
    v_exp_f32 v133, v133
    v_exp_f32 v134, v134
    v_mfma_f32_16x16x32_bf16 v[156:159], v[176:179], v[68:71], v[228:231]
    ds_read_b64_tr_b16 v[204:205], v248 offset:40960
    ds_read_b64_tr_b16 v[206:207], v248 offset:45056
    v_mfma_f32_16x16x32_bf16 v[148:151], v[180:183], v[72:75], v[148:151]
    v_exp_f32 v135, v135
    v_mfma_f32_16x16x32_bf16 v[156:159], v[180:183], v[76:79], v[156:159]
    ds_read_b64_tr_b16 v[208:209], v249 offset:40960
    ds_read_b64_tr_b16 v[210:211], v249 offset:45056
    s_waitcnt lgkmcnt(12)
    v_mfma_f32_16x16x32_bf16 v[148:151], v[184:187], v[80:83], v[148:151]
    v_exp_f32 v136, v136
    v_cvt_pk_bf16_f32 v130, v132, v133
    v_mfma_f32_16x16x32_bf16 v[156:159], v[184:187], v[84:87], v[156:159]
    ds_read_b64_tr_b16 v[212:213], v250 offset:40960
    ds_read_b64_tr_b16 v[214:215], v250 offset:45056
    v_mfma_f32_16x16x32_bf16 v[148:151], v[188:191], v[88:91], v[148:151]
    v_exp_f32 v137, v137
    v_cvt_pk_bf16_f32 v131, v134, v135
    v_mfma_f32_16x16x32_bf16 v[156:159], v[188:191], v[92:95], v[156:159]
    ds_read_b64_tr_b16 v[216:217], v251 offset:40960
    s_waitcnt lgkmcnt(14)
    ds_read_b64_tr_b16 v[218:219], v251 offset:45056
    v_mfma_f32_16x16x32_bf16 v[236:239], v[220:223], v[112:115], v[236:239]
    v_exp_f32 v138, v138
    v_mfma_f32_16x16x32_bf16 v[232:235], v[220:223], v[120:123], v[232:235]
    v_cvt_pk_bf16_f32 v136, v136, v137
    v_max3_f32 v100, v144, v145, v146
    s_waitcnt lgkmcnt(12)
    v_mfma_f32_16x16x32_bf16 v[0:3], v[160:163], v[112:115], v[0:3]
    v_exp_f32 v139, v139
    v_mfma_f32_16x16x32_bf16 v[4:7], v[160:163], v[120:123], v[4:7]
    v_exp_f32 v140, v140
    v_cvt_pk_bf16_f32 v137, v138, v139
    v_mfma_f32_16x16x32_bf16 v[8:11], v[192:195], v[112:115], v[8:11]
    ds_read_b32 v102, v254
    v_max3_f32 v101, v148, v149, v150
    v_mfma_f32_16x16x32_bf16 v[12:15], v[192:195], v[120:123], v[12:15]
    v_max3_f32 v100, v100, v147, v152
    v_max3_f32 v101, v101, v151, v156
    s_waitcnt lgkmcnt(9)
    v_mfma_f32_16x16x32_bf16 v[16:19], v[196:199], v[112:115], v[16:19]
    s_add_u32 s44, s44, 1
    v_mov_b32 v103, s44
    v_mfma_f32_16x16x32_bf16 v[20:23], v[196:199], v[120:123], v[20:23]
    v_max3_f32 v100, v100, v153, v154
    v_max3_f32 v101, v101, v157, v158
    s_waitcnt lgkmcnt(0)
    v_mfma_f32_16x16x32_bf16 v[24:27], v[200:203], v[112:115], v[24:27]
    ds_write_b32 v254, v103 offset:4
    v_cmp_gt_u32 vcc, s44, v102
    v_mfma_f32_16x16x32_bf16 v[28:31], v[200:203], v[120:123], v[28:31]
    s_cbranch_vccz K1_NW2
    s_call_b64 s[90:91], K1_WR0
K1_NW2:
    ds_read_b128 v[160:163], v240 offset:0
    v_max3_f32 v100, v100, v155, v159
    v_mfma_f32_16x16x32_bf16 v[32:35], v[204:207], v[112:115], v[32:35]
    ds_read_b128 v[164:167], v241 offset:0
    v_max_f32 v100, v100, v101
    v_mfma_f32_16x16x32_bf16 v[36:39], v[204:207], v[120:123], v[36:39]
    ds_read_b128 v[168:171], v242 offset:0
    v_cmp_lt_f32 vcc, s51, v100
    v_exp_f32 v141, v141
    v_mfma_f32_16x16x32_bf16 v[40:43], v[208:211], v[112:115], v[40:43]
    ds_read_b128 v[172:175], v243 offset:0
    v_cvt_pk_bf16_f32 v138, v140, v141
    v_mfma_f32_16x16x32_bf16 v[44:47], v[208:211], v[120:123], v[44:47]
    ds_read_b128 v[176:179], v240 offset:4096
    v_exp_f32 v142, v142
    v_mfma_f32_16x16x32_bf16 v[48:51], v[212:215], v[112:115], v[48:51]
    ds_read_b128 v[180:183], v241 offset:4096
    v_exp_f32 v143, v143
    v_mfma_f32_16x16x32_bf16 v[52:55], v[212:215], v[120:123], v[52:55]
    ds_read_b128 v[184:187], v242 offset:4096
    v_cvt_pk_bf16_f32 v139, v142, v143
    v_mfma_f32_16x16x32_bf16 v[56:59], v[216:219], v[112:115], v[56:59]
    ds_read_b128 v[188:191], v243 offset:4096
    v_mfma_f32_16x16x32_bf16 v[60:63], v[216:219], v[120:123], v[60:63]
    s_cbranch_vccz K1_NF5
    s_call_b64 s[90:91], K1_FIX1
K1_NF5:
    s_cmp_eq_u32 s44, 15
    s_cbranch_scc1 K1_LAST
    s_waitcnt lgkmcnt(6)
    v_mfma_f32_16x16x32_bf16 v[96:99], v[160:163], v[64:67], v[224:227]
    v_exp_f32 v144, v144
    v_mfma_f32_16x16x32_bf16 v[104:107], v[160:163], v[68:71], v[228:231]
    ds_read_b64_tr_b16 v[160:161], v244 offset:49152
    ds_read_b64_tr_b16 v[162:163], v244 offset:53248
    v_exp_f32 v145, v145
    v_mfma_f32_16x16x32_bf16 v[96:99], v[164:167], v[72:75], v[96:99]
    v_exp_f32 v146, v146
    v_mfma_f32_16x16x32_bf16 v[104:107], v[164:167], v[76:79], v[104:107]
    ds_read_b64_tr_b16 v[192:193], v245 offset:49152
    ds_read_b64_tr_b16 v[194:195], v245 offset:53248
    s_waitcnt lgkmcnt(8)
    v_mfma_f32_16x16x32_bf16 v[96:99], v[168:171], v[80:83], v[96:99]
    v_exp_f32 v147, v147
    v_mfma_f32_16x16x32_bf16 v[104:107], v[168:171], v[84:87], v[104:107]
    ds_read_b64_tr_b16 v[196:197], v246 offset:49152
    ds_read_b64_tr_b16 v[198:199], v246 offset:53248
    v_mfma_f32_16x16x32_bf16 v[96:99], v[172:175], v[88:91], v[96:99]
    v_exp_f32 v148, v148
    v_mfma_f32_16x16x32_bf16 v[104:107], v[172:175], v[92:95], v[104:107]
    ds_read_b64_tr_b16 v[200:201], v247 offset:49152
    ds_read_b64_tr_b16 v[202:203], v247 offset:53248
    v_cvt_pk_bf16_f32 v144, v144, v145
    s_waitcnt lgkmcnt(10)
    v_mfma_f32_16x16x32_bf16 v[100:103], v[176:179], v[64:67], v[224:227]
    v_exp_f32 v149, v149
    v_mfma_f32_16x16x32_bf16 v[108:111], v[176:179], v[68:71], v[228:231]
    ds_read_b64_tr_b16 v[204:205], v248 offset:49152
    ds_read_b64_tr_b16 v[206:207], v248 offset:53248
    v_mfma_f32_16x16x32_bf16 v[100:103], v[180:183], v[72:75], v[100:103]
    v_exp_f32 v150, v150
    v_cvt_pk_bf16_f32 v145, v146, v147
    v_mfma_f32_16x16x32_bf16 v[108:111], v[180:183], v[76:79], v[108:111]
    ds_read_b64_tr_b16 v[208:209], v249 offset:49152
    ds_read_b64_tr_b16 v[210:211], v249 offset:53248
    s_waitcnt lgkmcnt(12)
    v_mfma_f32_16x16x32_bf16 v[100:103], v[184:187], v[80:83], v[100:103]
    v_exp_f32 v151, v151
    v_mfma_f32_16x16x32_bf16 v[108:111], v[184:187], v[84:87], v[108:111]
    ds_read_b64_tr_b16 v[212:213], v250 offset:49152
    ds_read_b64_tr_b16 v[214:215], v250 offset:53248
    v_cvt_pk_bf16_f32 v146, v148, v149
    v_mfma_f32_16x16x32_bf16 v[100:103], v[188:191], v[88:91], v[100:103]
    v_exp_f32 v152, v152
    v_mfma_f32_16x16x32_bf16 v[108:111], v[188:191], v[92:95], v[108:111]
    ds_read_b64_tr_b16 v[216:217], v251 offset:49152
    s_waitcnt lgkmcnt(14)
    ds_read_b64_tr_b16 v[218:219], v251 offset:53248
    v_mfma_f32_16x16x32_bf16 v[236:239], v[220:223], v[128:131], v[236:239]
    v_exp_f32 v153, v153
    v_cvt_pk_bf16_f32 v147, v150, v151
    v_mfma_f32_16x16x32_bf16 v[232:235], v[220:223], v[136:139], v[232:235]
    v_cvt_pk_bf16_f32 v152, v152, v153
    s_waitcnt lgkmcnt(12)
    v_mfma_f32_16x16x32_bf16 v[0:3], v[160:163], v[128:131], v[0:3]
    v_exp_f32 v154, v154
    v_mfma_f32_16x16x32_bf16 v[4:7], v[160:163], v[136:139], v[4:7]
    ds_read_b128 v[160:163], v240 offset:8192
    v_max3_f32 v116, v96, v97, v98
    v_max3_f32 v117, v100, v101, v102
    v_mfma_f32_16x16x32_bf16 v[8:11], v[192:195], v[128:131], v[8:11]
    ds_read_b128 v[164:167], v241 offset:8192
    v_max3_f32 v116, v116, v99, v104
    v_mfma_f32_16x16x32_bf16 v[12:15], v[192:195], v[136:139], v[12:15]
    v_max3_f32 v117, v117, v103, v108
    s_waitcnt lgkmcnt(10)
    v_mfma_f32_16x16x32_bf16 v[16:19], v[196:199], v[128:131], v[16:19]
    ds_read_b128 v[168:171], v242 offset:8192
    v_max3_f32 v116, v116, v105, v106
    v_max3_f32 v117, v117, v109, v110
    v_mfma_f32_16x16x32_bf16 v[20:23], v[196:199], v[136:139], v[20:23]
    ds_read_b128 v[172:175], v243 offset:8192
    v_max3_f32 v116, v116, v107, v111
    v_mfma_f32_16x16x32_bf16 v[24:27], v[200:203], v[128:131], v[24:27]
    v_exp_f32 v155, v155
    v_mfma_f32_16x16x32_bf16 v[28:31], v[200:203], v[136:139], v[28:31]
    ds_read_b128 v[176:179], v240 offset:12288
    v_cvt_pk_bf16_f32 v153, v154, v155
    s_waitcnt lgkmcnt(9)
    v_mfma_f32_16x16x32_bf16 v[32:35], v[204:207], v[128:131], v[32:35]
    ds_read_b128 v[180:183], v241 offset:12288
    v_max_f32 v116, v116, v117
    v_mfma_f32_16x16x32_bf16 v[36:39], v[204:207], v[136:139], v[36:39]
    v_exp_f32 v156, v156
    v_mfma_f32_16x16x32_bf16 v[40:43], v[208:211], v[128:131], v[40:43]
    ds_read_b128 v[184:187], v242 offset:12288
    v_cmp_lt_f32 vcc, s51, v116
    v_exp_f32 v157, v157
    v_mfma_f32_16x16x32_bf16 v[44:47], v[208:211], v[136:139], v[44:47]
    ds_read_b128 v[188:191], v243 offset:12288
    s_waitcnt lgkmcnt(8)
    v_mfma_f32_16x16x32_bf16 v[48:51], v[212:215], v[128:131], v[48:51]
    v_exp_f32 v158, v158
    v_mfma_f32_16x16x32_bf16 v[52:55], v[212:215], v[136:139], v[52:55]
    v_exp_f32 v159, v159
    v_mfma_f32_16x16x32_bf16 v[56:59], v[216:219], v[128:131], v[56:59]
    v_cvt_pk_bf16_f32 v154, v156, v157
    v_cvt_pk_bf16_f32 v155, v158, v159
    v_mfma_f32_16x16x32_bf16 v[60:63], v[216:219], v[136:139], v[60:63]
    s_cbranch_vccz K1_NF6
    s_call_b64 s[90:91], K1_FIX2
K1_NF6:
    s_waitcnt lgkmcnt(6)
    v_mfma_f32_16x16x32_bf16 v[112:115], v[160:163], v[64:67], v[224:227]
    v_exp_f32 v96, v96
    v_exp_f32 v97, v97
    v_mfma_f32_16x16x32_bf16 v[120:123], v[160:163], v[68:71], v[228:231]
    ds_read_b64_tr_b16 v[160:161], v244 offset:57344
    ds_read_b64_tr_b16 v[162:163], v244 offset:61440
    v_mfma_f32_16x16x32_bf16 v[112:115], v[164:167], v[72:75], v[112:115]
    v_exp_f32 v98, v98
    v_mfma_f32_16x16x32_bf16 v[120:123], v[164:167], v[76:79], v[120:123]
    ds_read_b64_tr_b16 v[192:193], v245 offset:57344
    ds_read_b64_tr_b16 v[194:195], v245 offset:61440
    s_waitcnt lgkmcnt(8)
    v_mfma_f32_16x16x32_bf16 v[112:115], v[168:171], v[80:83], v[112:115]
    v_exp_f32 v99, v99
    v_cvt_pk_bf16_f32 v96, v96, v97
    v_mfma_f32_16x16x32_bf16 v[120:123], v[168:171], v[84:87], v[120:123]
    ds_read_b64_tr_b16 v[196:197], v246 offset:57344
    ds_read_b64_tr_b16 v[198:199], v246 offset:61440
    v_mfma_f32_16x16x32_bf16 v[112:115], v[172:175], v[88:91], v[112:115]
    v_exp_f32 v100, v100
    v_cvt_pk_bf16_f32 v97, v98, v99
    v_mfma_f32_16x16x32_bf16 v[120:123], v[172:175], v[92:95], v[120:123]
    ds_read_b64_tr_b16 v[200:201], v247 offset:57344
    ds_read_b64_tr_b16 v[202:203], v247 offset:61440
    s_waitcnt lgkmcnt(10)
    v_mfma_f32_16x16x32_bf16 v[116:119], v[176:179], v[64:67], v[224:227]
    v_exp_f32 v101, v101
    v_exp_f32 v102, v102
    v_mfma_f32_16x16x32_bf16 v[124:127], v[176:179], v[68:71], v[228:231]
    ds_read_b64_tr_b16 v[204:205], v248 offset:57344
    ds_read_b64_tr_b16 v[206:207], v248 offset:61440
    v_mfma_f32_16x16x32_bf16 v[116:119], v[180:183], v[72:75], v[116:119]
    v_exp_f32 v103, v103
    v_mfma_f32_16x16x32_bf16 v[124:127], v[180:183], v[76:79], v[124:127]
    ds_read_b64_tr_b16 v[208:209], v249 offset:57344
    ds_read_b64_tr_b16 v[210:211], v249 offset:61440
    s_waitcnt lgkmcnt(12)
    v_mfma_f32_16x16x32_bf16 v[116:119], v[184:187], v[80:83], v[116:119]
    v_exp_f32 v104, v104
    v_cvt_pk_bf16_f32 v98, v100, v101
    v_mfma_f32_16x16x32_bf16 v[124:127], v[184:187], v[84:87], v[124:127]
    ds_read_b64_tr_b16 v[212:213], v250 offset:57344
    ds_read_b64_tr_b16 v[214:215], v250 offset:61440
    v_mfma_f32_16x16x32_bf16 v[116:119], v[188:191], v[88:91], v[116:119]
    v_exp_f32 v105, v105
    v_cvt_pk_bf16_f32 v99, v102, v103
    v_mfma_f32_16x16x32_bf16 v[124:127], v[188:191], v[92:95], v[124:127]
    ds_read_b64_tr_b16 v[216:217], v251 offset:57344
    s_waitcnt lgkmcnt(14)
    ds_read_b64_tr_b16 v[218:219], v251 offset:61440
    v_mfma_f32_16x16x32_bf16 v[236:239], v[220:223], v[144:147], v[236:239]
    v_exp_f32 v106, v106
    v_mfma_f32_16x16x32_bf16 v[232:235], v[220:223], v[152:155], v[232:235]
    v_cvt_pk_bf16_f32 v104, v104, v105
    v_max3_f32 v132, v112, v113, v114
    s_waitcnt lgkmcnt(12)
    v_mfma_f32_16x16x32_bf16 v[0:3], v[160:163], v[144:147], v[0:3]
    v_exp_f32 v107, v107
    v_mfma_f32_16x16x32_bf16 v[4:7], v[160:163], v[152:155], v[4:7]
    v_exp_f32 v108, v108
    v_cvt_pk_bf16_f32 v105, v106, v107
    v_mfma_f32_16x16x32_bf16 v[8:11], v[192:195], v[144:147], v[8:11]
    ds_read_b32 v134, v254
    v_max3_f32 v133, v116, v117, v118
    v_mfma_f32_16x16x32_bf16 v[12:15], v[192:195], v[152:155], v[12:15]
    v_max3_f32 v132, v132, v115, v120
    v_max3_f32 v133, v133, v119, v124
    s_waitcnt lgkmcnt(9)
    v_mfma_f32_16x16x32_bf16 v[16:19], v[196:199], v[144:147], v[16:19]
    s_add_u32 s44, s44, 1
    v_mov_b32 v135, s44
    v_mfma_f32_16x16x32_bf16 v[20:23], v[196:199], v[152:155], v[20:23]
    v_max3_f32 v132, v132, v121, v122
    v_max3_f32 v133, v133, v125, v126
    s_waitcnt lgkmcnt(0)
    v_mfma_f32_16x16x32_bf16 v[24:27], v[200:203], v[144:147], v[24:27]
    ds_write_b32 v254, v135 offset:4
    v_cmp_gt_u32 vcc, s44, v134
    v_mfma_f32_16x16x32_bf16 v[28:31], v[200:203], v[152:155], v[28:31]
    s_cbranch_vccz K1_NW3
    s_call_b64 s[90:91], K1_WR1
K1_NW3:
    ds_read_b128 v[160:163], v240 offset:16384
    v_max3_f32 v132, v132, v123, v127
    v_mfma_f32_16x16x32_bf16 v[32:35], v[204:207], v[144:147], v[32:35]
    ds_read_b128 v[164:167], v241 offset:16384
    v_max_f32 v132, v132, v133
    v_mfma_f32_16x16x32_bf16 v[36:39], v[204:207], v[152:155], v[36:39]
    ds_read_b128 v[168:171], v242 offset:16384
    v_cmp_lt_f32 vcc, s51, v132
    v_exp_f32 v109, v109
    v_mfma_f32_16x16x32_bf16 v[40:43], v[208:211], v[144:147], v[40:43]
    ds_read_b128 v[172:175], v243 offset:16384
    v_cvt_pk_bf16_f32 v106, v108, v109
    v_mfma_f32_16x16x32_bf16 v[44:47], v[208:211], v[152:155], v[44:47]
    ds_read_b128 v[176:179], v240 offset:20480
    v_exp_f32 v110, v110
    v_mfma_f32_16x16x32_bf16 v[48:51], v[212:215], v[144:147], v[48:51]
    ds_read_b128 v[180:183], v241 offset:20480
    v_exp_f32 v111, v111
    v_mfma_f32_16x16x32_bf16 v[52:55], v[212:215], v[152:155], v[52:55]
    ds_read_b128 v[184:187], v242 offset:20480
    v_cvt_pk_bf16_f32 v107, v110, v111
    v_mfma_f32_16x16x32_bf16 v[56:59], v[216:219], v[144:147], v[56:59]
    ds_read_b128 v[188:191], v243 offset:20480
    v_mfma_f32_16x16x32_bf16 v[60:63], v[216:219], v[152:155], v[60:63]
    s_cbranch_vccz K1_NF7
    s_call_b64 s[90:91], K1_FIX3
K1_NF7:
    s_branch K1_LOOP
K1_LAST:
    v_mov_b32 v108, 16
    ds_read_b64_tr_b16 v[192:193], v244 offset:49152
    ds_read_b64_tr_b16 v[194:195], v244 offset:53248
    v_exp_f32 v144, v144
    ds_read_b64_tr_b16 v[196:197], v245 offset:49152
    ds_read_b64_tr_b16 v[198:199], v245 offset:53248
    v_exp_f32 v145, v145
    ds_read_b64_tr_b16 v[200:201], v246 offset:49152
    ds_read_b64_tr_b16 v[202:203], v246 offset:53248
    v_exp_f32 v146, v146
    ds_read_b64_tr_b16 v[204:205], v247 offset:49152
    s_waitcnt lgkmcnt(14)
    ds_read_b64_tr_b16 v[206:207], v247 offset:53248
    v_exp_f32 v147, v147
    s_waitcnt lgkmcnt(14)
    ds_read_b64_tr_b16 v[208:209], v248 offset:49152
    s_waitcnt lgkmcnt(14)
    ds_read_b64_tr_b16 v[210:211], v248 offset:53248
    v_cvt_pk_bf16_f32 v144, v144, v145
    v_cvt_pk_bf16_f32 v145, v146, v147
    s_waitcnt lgkmcnt(14)
    ds_read_b64_tr_b16 v[212:213], v249 offset:49152
    s_waitcnt lgkmcnt(14)
    ds_read_b64_tr_b16 v[214:215], v249 offset:53248
    v_exp_f32 v148, v148
    s_waitcnt lgkmcnt(14)
    ds_read_b64_tr_b16 v[216:217], v250 offset:49152
    s_waitcnt lgkmcnt(14)
    ds_read_b64_tr_b16 v[218:219], v250 offset:53248
    v_exp_f32 v149, v149
    v_mfma_f32_16x16x32_bf16 v[236:239], v[220:223], v[128:131], v[236:239]
    s_waitcnt lgkmcnt(14)
    ds_read_b64_tr_b16 v[160:161], v251 offset:49152
    s_waitcnt lgkmcnt(14)
    ds_read_b64_tr_b16 v[162:163], v251 offset:53248
    v_exp_f32 v150, v150
    v_mfma_f32_16x16x32_bf16 v[232:235], v[220:223], v[136:139], v[232:235]
    s_waitcnt lgkmcnt(14)
    ds_read_b64_tr_b16 v[164:165], v244 offset:57344
    s_waitcnt lgkmcnt(14)
    ds_read_b64_tr_b16 v[166:167], v244 offset:61440
    v_exp_f32 v151, v151
    v_mfma_f32_16x16x32_bf16 v[0:3], v[192:195], v[128:131], v[0:3]
    s_waitcnt lgkmcnt(14)
    ds_read_b64_tr_b16 v[168:169], v245 offset:57344
    s_waitcnt lgkmcnt(14)
    ds_read_b64_tr_b16 v[170:171], v245 offset:61440
    v_cvt_pk_bf16_f32 v146, v148, v149
    v_cvt_pk_bf16_f32 v147, v150, v151
    v_mfma_f32_16x16x32_bf16 v[4:7], v[192:195], v[136:139], v[4:7]
    s_waitcnt lgkmcnt(14)
    ds_read_b64_tr_b16 v[172:173], v246 offset:57344
    s_waitcnt lgkmcnt(14)
    ds_read_b64_tr_b16 v[174:175], v246 offset:61440
    v_exp_f32 v152, v152
    v_mfma_f32_16x16x32_bf16 v[8:11], v[196:199], v[128:131], v[8:11]
    s_waitcnt lgkmcnt(14)
    ds_read_b64_tr_b16 v[176:177], v247 offset:57344
    s_waitcnt lgkmcnt(14)
    ds_read_b64_tr_b16 v[178:179], v247 offset:61440
    v_exp_f32 v153, v153
    v_mfma_f32_16x16x32_bf16 v[12:15], v[196:199], v[136:139], v[12:15]
    s_waitcnt lgkmcnt(14)
    ds_read_b64_tr_b16 v[180:181], v248 offset:57344
    s_waitcnt lgkmcnt(14)
    ds_read_b64_tr_b16 v[182:183], v248 offset:61440
    v_exp_f32 v154, v154
    v_mfma_f32_16x16x32_bf16 v[16:19], v[200:203], v[128:131], v[16:19]
    s_waitcnt lgkmcnt(14)
    ds_read_b64_tr_b16 v[184:185], v249 offset:57344
    s_waitcnt lgkmcnt(14)
    ds_read_b64_tr_b16 v[186:187], v249 offset:61440
    v_exp_f32 v155, v155
    v_mfma_f32_16x16x32_bf16 v[20:23], v[200:203], v[136:139], v[20:23]
    s_waitcnt lgkmcnt(14)
    ds_read_b64_tr_b16 v[188:189], v250 offset:57344
    s_waitcnt lgkmcnt(14)
    ds_read_b64_tr_b16 v[190:191], v250 offset:61440
    v_cvt_pk_bf16_f32 v152, v152, v153
    v_cvt_pk_bf16_f32 v153, v154, v155
    v_mfma_f32_16x16x32_bf16 v[24:27], v[204:207], v[128:131], v[24:27]
    s_waitcnt lgkmcnt(14)
    ds_read_b64_tr_b16 v[124:125], v251 offset:57344
    s_waitcnt lgkmcnt(14)
    ds_read_b64_tr_b16 v[126:127], v251 offset:61440
    v_exp_f32 v156, v156
    v_mfma_f32_16x16x32_bf16 v[28:31], v[204:207], v[136:139], v[28:31]
    v_exp_f32 v157, v157
    v_mfma_f32_16x16x32_bf16 v[32:35], v[208:211], v[128:131], v[32:35]
    v_exp_f32 v158, v158
    v_mfma_f32_16x16x32_bf16 v[36:39], v[208:211], v[136:139], v[36:39]
    v_exp_f32 v159, v159
    v_mfma_f32_16x16x32_bf16 v[40:43], v[212:215], v[128:131], v[40:43]
    v_cvt_pk_bf16_f32 v154, v156, v157
    v_cvt_pk_bf16_f32 v155, v158, v159
    v_mfma_f32_16x16x32_bf16 v[44:47], v[212:215], v[136:139], v[44:47]
    s_waitcnt lgkmcnt(0)
    ds_write_b32 v254, v108 offset:4
    v_mfma_f32_16x16x32_bf16 v[48:51], v[216:219], v[128:131], v[48:51]
    v_mfma_f32_16x16x32_bf16 v[52:55], v[216:219], v[136:139], v[52:55]
    v_mfma_f32_16x16x32_bf16 v[56:59], v[160:163], v[128:131], v[56:59]
    v_mfma_f32_16x16x32_bf16 v[60:63], v[160:163], v[136:139], v[60:63]
    s_buffer_load_dword s12, s[36:39], s78 glc
    v_mfma_f32_16x16x32_bf16 v[236:239], v[220:223], v[144:147], v[236:239]
    v_lshlrev_b32 v229, 4, v255
    s_lshl_b32 s46, s77, 17
    v_add_u32 v230, s46, v229
    v_mfma_f32_16x16x32_bf16 v[232:235], v[220:223], v[152:155], v[232:235]
    v_xor_b32 v229, 0x20000, v230
    s_lshl_b32 s49, s42, 20
    s_lshl_b32 s46, s40, 18
    s_add_u32 s49, s49, s46
    s_lshl_b32 s46, s41, 12
    s_add_u32 s49, s49, s46
    v_mfma_f32_16x16x32_bf16 v[0:3], v[164:167], v[144:147], v[0:3]
    v_mfma_f32_16x16x32_bf16 v[4:7], v[164:167], v[152:155], v[4:7]
    v_mfma_f32_16x16x32_bf16 v[8:11], v[168:171], v[144:147], v[8:11]
    v_mfma_f32_16x16x32_bf16 v[12:15], v[168:171], v[152:155], v[12:15]
    v_rcp_f32 v252, v239
    v_mfma_f32_16x16x32_bf16 v[16:19], v[172:175], v[144:147], v[16:19]
    v_rcp_f32 v253, v235
    v_mfma_f32_16x16x32_bf16 v[20:23], v[172:175], v[152:155], v[20:23]
    s_lshl_b32 s47, s42, 20
    v_mul_f32 v0, v252, v0
    s_lshl_b32 s46, s76, 18
    v_mul_f32 v1, v252, v1
    v_mfma_f32_16x16x32_bf16 v[24:27], v[176:179], v[144:147], v[24:27]
    s_add_u32 s47, s47, s46
    v_cvt_pk_bf16_f32 v96, v0, v1
    s_lshl_b32 s46, s56, 15
    v_mul_f32 v2, v252, v2
    v_mfma_f32_16x16x32_bf16 v[28:31], v[176:179], v[152:155], v[28:31]
    s_add_u32 s47, s47, s46
    v_mul_f32 v3, v252, v3
    s_lshl_b32 s46, s10, 14
    v_cvt_pk_bf16_f32 v97, v2, v3
    v_mfma_f32_16x16x32_bf16 v[32:35], v[180:183], v[144:147], v[32:35]
    s_add_u32 s47, s47, s46
    v_mul_f32 v8, v252, v8
    s_mov_b32 s83, 0
    v_mul_f32 v9, v252, v9
    v_mfma_f32_16x16x32_bf16 v[36:39], v[180:183], v[152:155], v[36:39]
    s_mov_b32 s85, 0
    v_cvt_pk_bf16_f32 v98, v8, v9
    s_mov_b32 s86, -1
    v_mul_f32 v10, v252, v10
    v_mfma_f32_16x16x32_bf16 v[40:43], v[184:187], v[144:147], v[40:43]
    s_mov_b32 s8, 1
    v_mul_f32 v11, v252, v11
    v_lshrrev_b32 v231, 2, v255
    v_mfma_f32_16x16x32_bf16 v[44:47], v[184:187], v[152:155], v[44:47]
    v_mul_u32_u24 v231, 160, v231
    v_cvt_pk_bf16_f32 v99, v10, v11
    v_mfma_f32_16x16x32_bf16 v[48:51], v[188:191], v[144:147], v[48:51]
    v_and_b32 v232, 3, v255
    buffer_store_dwordx4 v[96:99], v230, s[36:39], s49 offen offset:0 sc1
    v_mfma_f32_16x16x32_bf16 v[52:55], v[188:191], v[152:155], v[52:55]
    v_lshl_add_u32 v231, v232, 3, v231
    v_mul_f32 v4, v253, v4
    v_mfma_f32_16x16x32_bf16 v[56:59], v[124:127], v[144:147], v[56:59]
    v_lshlrev_b32 v234, 13, v255
    v_mul_f32 v5, v253, v5
    v_mfma_f32_16x16x32_bf16 v[60:63], v[124:127], v[152:155], v[60:63]
    v_and_b32 v228, 31, v255
    v_cvt_pk_bf16_f32 v100, v4, v5
    v_lshlrev_b32 v228, 7, v228
    v_mul_f32 v6, v253, v6
    v_lshrrev_b32 v227, 5, v255
    v_mul_f32 v7, v253, v7
    v_lshl_add_u32 v228, v227, 17, v228
    v_cvt_pk_bf16_f32 v101, v6, v7
    s_mov_b32 s4, 0
    v_mul_f32 v12, v253, v12
    s_mul_i32 s46, s10, 81920
    v_mul_f32 v13, v253, v13
    v_add_u32 v231, s46, v231
    v_cvt_pk_bf16_f32 v102, v12, v13
    s_and_b32 s80, s57, 3
    v_mul_f32 v14, v253, v14
    s_mov_b32 s6, 0
    v_mul_f32 v15, v253, v15
    s_andn2_b32 s86, s86, 0x80
    v_cvt_pk_bf16_f32 v103, v14, v15
    s_mov_b32 s81, 1
    buffer_store_dwordx4 v[100:103], v229, s[36:39], s49 offen offset:0 sc1
    s_mov_b32 s82, 1
    v_mul_f32 v16, v252, v16
    s_lshl_b32 s84, 1, s80
    v_mul_f32 v17, v252, v17
    s_mov_b32 s11, 1
    v_cvt_pk_bf16_f32 v104, v16, v17
    s_lshl_b32 s13, s42, 5
    v_mul_f32 v18, v252, v18
    s_lshl_b32 s46, s56, 3
    v_mul_f32 v19, v252, v19
    s_add_u32 s13, s13, s46
    v_cvt_pk_bf16_f32 v105, v18, v19
    s_lshl_b32 s13, s13, 13
    v_mul_f32 v24, v252, v24
    s_lshl_b32 s46, s10, 9
    v_mul_f32 v25, v252, v25
    s_add_u32 s13, s13, s46
    v_cvt_pk_bf16_f32 v106, v24, v25
    s_lshl_b32 s46, s76, 10
    v_mul_f32 v26, v252, v26
    s_add_u32 s13, s13, s46
    v_mul_f32 v27, v252, v27
    s_lshl_b32 s46, s80, 0
    v_cvt_pk_bf16_f32 v107, v26, v27
    s_add_u32 s13, s13, s46
    buffer_store_dwordx4 v[104:107], v230, s[36:39], s49 offen offset:1024 sc1
    s_add_u32 s13, s13, 25165824
    v_mul_f32 v20, v253, v20
    v_mov_b32 v233, s84
    v_mul_f32 v21, v253, v21
    v_mul_f32 v22, v253, v22
    v_cvt_pk_bf16_f32 v108, v20, v21
    v_mul_f32 v23, v253, v23
    v_mul_f32 v28, v253, v28
    v_cvt_pk_bf16_f32 v109, v22, v23
    v_mul_f32 v29, v253, v29
    v_mul_f32 v30, v253, v30
    v_cvt_pk_bf16_f32 v110, v28, v29
    v_mul_f32 v31, v253, v31
    v_mul_f32 v32, v252, v32
    v_cvt_pk_bf16_f32 v111, v30, v31
    v_mul_f32 v33, v252, v33
    buffer_store_dwordx4 v[108:111], v229, s[36:39], s49 offen offset:1024 sc1
    v_cvt_pk_bf16_f32 v112, v32, v33
    v_mul_f32 v34, v252, v34
    v_mul_f32 v35, v252, v35
    v_mul_f32 v40, v252, v40
    v_cvt_pk_bf16_f32 v113, v34, v35
    v_mul_f32 v41, v252, v41
    v_mul_f32 v42, v252, v42
    v_cvt_pk_bf16_f32 v114, v40, v41
    v_mul_f32 v43, v252, v43
    v_mul_f32 v36, v253, v36
    v_cvt_pk_bf16_f32 v115, v42, v43
    v_mul_f32 v37, v253, v37
    buffer_store_dwordx4 v[112:115], v230, s[36:39], s49 offen offset:2048 sc1
    v_cvt_pk_bf16_f32 v116, v36, v37
    v_mul_f32 v38, v253, v38
    v_mul_f32 v39, v253, v39
    v_mul_f32 v44, v253, v44
    v_cvt_pk_bf16_f32 v117, v38, v39
    v_mul_f32 v45, v253, v45
    v_mul_f32 v46, v253, v46
    v_cvt_pk_bf16_f32 v118, v44, v45
    v_mul_f32 v47, v253, v47
    v_mul_f32 v48, v252, v48
    v_cvt_pk_bf16_f32 v119, v46, v47
    v_mul_f32 v49, v252, v49
    buffer_store_dwordx4 v[116:119], v229, s[36:39], s49 offen offset:2048 sc1
    v_cvt_pk_bf16_f32 v120, v48, v49
    v_mul_f32 v50, v252, v50
    v_mul_f32 v51, v252, v51
    v_mul_f32 v56, v252, v56
    v_cvt_pk_bf16_f32 v121, v50, v51
    v_mul_f32 v57, v252, v57
    v_mul_f32 v58, v252, v58
    v_cvt_pk_bf16_f32 v122, v56, v57
    v_mul_f32 v59, v252, v59
    v_mul_f32 v52, v253, v52
    v_cvt_pk_bf16_f32 v123, v58, v59
    v_mul_f32 v53, v253, v53
    buffer_store_dwordx4 v[120:123], v230, s[36:39], s49 offen offset:3072 sc1
    v_cvt_pk_bf16_f32 v124, v52, v53
    v_mul_f32 v54, v253, v54
    v_mul_f32 v55, v253, v55
    v_mul_f32 v60, v253, v60
    v_cvt_pk_bf16_f32 v125, v54, v55
    v_mul_f32 v61, v253, v61
    v_mul_f32 v62, v253, v62
    v_cvt_pk_bf16_f32 v126, v60, v61
    v_mul_f32 v63, v253, v63
    v_cvt_pk_bf16_f32 v127, v62, v63
    buffer_store_dwordx4 v[124:127], v229, s[36:39], s49 offen offset:3072 sc1
    s_mov_b32 s5, 3
    s_waitcnt lgkmcnt(0)
    s_setprio 2
    s_xor_b32 s46, s80, s4
    s_mul_i32 s46, s46, 20480
    v_add_u32 v232, s46, v231
    s_barrier
    ds_read_b64_tr_b16 v[64:65], v232 offset:0
    ds_read_b64_tr_b16 v[66:67], v232 offset:2560
    ds_read_b64_tr_b16 v[68:69], v232 offset:32
    ds_read_b64_tr_b16 v[70:71], v232 offset:2592
    ds_read_b64_tr_b16 v[72:73], v232 offset:64
    ds_read_b64_tr_b16 v[74:75], v232 offset:2624
    ds_read_b64_tr_b16 v[76:77], v232 offset:96
    ds_read_b64_tr_b16 v[78:79], v232 offset:2656
    ds_read_b64_tr_b16 v[80:81], v232 offset:128
    ds_read_b64_tr_b16 v[82:83], v232 offset:2688
    s_call_b64 s[90:91], K1_SVF
    s_cmp_le_u32 s81, 1
    s_cbranch_scc1 K1_C0
    s_min_u32 s5, s5, s81
    s_call_b64 s[90:91], K1_X0
    s_branch K1_C0
K1_L0:
    s_waitcnt vmcnt(20)
    s_waitcnt vmcnt(12)
    v_and_b32 v246, 3, v255
    v_lshlrev_b32 v246, 3, v246
    v_add_u32 v246, 131072, v246
    v_mov_b32 v250, 0
    v_mov_b32 v251, 0
    ds_write_b64 v246, v[250:251]
    s_waitcnt lgkmcnt(0)
    s_barrier
    s_mov_b32 s46, 49152
    s_add_u32 m0, s45, 114688
    s_nop 0
    buffer_load_dwordx4 v14, s[32:35], s46 offen offset:0 nt lds
    buffer_load_dwordx4 v9, s[32:35], s46 offen offset:1024 nt lds
    buffer_load_dwordx4 v14, s[32:35], s46 offen offset:2048 nt lds
    buffer_load_dwordx4 v9, s[32:35], s46 offen offset:3072 nt lds
    s_waitcnt vmcnt(12)
    v_mov_b32 v250, 1
    ds_write_b32 v246, v250
    s_mov_b32 s46, 65536
    s_add_u32 m0, s45, 0
    s_nop 0
    buffer_load_dwordx4 v10, s[28:31], s46 offen offset:0 nt lds
    buffer_load_dwordx4 v11, s[28:31], s46 offen offset:1024 nt lds
    buffer_load_dwordx4 v12, s[28:31], s46 offen offset:2048 nt lds
    buffer_load_dwordx4 v13, s[28:31], s46 offen offset:3072 nt lds
    s_waitcnt vmcnt(8)
    v_mov_b32 v250, 2
    ds_write_b32 v246, v250
    s_mov_b32 s46, 1
    s_call_b64 s[90:91], K1_FC
    s_mov_b32 s46, 65536
    s_add_u32 m0, s45, 65536
    s_nop 0
    buffer_load_dwordx4 v14, s[32:35], s46 offen offset:0 nt lds
    buffer_load_dwordx4 v9, s[32:35], s46 offen offset:1024 nt lds
    buffer_load_dwordx4 v14, s[32:35], s46 offen offset:2048 nt lds
    buffer_load_dwordx4 v9, s[32:35], s46 offen offset:3072 nt lds
    s_mov_b32 s46, 81920
    s_add_u32 m0, s45, 16384
    s_nop 0
    buffer_load_dwordx4 v10, s[28:31], s46 offen offset:0 nt lds
    buffer_load_dwordx4 v11, s[28:31], s46 offen offset:1024 nt lds
    buffer_load_dwordx4 v12, s[28:31], s46 offen offset:2048 nt lds
    buffer_load_dwordx4 v13, s[28:31], s46 offen offset:3072 nt lds
    s_waitcnt vmcnt(8)
    v_mov_b32 v250, 3
    ds_write_b32 v246, v250
    s_and_b32 s46, s42, 3
    s_lshl_b32 s46, s46, 3
    s_add_u32 s46, s46, s57
    s_lshl_b32 s62, s56, 5
    s_add_u32 s46, s46, s62
    s_mul_i32 s46, s46, 40960
    s_add_u32 s46, s46, 0
    v_lshlrev_b32 v19, 7, v255
    buffer_load_dword v18, v19, s[64:67], s46 offen
    s_mov_b32 s46, 2
    s_call_b64 s[90:91], K1_FC
    s_mov_b32 s46, 81920
    s_add_u32 m0, s45, 81920
    s_nop 0
    buffer_load_dwordx4 v14, s[32:35], s46 offen offset:0 nt lds
    buffer_load_dwordx4 v9, s[32:35], s46 offen offset:1024 nt lds
    buffer_load_dwordx4 v14, s[32:35], s46 offen offset:2048 nt lds
    buffer_load_dwordx4 v9, s[32:35], s46 offen offset:3072 nt lds
    s_mov_b32 s46, 98304
    s_add_u32 m0, s45, 32768
    s_nop 0
    buffer_load_dwordx4 v10, s[28:31], s46 offen offset:0 nt lds
    buffer_load_dwordx4 v11, s[28:31], s46 offen offset:1024 nt lds
    buffer_load_dwordx4 v12, s[28:31], s46 offen offset:2048 nt lds
    buffer_load_dwordx4 v13, s[28:31], s46 offen offset:3072 nt lds
    s_waitcnt vmcnt(9)
    v_mov_b32 v250, 4
    ds_write_b32 v246, v250
    s_mov_b32 s46, 3
    s_call_b64 s[90:91], K1_FC
    s_mov_b32 s46, 98304
    s_add_u32 m0, s45, 98304
    s_nop 0
    buffer_load_dwordx4 v14, s[32:35], s46 offen offset:0 nt lds
    buffer_load_dwordx4 v9, s[32:35], s46 offen offset:1024 nt lds
    buffer_load_dwordx4 v14, s[32:35], s46 offen offset:2048 nt lds
    buffer_load_dwordx4 v9, s[32:35], s46 offen offset:3072 nt lds
    s_mov_b32 s46, 114688
    s_add_u32 m0, s45, 49152
    s_nop 0
    buffer_load_dwordx4 v10, s[28:31], s46 offen offset:0 nt lds
    buffer_load_dwordx4 v11, s[28:31], s46 offen offset:1024 nt lds
    buffer_load_dwordx4 v12, s[28:31], s46 offen offset:2048 nt lds
    buffer_load_dwordx4 v13, s[28:31], s46 offen offset:3072 nt lds
    s_waitcnt vmcnt(8)
    v_mov_b32 v250, 5
    ds_write_b32 v246, v250
    s_mov_b32 s46, 4
    s_call_b64 s[90:91], K1_FC
    s_mov_b32 s46, 114688
    s_add_u32 m0, s45, 114688
    s_nop 0
    buffer_load_dwordx4 v14, s[32:35], s46 offen offset:0 nt lds
    buffer_load_dwordx4 v9, s[32:35], s46 offen offset:1024 nt lds
    buffer_load_dwordx4 v14, s[32:35], s46 offen offset:2048 nt lds
    buffer_load_dwordx4 v9, s[32:35], s46 offen offset:3072 nt lds
    s_mov_b32 s46, 131072
    s_add_u32 m0, s45, 0
    s_nop 0
    buffer_load_dwordx4 v10, s[28:31], s46 offen offset:0 nt lds
    buffer_load_dwordx4 v11, s[28:31], s46 offen offset:1024 nt lds
    buffer_load_dwordx4 v12, s[28:31], s46 offen offset:2048 nt lds
    buffer_load_dwordx4 v13, s[28:31], s46 offen offset:3072 nt lds
    s_waitcnt vmcnt(8)
    v_mov_b32 v250, 6
    ds_write_b32 v246, v250
    s_mov_b32 s46, 5
    s_call_b64 s[90:91], K1_FC
    s_mov_b32 s46, 131072
    s_add_u32 m0, s45, 65536
    s_nop 0
    buffer_load_dwordx4 v14, s[32:35], s46 offen offset:0 nt lds
    buffer_load_dwordx4 v9, s[32:35], s46 offen offset:1024 nt lds
    buffer_load_dwordx4 v14, s[32:35], s46 offen offset:2048 nt lds
    buffer_load_dwordx4 v9, s[32:35], s46 offen offset:3072 nt lds
    s_mov_b32 s46, 147456
    s_add_u32 m0, s45, 16384
    s_nop 0
    buffer_load_dwordx4 v10, s[28:31], s46 offen offset:0 nt lds
    buffer_load_dwordx4 v11, s[28:31], s46 offen offset:1024 nt lds
    buffer_load_dwordx4 v12, s[28:31], s46 offen offset:2048 nt lds
    buffer_load_dwordx4 v13, s[28:31], s46 offen offset:3072 nt lds
    s_waitcnt vmcnt(8)
    v_mov_b32 v250, 7
    ds_write_b32 v246, v250
    s_and_b32 s46, s42, 3
    s_lshl_b32 s46, s46, 3
    s_add_u32 s46, s46, s57
    s_lshl_b32 s62, s56, 5
    s_add_u32 s46, s46, s62
    s_mul_i32 s46, s46, 40960
    s_add_u32 s46, s46, 32768
    v_lshlrev_b32 v19, 7, v255
    buffer_load_dword v18, v19, s[64:67], s46 offen
    s_mov_b32 s46, 6
    s_call_b64 s[90:91], K1_FC
    s_mov_b32 s46, 147456
    s_add_u32 m0, s45, 81920
    s_nop 0
    buffer_load_dwordx4 v14, s[32:35], s46 offen offset:0 nt lds
    buffer_load_dwordx4 v9, s[32:35], s46 offen offset:1024 nt lds
    buffer_load_dwordx4 v14, s[32:35], s46 offen offset:2048 nt lds
    buffer_load_dwordx4 v9, s[32:35], s46 offen offset:3072 nt lds
    s_mov_b32 s46, 163840
    s_add_u32 m0, s45, 32768
    s_nop 0
    buffer_load_dwordx4 v10, s[28:31], s46 offen offset:0 nt lds
    buffer_load_dwordx4 v11, s[28:31], s46 offen offset:1024 nt lds
    buffer_load_dwordx4 v12, s[28:31], s46 offen offset:2048 nt lds
    buffer_load_dwordx4 v13, s[28:31], s46 offen offset:3072 nt lds
    s_waitcnt vmcnt(9)
    v_mov_b32 v250, 8
    ds_write_b32 v246, v250
    s_mov_b32 s46, 7
    s_call_b64 s[90:91], K1_FC
    s_mov_b32 s46, 163840
    s_add_u32 m0, s45, 98304
    s_nop 0
    buffer_load_dwordx4 v14, s[32:35], s46 offen offset:0 nt lds
    buffer_load_dwordx4 v9, s[32:35], s46 offen offset:1024 nt lds
    buffer_load_dwordx4 v14, s[32:35], s46 offen offset:2048 nt lds
    buffer_load_dwordx4 v9, s[32:35], s46 offen offset:3072 nt lds
    s_mov_b32 s46, 180224
    s_add_u32 m0, s45, 49152
    s_nop 0
    buffer_load_dwordx4 v10, s[28:31], s46 offen offset:0 nt lds
    buffer_load_dwordx4 v11, s[28:31], s46 offen offset:1024 nt lds
    buffer_load_dwordx4 v12, s[28:31], s46 offen offset:2048 nt lds
    buffer_load_dwordx4 v13, s[28:31], s46 offen offset:3072 nt lds
    s_waitcnt vmcnt(8)
    v_mov_b32 v250, 9
    ds_write_b32 v246, v250
    s_mov_b32 s46, 8
    s_call_b64 s[90:91], K1_FC
    s_mov_b32 s46, 180224
    s_add_u32 m0, s45, 114688
    s_nop 0
    buffer_load_dwordx4 v14, s[32:35], s46 offen offset:0 nt lds
    buffer_load_dwordx4 v9, s[32:35], s46 offen offset:1024 nt lds
    buffer_load_dwordx4 v14, s[32:35], s46 offen offset:2048 nt lds
    buffer_load_dwordx4 v9, s[32:35], s46 offen offset:3072 nt lds
    s_mov_b32 s46, 196608
    s_add_u32 m0, s45, 0
    s_nop 0
    buffer_load_dwordx4 v10, s[28:31], s46 offen offset:0 nt lds
    buffer_load_dwordx4 v11, s[28:31], s46 offen offset:1024 nt lds
    buffer_load_dwordx4 v12, s[28:31], s46 offen offset:2048 nt lds
    buffer_load_dwordx4 v13, s[28:31], s46 offen offset:3072 nt lds
    s_waitcnt vmcnt(8)
    v_mov_b32 v250, 10
    ds_write_b32 v246, v250
    s_xor_b32 s46, s7, 26
    s_mul_i32 s46, s46, 40960
    s_add_u32 s46, s46, s63
    s_mov_b32 m0, 135168
    s_nop 0
    buffer_load_dwordx4 v237, s[64:67], s46 offen lds
    s_xor_b32 s46, s7, 27
    s_mul_i32 s46, s46, 40960
    s_add_u32 s46, s46, s63
    s_mov_b32 m0, 139264
    s_nop 0
    buffer_load_dwordx4 v236, s[64:67], s46 offen lds
    s_xor_b32 s46, s7, 28
    s_mul_i32 s46, s46, 40960
    s_add_u32 s46, s46, s63
    s_mov_b32 m0, 143360
    s_nop 0
    buffer_load_dwordx4 v235, s[64:67], s46 offen lds
    s_mov_b32 s46, 9
    s_call_b64 s[90:91], K1_FC
    s_mov_b32 s46, 196608
    s_add_u32 m0, s45, 65536
    s_nop 0
    buffer_load_dwordx4 v14, s[32:35], s46 offen offset:0 nt lds
    buffer_load_dwordx4 v9, s[32:35], s46 offen offset:1024 nt lds
    buffer_load_dwordx4 v14, s[32:35], s46 offen offset:2048 nt lds
    buffer_load_dwordx4 v9, s[32:35], s46 offen offset:3072 nt lds
    s_mov_b32 s46, 212992
    s_add_u32 m0, s45, 16384
    s_nop 0
    buffer_load_dwordx4 v10, s[28:31], s46 offen offset:0 nt lds
    buffer_load_dwordx4 v11, s[28:31], s46 offen offset:1024 nt lds
    buffer_load_dwordx4 v12, s[28:31], s46 offen offset:2048 nt lds
    buffer_load_dwordx4 v13, s[28:31], s46 offen offset:3072 nt lds
    s_waitcnt vmcnt(11)
    v_mov_b32 v250, 11
    ds_write_b32 v246, v250
    s_mov_b32 s46, 229376
    buffer_load_dwordx4 v[24:27], v10, s[28:31], s46 offen offset:0 nt
    buffer_load_dwordx4 v[28:31], v11, s[28:31], s46 offen offset:1024 nt
    buffer_load_dwordx4 v[32:35], v12, s[28:31], s46 offen offset:2048 nt
    buffer_load_dwordx4 v[36:39], v13, s[28:31], s46 offen offset:3072 nt
    s_mov_b32 s46, 212992
    buffer_load_dwordx4 v[40:43], v14, s[32:35], s46 offen offset:0 nt
    buffer_load_dwordx4 v[44:47], v9, s[32:35], s46 offen offset:1024 nt
    buffer_load_dwordx4 v[48:51], v14, s[32:35], s46 offen offset:2048 nt
    buffer_load_dwordx4 v[52:55], v9, s[32:35], s46 offen offset:3072 nt
    s_waitcnt vmcnt(8)
    v_mov_b32 v250, 12
    ds_write_b32 v246, v250
    s_mov_b32 s46, 10
    s_call_b64 s[90:91], K1_FC
    s_mov_b32 s46, 245760
    buffer_load_dwordx4 v[56:59], v10, s[28:31], s46 offen offset:0 nt
    buffer_load_dwordx4 v[60:63], v11, s[28:31], s46 offen offset:1024 nt
    buffer_load_dwordx4 v[64:67], v12, s[28:31], s46 offen offset:2048 nt
    buffer_load_dwordx4 v[68:71], v13, s[28:31], s46 offen offset:3072 nt
    s_mov_b32 s46, 229376
    buffer_load_dwordx4 v[72:75], v14, s[32:35], s46 offen offset:0 nt
    buffer_load_dwordx4 v[76:79], v9, s[32:35], s46 offen offset:1024 nt
    buffer_load_dwordx4 v[80:83], v14, s[32:35], s46 offen offset:2048 nt
    buffer_load_dwordx4 v[84:87], v9, s[32:35], s46 offen offset:3072 nt
    s_mov_b32 s46, 245760
    buffer_load_dwordx4 v[88:91], v14, s[32:35], s46 offen offset:0 nt
    buffer_load_dwordx4 v[92:95], v9, s[32:35], s46 offen offset:1024 nt
    buffer_load_dwordx4 v[96:99], v14, s[32:35], s46 offen offset:2048 nt
    buffer_load_dwordx4 v[100:103], v9, s[32:35], s46 offen offset:3072 nt
    s_xor_b32 s46, s7, 28
    s_mul_i32 s46, s46, 40960
    s_add_u32 s46, s46, s63
    s_mov_b32 m0, 147456
    s_nop 0
    buffer_load_dwordx4 v239, s[64:67], s46 offen lds
    s_xor_b32 s46, s7, 29
    s_mul_i32 s46, s46, 40960
    s_add_u32 s46, s46, s63
    s_mov_b32 m0, 148480
    s_nop 0
    buffer_load_dwordx4 v235, s[64:67], s46 offen lds
    s_xor_b32 s46, s7, 29
    s_mul_i32 s46, s46, 40960
    s_add_u32 s46, s46, s63
    s_mov_b32 m0, 149504
    s_nop 0
    buffer_load_dwordx4 v236, s[64:67], s46 offen lds
    s_xor_b32 s46, s7, 29
    s_mul_i32 s46, s46, 40960
    s_add_u32 s46, s46, s63
    s_mov_b32 m0, 150528
    s_nop 0
    buffer_load_dwordx4 v237, s[64:67], s46 offen lds
    s_xor_b32 s46, s7, 25
    s_mul_i32 s46, s46, 40960
    s_add_u32 s46, s46, s63
    buffer_load_dwordx4 v[20:23], v238, s[64:67], s46 offen
    v_lshlrev_b32 v17, 4, v255
    v_add_u32 v17, 131072, v17
    s_mov_b32 s46, 11
    s_call_b64 s[90:91], K1_FC
    s_mov_b32 s46, 12
    s_call_b64 s[90:91], K1_FC
    s_waitcnt vmcnt(21)
    ds_write_b128 v247, v[24:27] offset:32768
    ds_write_b128 v247, v[28:31] offset:33792
    ds_write_b128 v247, v[32:35] offset:34816
    ds_write_b128 v247, v[36:39] offset:35840
    s_waitcnt vmcnt(17)
    ds_write_b128 v248, v[40:43] offset:16384
    ds_write_b128 v248, v[44:47] offset:17408
    ds_write_b128 v248, v[48:51] offset:18432
    ds_write_b128 v248, v[52:55] offset:19456
    v_mov_b32 v250, 13
    ds_write_b32 v246, v250
    s_mov_b32 s46, 13
    s_call_b64 s[90:91], K1_FC
    s_waitcnt vmcnt(13)
    ds_write_b128 v247, v[56:59] offset:49152
    ds_write_b128 v247, v[60:63] offset:50176
    ds_write_b128 v247, v[64:67] offset:51200
    ds_write_b128 v247, v[68:71] offset:52224
    s_waitcnt vmcnt(9)
    ds_write_b128 v248, v[72:75] offset:32768
    ds_write_b128 v248, v[76:79] offset:33792
    ds_write_b128 v248, v[80:83] offset:34816
    ds_write_b128 v248, v[84:87] offset:35840
    v_mov_b32 v250, 14
    ds_write_b32 v246, v250
    s_xor_b32 s46, s7, 0
    s_mul_i32 s46, s46, 40960
    s_add_u32 s46, s46, s63
    s_mov_b32 m0, 0
    s_nop 0
    buffer_load_dwordx4 v235, s[64:67], s46 offen lds
    s_xor_b32 s46, s7, 0
    s_mul_i32 s46, s46, 40960
    s_add_u32 s46, s46, s63
    s_mov_b32 m0, 1024
    s_nop 0
    buffer_load_dwordx4 v236, s[64:67], s46 offen lds
    s_xor_b32 s46, s7, 0
    s_mul_i32 s46, s46, 40960
    s_add_u32 s46, s46, s63
    s_mov_b32 m0, 2048
    s_nop 0
    buffer_load_dwordx4 v237, s[64:67], s46 offen lds
    s_xor_b32 s46, s7, 0
    s_mul_i32 s46, s46, 40960
    s_add_u32 s46, s46, s63
    s_mov_b32 m0, 3072
    s_nop 0
    buffer_load_dwordx4 v238, s[64:67], s46 offen lds
    s_xor_b32 s46, s7, 3
    s_mul_i32 s46, s46, 40960
    s_add_u32 s46, s46, s63
    s_mov_b32 m0, 16384
    s_nop 0
    buffer_load_dwordx4 v236, s[64:67], s46 offen lds
    s_xor_b32 s46, s7, 3
    s_mul_i32 s46, s46, 40960
    s_add_u32 s46, s46, s63
    s_mov_b32 m0, 17408
    s_nop 0
    buffer_load_dwordx4 v237, s[64:67], s46 offen lds
    s_xor_b32 s46, s7, 3
    s_mul_i32 s46, s46, 40960
    s_add_u32 s46, s46, s63
    s_mov_b32 m0, 18432
    s_nop 0
    buffer_load_dwordx4 v238, s[64:67], s46 offen lds
    s_xor_b32 s46, s7, 3
    s_mul_i32 s46, s46, 40960
    s_add_u32 s46, s46, s63
    s_mov_b32 m0, 19456
    s_nop 0
    buffer_load_dwordx4 v239, s[64:67], s46 offen lds
    s_xor_b32 s46, s7, 12
    s_mul_i32 s46, s46, 40960
    s_add_u32 s46, s46, s63
    s_mov_b32 m0, 65536
    s_nop 0
    buffer_load_dwordx4 v239, s[64:67], s46 offen lds
    s_xor_b32 s46, s7, 13
    s_mul_i32 s46, s46, 40960
    s_add_u32 s46, s46, s63
    s_mov_b32 m0, 66560
    s_nop 0
    buffer_load_dwordx4 v235, s[64:67], s46 offen lds
    s_xor_b32 s46, s7, 13
    s_mul_i32 s46, s46, 40960
    s_add_u32 s46, s46, s63
    s_mov_b32 m0, 67584
    s_nop 0
    buffer_load_dwordx4 v236, s[64:67], s46 offen lds
    s_xor_b32 s46, s7, 13
    s_mul_i32 s46, s46, 40960
    s_add_u32 s46, s46, s63
    s_mov_b32 m0, 68608
    s_nop 0
    buffer_load_dwordx4 v237, s[64:67], s46 offen lds
    s_mov_b32 s46, 14
    s_call_b64 s[90:91], K1_FC
    s_waitcnt vmcnt(17)
    ds_write_b128 v248, v[88:91] offset:49152
    ds_write_b128 v248, v[92:95] offset:50176
    ds_write_b128 v248, v[96:99] offset:51200
    ds_write_b128 v248, v[100:103] offset:52224
    v_mov_b32 v250, 15
    ds_write_b32 v246, v250
    s_xor_b32 s46, s7, 6
    s_mul_i32 s46, s46, 40960
    s_add_u32 s46, s46, s63
    s_mov_b32 m0, 32768
    s_nop 0
    buffer_load_dwordx4 v237, s[64:67], s46 offen lds
    s_xor_b32 s46, s7, 6
    s_mul_i32 s46, s46, 40960
    s_add_u32 s46, s46, s63
    s_mov_b32 m0, 33792
    s_nop 0
    buffer_load_dwordx4 v238, s[64:67], s46 offen lds
    s_xor_b32 s46, s7, 6
    s_mul_i32 s46, s46, 40960
    s_add_u32 s46, s46, s63
    s_mov_b32 m0, 34816
    s_nop 0
    buffer_load_dwordx4 v239, s[64:67], s46 offen lds
    s_xor_b32 s46, s7, 7
    s_mul_i32 s46, s46, 40960
    s_add_u32 s46, s46, s63
    s_mov_b32 m0, 35840
    s_nop 0
    buffer_load_dwordx4 v235, s[64:67], s46 offen lds
    s_xor_b32 s46, s7, 16
    s_mul_i32 s46, s46, 40960
    s_add_u32 s46, s46, s63
    s_mov_b32 m0, 81920
    s_nop 0
    buffer_load_dwordx4 v235, s[64:67], s46 offen lds
    s_xor_b32 s46, s7, 16
    s_mul_i32 s46, s46, 40960
    s_add_u32 s46, s46, s63
    s_mov_b32 m0, 82944
    s_nop 0
    buffer_load_dwordx4 v236, s[64:67], s46 offen lds
    s_xor_b32 s46, s7, 16
    s_mul_i32 s46, s46, 40960
    s_add_u32 s46, s46, s63
    s_mov_b32 m0, 83968
    s_nop 0
    buffer_load_dwordx4 v237, s[64:67], s46 offen lds
    s_xor_b32 s46, s7, 16
    s_mul_i32 s46, s46, 40960
    s_add_u32 s46, s46, s63
    s_mov_b32 m0, 84992
    s_nop 0
    buffer_load_dwordx4 v238, s[64:67], s46 offen lds
    s_xor_b32 s46, s7, 22
    s_mul_i32 s46, s46, 40960
    s_add_u32 s46, s46, s63
    buffer_load_dwordx4 v[104:107], v237, s[64:67], s46 offen
    s_xor_b32 s46, s7, 22
    s_mul_i32 s46, s46, 40960
    s_add_u32 s46, s46, s63
    buffer_load_dwordx4 v[108:111], v238, s[64:67], s46 offen
    s_xor_b32 s46, s7, 22
    s_mul_i32 s46, s46, 40960
    s_add_u32 s46, s46, s63
    buffer_load_dwordx4 v[112:115], v239, s[64:67], s46 offen
    s_xor_b32 s46, s7, 23
    s_mul_i32 s46, s46, 40960
    s_add_u32 s46, s46, s63
    buffer_load_dwordx4 v[116:119], v235, s[64:67], s46 offen
    s_waitcnt vmcnt(25)
    s_mov_b32 s46, 15
    s_call_b64 s[90:91], K1_FC
    s_xor_b32 s46, s7, 9
    s_mul_i32 s46, s46, 40960
    s_add_u32 s46, s46, s63
    s_mov_b32 m0, 49152
    s_nop 0
    buffer_load_dwordx4 v238, s[64:67], s46 offen lds
    s_xor_b32 s46, s7, 9
    s_mul_i32 s46, s46, 40960
    s_add_u32 s46, s46, s63
    s_mov_b32 m0, 50176
    s_nop 0
    buffer_load_dwordx4 v239, s[64:67], s46 offen lds
    s_xor_b32 s46, s7, 10
    s_mul_i32 s46, s46, 40960
    s_add_u32 s46, s46, s63
    s_mov_b32 m0, 51200
    s_nop 0
    buffer_load_dwordx4 v235, s[64:67], s46 offen lds
    s_xor_b32 s46, s7, 10
    s_mul_i32 s46, s46, 40960
    s_add_u32 s46, s46, s63
    s_mov_b32 m0, 52224
    s_nop 0
    buffer_load_dwordx4 v236, s[64:67], s46 offen lds
    s_xor_b32 s46, s7, 19
    s_mul_i32 s46, s46, 40960
    s_add_u32 s46, s46, s63
    s_mov_b32 m0, 98304
    s_nop 0
    buffer_load_dwordx4 v236, s[64:67], s46 offen lds
    s_xor_b32 s46, s7, 19
    s_mul_i32 s46, s46, 40960
    s_add_u32 s46, s46, s63
    s_mov_b32 m0, 99328
    s_nop 0
    buffer_load_dwordx4 v237, s[64:67], s46 offen lds
    s_xor_b32 s46, s7, 19
    s_mul_i32 s46, s46, 40960
    s_add_u32 s46, s46, s63
    s_mov_b32 m0, 100352
    s_nop 0
    buffer_load_dwordx4 v238, s[64:67], s46 offen lds
    s_xor_b32 s46, s7, 19
    s_mul_i32 s46, s46, 40960
    s_add_u32 s46, s46, s63
    s_mov_b32 m0, 101376
    s_nop 0
    buffer_load_dwordx4 v239, s[64:67], s46 offen lds
    v_lshlrev_b32 v229, 4, v255
    s_lshl_b32 s46, s77, 17
    v_add_u32 v230, s46, v229
    v_xor_b32 v229, 0x20000, v230
    s_lshl_b32 s47, s42, 20
    s_lshl_b32 s46, s76, 18
    s_add_u32 s47, s47, s46
    s_lshl_b32 s46, s56, 15
    s_add_u32 s47, s47, s46
    s_lshl_b32 s46, s10, 14
    s_add_u32 s47, s47, s46
    s_mov_b32 s83, 0
    s_mov_b32 s85, 0
    s_mov_b32 s86, -1
    s_mov_b32 s8, 1
    v_lshrrev_b32 v231, 2, v255
    v_mul_u32_u24 v231, 160, v231
    v_and_b32 v232, 3, v255
    v_lshl_add_u32 v231, v232, 3, v231
    v_lshlrev_b32 v234, 13, v255
    v_and_b32 v228, 31, v255
    v_lshlrev_b32 v228, 7, v228
    v_lshrrev_b32 v227, 5, v255
    v_lshl_add_u32 v228, v227, 17, v228
    s_mov_b32 s4, 0
    s_mul_i32 s46, s10, 81920
    v_add_u32 v231, s46, v231
    s_mov_b32 s80, 0
    s_mov_b32 s81, 0
    s_mov_b32 s82, 0
    s_mov_b32 s84, 0
    s_mov_b32 s11, 0
    s_mov_b32 s49, 0
    s_mov_b32 s6, 0
    s_buffer_load_dword s12, s[36:39], s78 glc
    s_waitcnt vmcnt(32)
    s_waitcnt vmcnt(8)
    s_mov_b32 s46, 16
    s_call_b64 s[90:91], K1_FC
    ds_write_b128 v17, v[20:23]
    ds_write_b128 v248, v[104:107] offset:49152
    ds_write_b128 v248, v[108:111] offset:50176
    ds_write_b128 v248, v[112:115] offset:51200
    ds_write_b128 v248, v[116:119] offset:52224
    s_mov_b32 s5, 2
    s_waitcnt lgkmcnt(0)
    s_call_b64 s[90:91], K1_SVC
    s_mov_b32 s46, s85
    s_call_b64 s[90:91], K1_WV
    s_barrier
    s_setprio 1
    s_branch K1_B0
K1_L1:
    s_waitcnt vmcnt(20)
    s_waitcnt vmcnt(12)
    v_and_b32 v246, 3, v255
    v_lshlrev_b32 v246, 3, v246
    v_add_u32 v246, 132128, v246
    v_mov_b32 v250, 0
    v_mov_b32 v251, 0
    ds_write_b64 v246, v[250:251]
    s_waitcnt lgkmcnt(0)
    s_barrier
    s_mov_b32 s46, 49152
    s_add_u32 m0, s45, 114688
    s_nop 0
    buffer_load_dwordx4 v14, s[32:35], s46 offen offset:0 nt lds
    buffer_load_dwordx4 v9, s[32:35], s46 offen offset:1024 nt lds
    buffer_load_dwordx4 v14, s[32:35], s46 offen offset:2048 nt lds
    buffer_load_dwordx4 v9, s[32:35], s46 offen offset:3072 nt lds
    s_waitcnt vmcnt(12)
    v_mov_b32 v250, 1
    ds_write_b32 v246, v250
    s_mov_b32 s46, 65536
    s_add_u32 m0, s45, 0
    s_nop 0
    buffer_load_dwordx4 v10, s[28:31], s46 offen offset:0 nt lds
    buffer_load_dwordx4 v11, s[28:31], s46 offen offset:1024 nt lds
    buffer_load_dwordx4 v12, s[28:31], s46 offen offset:2048 nt lds
    buffer_load_dwordx4 v13, s[28:31], s46 offen offset:3072 nt lds
    s_waitcnt vmcnt(8)
    v_mov_b32 v250, 2
    ds_write_b32 v246, v250
    s_mov_b32 s46, 1
    s_call_b64 s[90:91], K1_FC
    s_mov_b32 s46, 65536
    s_add_u32 m0, s45, 65536
    s_nop 0
    buffer_load_dwordx4 v14, s[32:35], s46 offen offset:0 nt lds
    buffer_load_dwordx4 v9, s[32:35], s46 offen offset:1024 nt lds
    buffer_load_dwordx4 v14, s[32:35], s46 offen offset:2048 nt lds
    buffer_load_dwordx4 v9, s[32:35], s46 offen offset:3072 nt lds
    s_mov_b32 s46, 81920
    s_add_u32 m0, s45, 16384
    s_nop 0
    buffer_load_dwordx4 v10, s[28:31], s46 offen offset:0 nt lds
    buffer_load_dwordx4 v11, s[28:31], s46 offen offset:1024 nt lds
    buffer_load_dwordx4 v12, s[28:31], s46 offen offset:2048 nt lds
    buffer_load_dwordx4 v13, s[28:31], s46 offen offset:3072 nt lds
    s_waitcnt vmcnt(8)
    v_mov_b32 v250, 3
    ds_write_b32 v246, v250
    s_mov_b32 s46, 2
    s_call_b64 s[90:91], K1_FC
    s_mov_b32 s46, 81920
    s_add_u32 m0, s45, 81920
    s_nop 0
    buffer_load_dwordx4 v14, s[32:35], s46 offen offset:0 nt lds
    buffer_load_dwordx4 v9, s[32:35], s46 offen offset:1024 nt lds
    buffer_load_dwordx4 v14, s[32:35], s46 offen offset:2048 nt lds
    buffer_load_dwordx4 v9, s[32:35], s46 offen offset:3072 nt lds
    s_mov_b32 s46, 98304
    s_add_u32 m0, s45, 32768
    s_nop 0
    buffer_load_dwordx4 v10, s[28:31], s46 offen offset:0 nt lds
    buffer_load_dwordx4 v11, s[28:31], s46 offen offset:1024 nt lds
    buffer_load_dwordx4 v12, s[28:31], s46 offen offset:2048 nt lds
    buffer_load_dwordx4 v13, s[28:31], s46 offen offset:3072 nt lds
    s_waitcnt vmcnt(8)
    v_mov_b32 v250, 4
    ds_write_b32 v246, v250
    s_and_b32 s46, s42, 3
    s_lshl_b32 s46, s46, 3
    s_add_u32 s46, s46, s57
    s_lshl_b32 s62, s56, 5
    s_add_u32 s46, s46, s62
    s_mul_i32 s46, s46, 40960
    s_add_u32 s46, s46, 8192
    v_lshlrev_b32 v19, 7, v255
    buffer_load_dword v18, v19, s[64:67], s46 offen
    s_mov_b32 s46, 3
    s_call_b64 s[90:91], K1_FC
    s_mov_b32 s46, 98304
    s_add_u32 m0, s45, 98304
    s_nop 0
    buffer_load_dwordx4 v14, s[32:35], s46 offen offset:0 nt lds
    buffer_load_dwordx4 v9, s[32:35], s46 offen offset:1024 nt lds
    buffer_load_dwordx4 v14, s[32:35], s46 offen offset:2048 nt lds
    buffer_load_dwordx4 v9, s[32:35], s46 offen offset:3072 nt lds
    s_mov_b32 s46, 114688
    s_add_u32 m0, s45, 49152
    s_nop 0
    buffer_load_dwordx4 v10, s[28:31], s46 offen offset:0 nt lds
    buffer_load_dwordx4 v11, s[28:31], s46 offen offset:1024 nt lds
    buffer_load_dwordx4 v12, s[28:31], s46 offen offset:2048 nt lds
    buffer_load_dwordx4 v13, s[28:31], s46 offen offset:3072 nt lds
    s_waitcnt vmcnt(9)
    v_mov_b32 v250, 5
    ds_write_b32 v246, v250
    s_mov_b32 s46, 4
    s_call_b64 s[90:91], K1_FC
    s_mov_b32 s46, 114688
    s_add_u32 m0, s45, 114688
    s_nop 0
    buffer_load_dwordx4 v14, s[32:35], s46 offen offset:0 nt lds
    buffer_load_dwordx4 v9, s[32:35], s46 offen offset:1024 nt lds
    buffer_load_dwordx4 v14, s[32:35], s46 offen offset:2048 nt lds
    buffer_load_dwordx4 v9, s[32:35], s46 offen offset:3072 nt lds
    s_mov_b32 s46, 131072
    s_add_u32 m0, s45, 0
    s_nop 0
    buffer_load_dwordx4 v10, s[28:31], s46 offen offset:0 nt lds
    buffer_load_dwordx4 v11, s[28:31], s46 offen offset:1024 nt lds
    buffer_load_dwordx4 v12, s[28:31], s46 offen offset:2048 nt lds
    buffer_load_dwordx4 v13, s[28:31], s46 offen offset:3072 nt lds
    s_waitcnt vmcnt(8)
    v_mov_b32 v250, 6
    ds_write_b32 v246, v250
    s_mov_b32 s46, 5
    s_call_b64 s[90:91], K1_FC
    s_mov_b32 s46, 131072
    s_add_u32 m0, s45, 65536
    s_nop 0
    buffer_load_dwordx4 v14, s[32:35], s46 offen offset:0 nt lds
    buffer_load_dwordx4 v9, s[32:35], s46 offen offset:1024 nt lds
    buffer_load_dwordx4 v14, s[32:35], s46 offen offset:2048 nt lds
    buffer_load_dwordx4 v9, s[32:35], s46 offen offset:3072 nt lds
    s_mov_b32 s46, 147456
    s_add_u32 m0, s45, 16384
    s_nop 0
    buffer_load_dwordx4 v10, s[28:31], s46 offen offset:0 nt lds
    buffer_load_dwordx4 v11, s[28:31], s46 offen offset:1024 nt lds
    buffer_load_dwordx4 v12, s[28:31], s46 offen offset:2048 nt lds
    buffer_load_dwordx4 v13, s[28:31], s46 offen offset:3072 nt lds
    s_waitcnt vmcnt(8)
    v_mov_b32 v250, 7
    ds_write_b32 v246, v250
    s_mov_b32 s46, 6
    s_call_b64 s[90:91], K1_FC
    s_mov_b32 s46, 147456
    s_add_u32 m0, s45, 81920
    s_nop 0
    buffer_load_dwordx4 v14, s[32:35], s46 offen offset:0 nt lds
    buffer_load_dwordx4 v9, s[32:35], s46 offen offset:1024 nt lds
    buffer_load_dwordx4 v14, s[32:35], s46 offen offset:2048 nt lds
    buffer_load_dwordx4 v9, s[32:35], s46 offen offset:3072 nt lds
    s_mov_b32 s46, 163840
    s_add_u32 m0, s45, 32768
    s_nop 0
    buffer_load_dwordx4 v10, s[28:31], s46 offen offset:0 nt lds
    buffer_load_dwordx4 v11, s[28:31], s46 offen offset:1024 nt lds
    buffer_load_dwordx4 v12, s[28:31], s46 offen offset:2048 nt lds
    buffer_load_dwordx4 v13, s[28:31], s46 offen offset:3072 nt lds
    s_waitcnt vmcnt(8)
    v_mov_b32 v250, 8
    ds_write_b32 v246, v250
    s_mov_b32 s46, 7
    s_call_b64 s[90:91], K1_FC
    s_mov_b32 s46, 163840
    s_add_u32 m0, s45, 98304
    s_nop 0
    buffer_load_dwordx4 v14, s[32:35], s46 offen offset:0 nt lds
    buffer_load_dwordx4 v9, s[32:35], s46 offen offset:1024 nt lds
    buffer_load_dwordx4 v14, s[32:35], s46 offen offset:2048 nt lds
    buffer_load_dwordx4 v9, s[32:35], s46 offen offset:3072 nt lds
    s_mov_b32 s46, 180224
    s_add_u32 m0, s45, 49152
    s_nop 0
    buffer_load_dwordx4 v10, s[28:31], s46 offen offset:0 nt lds
    buffer_load_dwordx4 v11, s[28:31], s46 offen offset:1024 nt lds
    buffer_load_dwordx4 v12, s[28:31], s46 offen offset:2048 nt lds
    buffer_load_dwordx4 v13, s[28:31], s46 offen offset:3072 nt lds
    s_waitcnt vmcnt(8)
    v_mov_b32 v250, 9
    ds_write_b32 v246, v250
    s_mov_b32 s46, 8
    s_call_b64 s[90:91], K1_FC
    s_mov_b32 s46, 180224
    s_add_u32 m0, s45, 114688
    s_nop 0
    buffer_load_dwordx4 v14, s[32:35], s46 offen offset:0 nt lds
    buffer_load_dwordx4 v9, s[32:35], s46 offen offset:1024 nt lds
    buffer_load_dwordx4 v14, s[32:35], s46 offen offset:2048 nt lds
    buffer_load_dwordx4 v9, s[32:35], s46 offen offset:3072 nt lds
    s_mov_b32 s46, 196608
    s_add_u32 m0, s45, 0
    s_nop 0
    buffer_load_dwordx4 v10, s[28:31], s46 offen offset:0 nt lds
    buffer_load_dwordx4 v11, s[28:31], s46 offen offset:1024 nt lds
    buffer_load_dwordx4 v12, s[28:31], s46 offen offset:2048 nt lds
    buffer_load_dwordx4 v13, s[28:31], s46 offen offset:3072 nt lds
    s_waitcnt vmcnt(8)
    v_mov_b32 v250, 10
    ds_write_b32 v246, v250
    s_xor_b32 s46, s7, 26
    s_mul_i32 s46, s46, 40960
    s_add_u32 s46, s46, s63
    s_mov_b32 m0, 136192
    s_nop 0
    buffer_load_dwordx4 v238, s[64:67], s46 offen lds
    s_xor_b32 s46, s7, 27
    s_mul_i32 s46, s46, 40960
    s_add_u32 s46, s46, s63
    s_mov_b32 m0, 140288
    s_nop 0
    buffer_load_dwordx4 v237, s[64:67], s46 offen lds
    s_xor_b32 s46, s7, 28
    s_mul_i32 s46, s46, 40960
    s_add_u32 s46, s46, s63
    s_mov_b32 m0, 144384
    s_nop 0
    buffer_load_dwordx4 v236, s[64:67], s46 offen lds
    s_mov_b32 s46, 9
    s_call_b64 s[90:91], K1_FC
    s_mov_b32 s46, 196608
    s_add_u32 m0, s45, 65536
    s_nop 0
    buffer_load_dwordx4 v14, s[32:35], s46 offen offset:0 nt lds
    buffer_load_dwordx4 v9, s[32:35], s46 offen offset:1024 nt lds
    buffer_load_dwordx4 v14, s[32:35], s46 offen offset:2048 nt lds
    buffer_load_dwordx4 v9, s[32:35], s46 offen offset:3072 nt lds
    s_mov_b32 s46, 212992
    s_add_u32 m0, s45, 16384
    s_nop 0
    buffer_load_dwordx4 v10, s[28:31], s46 offen offset:0 nt lds
    buffer_load_dwordx4 v11, s[28:31], s46 offen offset:1024 nt lds
    buffer_load_dwordx4 v12, s[28:31], s46 offen offset:2048 nt lds
    buffer_load_dwordx4 v13, s[28:31], s46 offen offset:3072 nt lds
    s_waitcnt vmcnt(11)
    v_mov_b32 v250, 11
    ds_write_b32 v246, v250
    s_mov_b32 s46, 229376
    buffer_load_dwordx4 v[24:27], v10, s[28:31], s46 offen offset:0 nt
    buffer_load_dwordx4 v[28:31], v11, s[28:31], s46 offen offset:1024 nt
    buffer_load_dwordx4 v[32:35], v12, s[28:31], s46 offen offset:2048 nt
    buffer_load_dwordx4 v[36:39], v13, s[28:31], s46 offen offset:3072 nt
    s_mov_b32 s46, 212992
    buffer_load_dwordx4 v[40:43], v14, s[32:35], s46 offen offset:0 nt
    buffer_load_dwordx4 v[44:47], v9, s[32:35], s46 offen offset:1024 nt
    buffer_load_dwordx4 v[48:51], v14, s[32:35], s46 offen offset:2048 nt
    buffer_load_dwordx4 v[52:55], v9, s[32:35], s46 offen offset:3072 nt
    s_waitcnt vmcnt(8)
    v_mov_b32 v250, 12
    ds_write_b32 v246, v250
    s_mov_b32 s46, 10
    s_call_b64 s[90:91], K1_FC
    s_mov_b32 s46, 245760
    buffer_load_dwordx4 v[56:59], v10, s[28:31], s46 offen offset:0 nt
    buffer_load_dwordx4 v[60:63], v11, s[28:31], s46 offen offset:1024 nt
    buffer_load_dwordx4 v[64:67], v12, s[28:31], s46 offen offset:2048 nt
    buffer_load_dwordx4 v[68:71], v13, s[28:31], s46 offen offset:3072 nt
    s_mov_b32 s46, 229376
    buffer_load_dwordx4 v[72:75], v14, s[32:35], s46 offen offset:0 nt
    buffer_load_dwordx4 v[76:79], v9, s[32:35], s46 offen offset:1024 nt
    buffer_load_dwordx4 v[80:83], v14, s[32:35], s46 offen offset:2048 nt
    buffer_load_dwordx4 v[84:87], v9, s[32:35], s46 offen offset:3072 nt
    s_mov_b32 s46, 245760
    buffer_load_dwordx4 v[88:91], v14, s[32:35], s46 offen offset:0 nt
    buffer_load_dwordx4 v[92:95], v9, s[32:35], s46 offen offset:1024 nt
    buffer_load_dwordx4 v[96:99], v14, s[32:35], s46 offen offset:2048 nt
    buffer_load_dwordx4 v[100:103], v9, s[32:35], s46 offen offset:3072 nt
    s_xor_b32 s46, s7, 29
    s_mul_i32 s46, s46, 40960
    s_add_u32 s46, s46, s63
    s_mov_b32 m0, 151552
    s_nop 0
    buffer_load_dwordx4 v238, s[64:67], s46 offen lds
    s_xor_b32 s46, s7, 29
    s_mul_i32 s46, s46, 40960
    s_add_u32 s46, s46, s63
    s_mov_b32 m0, 152576
    s_nop 0
    buffer_load_dwordx4 v239, s[64:67], s46 offen lds
    s_xor_b32 s46, s7, 30
    s_mul_i32 s46, s46, 40960
    s_add_u32 s46, s46, s63
    s_mov_b32 m0, 153600
    s_nop 0
    buffer_load_dwordx4 v235, s[64:67], s46 offen lds
    s_xor_b32 s46, s7, 30
    s_mul_i32 s46, s46, 40960
    s_add_u32 s46, s46, s63
    s_mov_b32 m0, 154624
    s_nop 0
    buffer_load_dwordx4 v236, s[64:67], s46 offen lds
    s_xor_b32 s46, s7, 25
    s_mul_i32 s46, s46, 40960
    s_add_u32 s46, s46, s63
    buffer_load_dwordx4 v[20:23], v239, s[64:67], s46 offen
    v_lshlrev_b32 v17, 4, v255
    v_add_u32 v17, 132096, v17
    s_mov_b32 s46, 11
    s_call_b64 s[90:91], K1_FC
    s_mov_b32 s46, 12
    s_call_b64 s[90:91], K1_FC
    s_waitcnt vmcnt(21)
    ds_write_b128 v247, v[24:27] offset:32768
    ds_write_b128 v247, v[28:31] offset:33792
    ds_write_b128 v247, v[32:35] offset:34816
    ds_write_b128 v247, v[36:39] offset:35840
    s_waitcnt vmcnt(17)
    ds_write_b128 v248, v[40:43] offset:16384
    ds_write_b128 v248, v[44:47] offset:17408
    ds_write_b128 v248, v[48:51] offset:18432
    ds_write_b128 v248, v[52:55] offset:19456
    v_mov_b32 v250, 13
    ds_write_b32 v246, v250
    s_mov_b32 s46, 13
    s_call_b64 s[90:91], K1_FC
    s_waitcnt vmcnt(13)
    ds_write_b128 v247, v[56:59] offset:49152
    ds_write_b128 v247, v[60:63] offset:50176
    ds_write_b128 v247, v[64:67] offset:51200
    ds_write_b128 v247, v[68:71] offset:52224
    s_waitcnt vmcnt(9)
    ds_write_b128 v248, v[72:75] offset:32768
    ds_write_b128 v248, v[76:79] offset:33792
    ds_write_b128 v248, v[80:83] offset:34816
    ds_write_b128 v248, v[84:87] offset:35840
    v_mov_b32 v250, 14
    ds_write_b32 v246, v250
    s_xor_b32 s46, s7, 0
    s_mul_i32 s46, s46, 40960
    s_add_u32 s46, s46, s63
    s_mov_b32 m0, 4096
    s_nop 0
    buffer_load_dwordx4 v239, s[64:67], s46 offen lds
    s_xor_b32 s46, s7, 1
    s_mul_i32 s46, s46, 40960
    s_add_u32 s46, s46, s63
    s_mov_b32 m0, 5120
    s_nop 0
    buffer_load_dwordx4 v235, s[64:67], s46 offen lds
    s_xor_b32 s46, s7, 1
    s_mul_i32 s46, s46, 40960
    s_add_u32 s46, s46, s63
    s_mov_b32 m0, 6144
    s_nop 0
    buffer_load_dwordx4 v236, s[64:67], s46 offen lds
    s_xor_b32 s46, s7, 1
    s_mul_i32 s46, s46, 40960
    s_add_u32 s46, s46, s63
    s_mov_b32 m0, 7168
    s_nop 0
    buffer_load_dwordx4 v237, s[64:67], s46 offen lds
    s_xor_b32 s46, s7, 4
    s_mul_i32 s46, s46, 40960
    s_add_u32 s46, s46, s63
    s_mov_b32 m0, 20480
    s_nop 0
    buffer_load_dwordx4 v235, s[64:67], s46 offen lds
    s_xor_b32 s46, s7, 4
    s_mul_i32 s46, s46, 40960
    s_add_u32 s46, s46, s63
    s_mov_b32 m0, 21504
    s_nop 0
    buffer_load_dwordx4 v236, s[64:67], s46 offen lds
    s_xor_b32 s46, s7, 4
    s_mul_i32 s46, s46, 40960
    s_add_u32 s46, s46, s63
    s_mov_b32 m0, 22528
    s_nop 0
    buffer_load_dwordx4 v237, s[64:67], s46 offen lds
    s_xor_b32 s46, s7, 4
    s_mul_i32 s46, s46, 40960
    s_add_u32 s46, s46, s63
    s_mov_b32 m0, 23552
    s_nop 0
    buffer_load_dwordx4 v238, s[64:67], s46 offen lds
    s_xor_b32 s46, s7, 13
    s_mul_i32 s46, s46, 40960
    s_add_u32 s46, s46, s63
    s_mov_b32 m0, 69632
    s_nop 0
    buffer_load_dwordx4 v238, s[64:67], s46 offen lds
    s_xor_b32 s46, s7, 13
    s_mul_i32 s46, s46, 40960
    s_add_u32 s46, s46, s63
    s_mov_b32 m0, 70656
    s_nop 0
    buffer_load_dwordx4 v239, s[64:67], s46 offen lds
    s_xor_b32 s46, s7, 14
    s_mul_i32 s46, s46, 40960
    s_add_u32 s46, s46, s63
    s_mov_b32 m0, 71680
    s_nop 0
    buffer_load_dwordx4 v235, s[64:67], s46 offen lds
    s_xor_b32 s46, s7, 14
    s_mul_i32 s46, s46, 40960
    s_add_u32 s46, s46, s63
    s_mov_b32 m0, 72704
    s_nop 0
    buffer_load_dwordx4 v236, s[64:67], s46 offen lds
    s_mov_b32 s46, 14
    s_call_b64 s[90:91], K1_FC
    s_waitcnt vmcnt(17)
    ds_write_b128 v248, v[88:91] offset:49152
    ds_write_b128 v248, v[92:95] offset:50176
    ds_write_b128 v248, v[96:99] offset:51200
    ds_write_b128 v248, v[100:103] offset:52224
    v_mov_b32 v250, 15
    ds_write_b32 v246, v250
    s_xor_b32 s46, s7, 7
    s_mul_i32 s46, s46, 40960
    s_add_u32 s46, s46, s63
    s_mov_b32 m0, 36864
    s_nop 0
    buffer_load_dwordx4 v236, s[64:67], s46 offen lds
    s_xor_b32 s46, s7, 7
    s_mul_i32 s46, s46, 40960
    s_add_u32 s46, s46, s63
    s_mov_b32 m0, 37888
    s_nop 0
    buffer_load_dwordx4 v237, s[64:67], s46 offen lds
    s_xor_b32 s46, s7, 7
    s_mul_i32 s46, s46, 40960
    s_add_u32 s46, s46, s63
    s_mov_b32 m0, 38912
    s_nop 0
    buffer_load_dwordx4 v238, s[64:67], s46 offen lds
    s_xor_b32 s46, s7, 7
    s_mul_i32 s46, s46, 40960
    s_add_u32 s46, s46, s63
    s_mov_b32 m0, 39936
    s_nop 0
    buffer_load_dwordx4 v239, s[64:67], s46 offen lds
    s_xor_b32 s46, s7, 16
    s_mul_i32 s46, s46, 40960
    s_add_u32 s46, s46, s63
    s_mov_b32 m0, 86016
    s_nop 0
    buffer_load_dwordx4 v239, s[64:67], s46 offen lds
    s_xor_b32 s46, s7, 17
    s_mul_i32 s46, s46, 40960
    s_add_u32 s46, s46, s63
    s_mov_b32 m0, 87040
    s_nop 0
    buffer_load_dwordx4 v235, s[64:67], s46 offen lds
    s_xor_b32 s46, s7, 17
    s_mul_i32 s46, s46, 40960
    s_add_u32 s46, s46, s63
    s_mov_b32 m0, 88064
    s_nop 0
    buffer_load_dwordx4 v236, s[64:67], s46 offen lds
    s_xor_b32 s46, s7, 17
    s_mul_i32 s46, s46, 40960
    s_add_u32 s46, s46, s63
    s_mov_b32 m0, 89088
    s_nop 0
    buffer_load_dwordx4 v237, s[64:67], s46 offen lds
    s_xor_b32 s46, s7, 23
    s_mul_i32 s46, s46, 40960
    s_add_u32 s46, s46, s63
    buffer_load_dwordx4 v[104:107], v236, s[64:67], s46 offen
    s_xor_b32 s46, s7, 23
    s_mul_i32 s46, s46, 40960
    s_add_u32 s46, s46, s63
    buffer_load_dwordx4 v[108:111], v237, s[64:67], s46 offen
    s_xor_b32 s46, s7, 23
    s_mul_i32 s46, s46, 40960
    s_add_u32 s46, s46, s63
    buffer_load_dwordx4 v[112:115], v238, s[64:67], s46 offen
    s_xor_b32 s46, s7, 23
    s_mul_i32 s46, s46, 40960
    s_add_u32 s46, s46, s63
    buffer_load_dwordx4 v[116:119], v239, s[64:67], s46 offen
    s_waitcnt vmcnt(25)
    s_mov_b32 s46, 15
    s_call_b64 s[90:91], K1_FC
    s_xor_b32 s46, s7, 10
    s_mul_i32 s46, s46, 40960
    s_add_u32 s46, s46, s63
    s_mov_b32 m0, 53248
    s_nop 0
    buffer_load_dwordx4 v237, s[64:67], s46 offen lds
    s_xor_b32 s46, s7, 10
    s_mul_i32 s46, s46, 40960
    s_add_u32 s46, s46, s63
    s_mov_b32 m0, 54272
    s_nop 0
    buffer_load_dwordx4 v238, s[64:67], s46 offen lds
    s_xor_b32 s46, s7, 10
    s_mul_i32 s46, s46, 40960
    s_add_u32 s46, s46, s63
    s_mov_b32 m0, 55296
    s_nop 0
    buffer_load_dwordx4 v239, s[64:67], s46 offen lds
    s_xor_b32 s46, s7, 11
    s_mul_i32 s46, s46, 40960
    s_add_u32 s46, s46, s63
    s_mov_b32 m0, 56320
    s_nop 0
    buffer_load_dwordx4 v235, s[64:67], s46 offen lds
    s_xor_b32 s46, s7, 20
    s_mul_i32 s46, s46, 40960
    s_add_u32 s46, s46, s63
    s_mov_b32 m0, 102400
    s_nop 0
    buffer_load_dwordx4 v235, s[64:67], s46 offen lds
    s_xor_b32 s46, s7, 20
    s_mul_i32 s46, s46, 40960
    s_add_u32 s46, s46, s63
    s_mov_b32 m0, 103424
    s_nop 0
    buffer_load_dwordx4 v236, s[64:67], s46 offen lds
    s_xor_b32 s46, s7, 20
    s_mul_i32 s46, s46, 40960
    s_add_u32 s46, s46, s63
    s_mov_b32 m0, 104448
    s_nop 0
    buffer_load_dwordx4 v237, s[64:67], s46 offen lds
    s_xor_b32 s46, s7, 20
    s_mul_i32 s46, s46, 40960
    s_add_u32 s46, s46, s63
    s_mov_b32 m0, 105472
    s_nop 0
    buffer_load_dwordx4 v238, s[64:67], s46 offen lds
    v_lshlrev_b32 v229, 4, v255
    s_lshl_b32 s46, s77, 17
    v_add_u32 v230, s46, v229
    v_xor_b32 v229, 0x20000, v230
    s_lshl_b32 s47, s42, 20
    s_lshl_b32 s46, s76, 18
    s_add_u32 s47, s47, s46
    s_lshl_b32 s46, s56, 15
    s_add_u32 s47, s47, s46
    s_lshl_b32 s46, s10, 14
    s_add_u32 s47, s47, s46
    s_mov_b32 s83, 0
    s_mov_b32 s85, 0
    s_mov_b32 s86, -1
    s_mov_b32 s8, 1
    v_lshrrev_b32 v231, 2, v255
    v_mul_u32_u24 v231, 160, v231
    v_and_b32 v232, 3, v255
    v_lshl_add_u32 v231, v232, 3, v231
    v_lshlrev_b32 v234, 13, v255
    v_and_b32 v228, 31, v255
    v_lshlrev_b32 v228, 7, v228
    v_lshrrev_b32 v227, 5, v255
    v_lshl_add_u32 v228, v227, 17, v228
    s_mov_b32 s4, 0
    s_mul_i32 s46, s10, 81920
    v_add_u32 v231, s46, v231
    s_mov_b32 s80, 0
    s_mov_b32 s81, 0
    s_mov_b32 s82, 0
    s_mov_b32 s84, 0
    s_mov_b32 s11, 0
    s_mov_b32 s49, 0
    s_mov_b32 s6, 0
    s_buffer_load_dword s12, s[36:39], s78 glc
    s_waitcnt vmcnt(32)
    s_waitcnt vmcnt(8)
    s_mov_b32 s46, 16
    s_call_b64 s[90:91], K1_FC
    ds_write_b128 v17, v[20:23]
    ds_write_b128 v248, v[104:107] offset:49152
    ds_write_b128 v248, v[108:111] offset:50176
    ds_write_b128 v248, v[112:115] offset:51200
    ds_write_b128 v248, v[116:119] offset:52224
    s_mov_b32 s5, 2
    s_waitcnt lgkmcnt(0)
    s_call_b64 s[90:91], K1_SVC
    s_mov_b32 s46, s85
    s_call_b64 s[90:91], K1_WV
    s_barrier
    s_setprio 1
    s_branch K1_B0
K1_L2:
    s_waitcnt vmcnt(20)
    s_waitcnt vmcnt(12)
    v_and_b32 v246, 3, v255
    v_lshlrev_b32 v246, 3, v246
    v_add_u32 v246, 133184, v246
    v_mov_b32 v250, 0
    v_mov_b32 v251, 0
    ds_write_b64 v246, v[250:251]
    s_waitcnt lgkmcnt(0)
    s_barrier
    s_mov_b32 s46, 49152
    s_add_u32 m0, s45, 114688
    s_nop 0
    buffer_load_dwordx4 v14, s[32:35], s46 offen offset:0 nt lds
    buffer_load_dwordx4 v9, s[32:35], s46 offen offset:1024 nt lds
    buffer_load_dwordx4 v14, s[32:35], s46 offen offset:2048 nt lds
    buffer_load_dwordx4 v9, s[32:35], s46 offen offset:3072 nt lds
    s_waitcnt vmcnt(12)
    v_mov_b32 v250, 1
    ds_write_b32 v246, v250
    s_mov_b32 s46, 65536
    s_add_u32 m0, s45, 0
    s_nop 0
    buffer_load_dwordx4 v10, s[28:31], s46 offen offset:0 nt lds
    buffer_load_dwordx4 v11, s[28:31], s46 offen offset:1024 nt lds
    buffer_load_dwordx4 v12, s[28:31], s46 offen offset:2048 nt lds
    buffer_load_dwordx4 v13, s[28:31], s46 offen offset:3072 nt lds
    s_waitcnt vmcnt(8)
    v_mov_b32 v250, 2
    ds_write_b32 v246, v250
    s_mov_b32 s46, 1
    s_call_b64 s[90:91], K1_FC
    s_mov_b32 s46, 65536
    s_add_u32 m0, s45, 65536
    s_nop 0
    buffer_load_dwordx4 v14, s[32:35], s46 offen offset:0 nt lds
    buffer_load_dwordx4 v9, s[32:35], s46 offen offset:1024 nt lds
    buffer_load_dwordx4 v14, s[32:35], s46 offen offset:2048 nt lds
    buffer_load_dwordx4 v9, s[32:35], s46 offen offset:3072 nt lds
    s_mov_b32 s46, 81920
    s_add_u32 m0, s45, 16384
    s_nop 0
    buffer_load_dwordx4 v10, s[28:31], s46 offen offset:0 nt lds
    buffer_load_dwordx4 v11, s[28:31], s46 offen offset:1024 nt lds
    buffer_load_dwordx4 v12, s[28:31], s46 offen offset:2048 nt lds
    buffer_load_dwordx4 v13, s[28:31], s46 offen offset:3072 nt lds
    s_waitcnt vmcnt(8)
    v_mov_b32 v250, 3
    ds_write_b32 v246, v250
    s_mov_b32 s46, 2
    s_call_b64 s[90:91], K1_FC
    s_mov_b32 s46, 81920
    s_add_u32 m0, s45, 81920
    s_nop 0
    buffer_load_dwordx4 v14, s[32:35], s46 offen offset:0 nt lds
    buffer_load_dwordx4 v9, s[32:35], s46 offen offset:1024 nt lds
    buffer_load_dwordx4 v14, s[32:35], s46 offen offset:2048 nt lds
    buffer_load_dwordx4 v9, s[32:35], s46 offen offset:3072 nt lds
    s_mov_b32 s46, 98304
    s_add_u32 m0, s45, 32768
    s_nop 0
    buffer_load_dwordx4 v10, s[28:31], s46 offen offset:0 nt lds
    buffer_load_dwordx4 v11, s[28:31], s46 offen offset:1024 nt lds
    buffer_load_dwordx4 v12, s[28:31], s46 offen offset:2048 nt lds
    buffer_load_dwordx4 v13, s[28:31], s46 offen offset:3072 nt lds
    s_waitcnt vmcnt(8)
    v_mov_b32 v250, 4
    ds_write_b32 v246, v250
    s_mov_b32 s46, 3
    s_call_b64 s[90:91], K1_FC
    s_mov_b32 s46, 98304
    s_add_u32 m0, s45, 98304
    s_nop 0
    buffer_load_dwordx4 v14, s[32:35], s46 offen offset:0 nt lds
    buffer_load_dwordx4 v9, s[32:35], s46 offen offset:1024 nt lds
    buffer_load_dwordx4 v14, s[32:35], s46 offen offset:2048 nt lds
    buffer_load_dwordx4 v9, s[32:35], s46 offen offset:3072 nt lds
    s_mov_b32 s46, 114688
    s_add_u32 m0, s45, 49152
    s_nop 0
    buffer_load_dwordx4 v10, s[28:31], s46 offen offset:0 nt lds
    buffer_load_dwordx4 v11, s[28:31], s46 offen offset:1024 nt lds
    buffer_load_dwordx4 v12, s[28:31], s46 offen offset:2048 nt lds
    buffer_load_dwordx4 v13, s[28:31], s46 offen offset:3072 nt lds
    s_waitcnt vmcnt(8)
    v_mov_b32 v250, 5
    ds_write_b32 v246, v250
    s_and_b32 s46, s42, 3
    s_lshl_b32 s46, s46, 3
    s_add_u32 s46, s46, s57
    s_lshl_b32 s62, s56, 5
    s_add_u32 s46, s46, s62
    s_mul_i32 s46, s46, 40960
    s_add_u32 s46, s46, 16384
    v_lshlrev_b32 v19, 7, v255
    buffer_load_dword v18, v19, s[64:67], s46 offen
    s_mov_b32 s46, 4
    s_call_b64 s[90:91], K1_FC
    s_mov_b32 s46, 114688
    s_add_u32 m0, s45, 114688
    s_nop 0
    buffer_load_dwordx4 v14, s[32:35], s46 offen offset:0 nt lds
    buffer_load_dwordx4 v9, s[32:35], s46 offen offset:1024 nt lds
    buffer_load_dwordx4 v14, s[32:35], s46 offen offset:2048 nt lds
    buffer_load_dwordx4 v9, s[32:35], s46 offen offset:3072 nt lds
    s_mov_b32 s46, 131072
    s_add_u32 m0, s45, 0
    s_nop 0
    buffer_load_dwordx4 v10, s[28:31], s46 offen offset:0 nt lds
    buffer_load_dwordx4 v11, s[28:31], s46 offen offset:1024 nt lds
    buffer_load_dwordx4 v12, s[28:31], s46 offen offset:2048 nt lds
    buffer_load_dwordx4 v13, s[28:31], s46 offen offset:3072 nt lds
    s_waitcnt vmcnt(9)
    v_mov_b32 v250, 6
    ds_write_b32 v246, v250
    s_mov_b32 s46, 5
    s_call_b64 s[90:91], K1_FC
    s_mov_b32 s46, 131072
    s_add_u32 m0, s45, 65536
    s_nop 0
    buffer_load_dwordx4 v14, s[32:35], s46 offen offset:0 nt lds
    buffer_load_dwordx4 v9, s[32:35], s46 offen offset:1024 nt lds
    buffer_load_dwordx4 v14, s[32:35], s46 offen offset:2048 nt lds
    buffer_load_dwordx4 v9, s[32:35], s46 offen offset:3072 nt lds
    s_mov_b32 s46, 147456
    s_add_u32 m0, s45, 16384
    s_nop 0
    buffer_load_dwordx4 v10, s[28:31], s46 offen offset:0 nt lds
    buffer_load_dwordx4 v11, s[28:31], s46 offen offset:1024 nt lds
    buffer_load_dwordx4 v12, s[28:31], s46 offen offset:2048 nt lds
    buffer_load_dwordx4 v13, s[28:31], s46 offen offset:3072 nt lds
    s_waitcnt vmcnt(8)
    v_mov_b32 v250, 7
    ds_write_b32 v246, v250
    s_mov_b32 s46, 6
    s_call_b64 s[90:91], K1_FC
    s_mov_b32 s46, 147456
    s_add_u32 m0, s45, 81920
    s_nop 0
    buffer_load_dwordx4 v14, s[32:35], s46 offen offset:0 nt lds
    buffer_load_dwordx4 v9, s[32:35], s46 offen offset:1024 nt lds
    buffer_load_dwordx4 v14, s[32:35], s46 offen offset:2048 nt lds
    buffer_load_dwordx4 v9, s[32:35], s46 offen offset:3072 nt lds
    s_mov_b32 s46, 163840
    s_add_u32 m0, s45, 32768
    s_nop 0
    buffer_load_dwordx4 v10, s[28:31], s46 offen offset:0 nt lds
    buffer_load_dwordx4 v11, s[28:31], s46 offen offset:1024 nt lds
    buffer_load_dwordx4 v12, s[28:31], s46 offen offset:2048 nt lds
    buffer_load_dwordx4 v13, s[28:31], s46 offen offset:3072 nt lds
    s_waitcnt vmcnt(8)
    v_mov_b32 v250, 8
    ds_write_b32 v246, v250
    s_mov_b32 s46, 7
    s_call_b64 s[90:91], K1_FC
    s_mov_b32 s46, 163840
    s_add_u32 m0, s45, 98304
    s_nop 0
    buffer_load_dwordx4 v14, s[32:35], s46 offen offset:0 nt lds
    buffer_load_dwordx4 v9, s[32:35], s46 offen offset:1024 nt lds
    buffer_load_dwordx4 v14, s[32:35], s46 offen offset:2048 nt lds
    buffer_load_dwordx4 v9, s[32:35], s46 offen offset:3072 nt lds
    s_mov_b32 s46, 180224
    s_add_u32 m0, s45, 49152
    s_nop 0
    buffer_load_dwordx4 v10, s[28:31], s46 offen offset:0 nt lds
    buffer_load_dwordx4 v11, s[28:31], s46 offen offset:1024 nt lds
    buffer_load_dwordx4 v12, s[28:31], s46 offen offset:2048 nt lds
    buffer_load_dwordx4 v13, s[28:31], s46 offen offset:3072 nt lds
    s_waitcnt vmcnt(8)
    v_mov_b32 v250, 9
    ds_write_b32 v246, v250
    s_mov_b32 s46, 8
    s_call_b64 s[90:91], K1_FC
    s_mov_b32 s46, 180224
    s_add_u32 m0, s45, 114688
    s_nop 0
    buffer_load_dwordx4 v14, s[32:35], s46 offen offset:0 nt lds
    buffer_load_dwordx4 v9, s[32:35], s46 offen offset:1024 nt lds
    buffer_load_dwordx4 v14, s[32:35], s46 offen offset:2048 nt lds
    buffer_load_dwordx4 v9, s[32:35], s46 offen offset:3072 nt lds
    s_mov_b32 s46, 196608
    s_add_u32 m0, s45, 0
    s_nop 0
    buffer_load_dwordx4 v10, s[28:31], s46 offen offset:0 nt lds
    buffer_load_dwordx4 v11, s[28:31], s46 offen offset:1024 nt lds
    buffer_load_dwordx4 v12, s[28:31], s46 offen offset:2048 nt lds
    buffer_load_dwordx4 v13, s[28:31], s46 offen offset:3072 nt lds
    s_waitcnt vmcnt(8)
    v_mov_b32 v250, 10
    ds_write_b32 v246, v250
    s_xor_b32 s46, s7, 26
    s_mul_i32 s46, s46, 40960
    s_add_u32 s46, s46, s63
    s_mov_b32 m0, 137216
    s_nop 0
    buffer_load_dwordx4 v239, s[64:67], s46 offen lds
    s_xor_b32 s46, s7, 27
    s_mul_i32 s46, s46, 40960
    s_add_u32 s46, s46, s63
    s_mov_b32 m0, 141312
    s_nop 0
    buffer_load_dwordx4 v238, s[64:67], s46 offen lds
    s_xor_b32 s46, s7, 28
    s_mul_i32 s46, s46, 40960
    s_add_u32 s46, s46, s63
    s_mov_b32 m0, 145408
    s_nop 0
    buffer_load_dwordx4 v237, s[64:67], s46 offen lds
    s_mov_b32 s46, 9
    s_call_b64 s[90:91], K1_FC
    s_mov_b32 s46, 196608
    s_add_u32 m0, s45, 65536
    s_nop 0
    buffer_load_dwordx4 v14, s[32:35], s46 offen offset:0 nt lds
    buffer_load_dwordx4 v9, s[32:35], s46 offen offset:1024 nt lds
    buffer_load_dwordx4 v14, s[32:35], s46 offen offset:2048 nt lds
    buffer_load_dwordx4 v9, s[32:35], s46 offen offset:3072 nt lds
    s_mov_b32 s46, 212992
    s_add_u32 m0, s45, 16384
    s_nop 0
    buffer_load_dwordx4 v10, s[28:31], s46 offen offset:0 nt lds
    buffer_load_dwordx4 v11, s[28:31], s46 offen offset:1024 nt lds
    buffer_load_dwordx4 v12, s[28:31], s46 offen offset:2048 nt lds
    buffer_load_dwordx4 v13, s[28:31], s46 offen offset:3072 nt lds
    s_waitcnt vmcnt(11)
    v_mov_b32 v250, 11
    ds_write_b32 v246, v250
    s_mov_b32 s46, 229376
    buffer_load_dwordx4 v[24:27], v10, s[28:31], s46 offen offset:0 nt
    buffer_load_dwordx4 v[28:31], v11, s[28:31], s46 offen offset:1024 nt
    buffer_load_dwordx4 v[32:35], v12, s[28:31], s46 offen offset:2048 nt
    buffer_load_dwordx4 v[36:39], v13, s[28:31], s46 offen offset:3072 nt
    s_mov_b32 s46, 212992
    buffer_load_dwordx4 v[40:43], v14, s[32:35], s46 offen offset:0 nt
    buffer_load_dwordx4 v[44:47], v9, s[32:35], s46 offen offset:1024 nt
    buffer_load_dwordx4 v[48:51], v14, s[32:35], s46 offen offset:2048 nt
    buffer_load_dwordx4 v[52:55], v9, s[32:35], s46 offen offset:3072 nt
    s_waitcnt vmcnt(8)
    v_mov_b32 v250, 12
    ds_write_b32 v246, v250
    s_mov_b32 s46, 10
    s_call_b64 s[90:91], K1_FC
    s_mov_b32 s46, 245760
    buffer_load_dwordx4 v[56:59], v10, s[28:31], s46 offen offset:0 nt
    buffer_load_dwordx4 v[60:63], v11, s[28:31], s46 offen offset:1024 nt
    buffer_load_dwordx4 v[64:67], v12, s[28:31], s46 offen offset:2048 nt
    buffer_load_dwordx4 v[68:71], v13, s[28:31], s46 offen offset:3072 nt
    s_mov_b32 s46, 229376
    buffer_load_dwordx4 v[72:75], v14, s[32:35], s46 offen offset:0 nt
    buffer_load_dwordx4 v[76:79], v9, s[32:35], s46 offen offset:1024 nt
    buffer_load_dwordx4 v[80:83], v14, s[32:35], s46 offen offset:2048 nt
    buffer_load_dwordx4 v[84:87], v9, s[32:35], s46 offen offset:3072 nt
    s_mov_b32 s46, 245760
    buffer_load_dwordx4 v[88:91], v14, s[32:35], s46 offen offset:0 nt
    buffer_load_dwordx4 v[92:95], v9, s[32:35], s46 offen offset:1024 nt
    buffer_load_dwordx4 v[96:99], v14, s[32:35], s46 offen offset:2048 nt
    buffer_load_dwordx4 v[100:103], v9, s[32:35], s46 offen offset:3072 nt
    s_xor_b32 s46, s7, 30
    s_mul_i32 s46, s46, 40960
    s_add_u32 s46, s46, s63
    s_mov_b32 m0, 155648
    s_nop 0
    buffer_load_dwordx4 v237, s[64:67], s46 offen lds
    s_xor_b32 s46, s7, 30
    s_mul_i32 s46, s46, 40960
    s_add_u32 s46, s46, s63
    s_mov_b32 m0, 156672
    s_nop 0
    buffer_load_dwordx4 v238, s[64:67], s46 offen lds
    s_xor_b32 s46, s7, 30
    s_mul_i32 s46, s46, 40960
    s_add_u32 s46, s46, s63
    s_mov_b32 m0, 157696
    s_nop 0
    buffer_load_dwordx4 v239, s[64:67], s46 offen lds
    s_xor_b32 s46, s7, 31
    s_mul_i32 s46, s46, 40960
    s_add_u32 s46, s46, s63
    s_mov_b32 m0, 158720
    s_nop 0
    buffer_load_dwordx4 v235, s[64:67], s46 offen lds
    s_xor_b32 s46, s7, 26
    s_mul_i32 s46, s46, 40960
    s_add_u32 s46, s46, s63
    buffer_load_dwordx4 v[20:23], v235, s[64:67], s46 offen
    v_lshlrev_b32 v17, 4, v255
    v_add_u32 v17, 133120, v17
    s_mov_b32 s46, 11
    s_call_b64 s[90:91], K1_FC
    s_mov_b32 s46, 12
    s_call_b64 s[90:91], K1_FC
    s_waitcnt vmcnt(21)
    ds_write_b128 v247, v[24:27] offset:32768
    ds_write_b128 v247, v[28:31] offset:33792
    ds_write_b128 v247, v[32:35] offset:34816
    ds_write_b128 v247, v[36:39] offset:35840
    s_waitcnt vmcnt(17)
    ds_write_b128 v248, v[40:43] offset:16384
    ds_write_b128 v248, v[44:47] offset:17408
    ds_write_b128 v248, v[48:51] offset:18432
    ds_write_b128 v248, v[52:55] offset:19456
    v_mov_b32 v250, 13
    ds_write_b32 v246, v250
    s_mov_b32 s46, 13
    s_call_b64 s[90:91], K1_FC
    s_waitcnt vmcnt(13)
    ds_write_b128 v247, v[56:59] offset:49152
    ds_write_b128 v247, v[60:63] offset:50176
    ds_write_b128 v247, v[64:67] offset:51200
    ds_write_b128 v247, v[68:71] offset:52224
    s_waitcnt vmcnt(9)
    ds_write_b128 v248, v[72:75] offset:32768
    ds_write_b128 v248, v[76:79] offset:33792
    ds_write_b128 v248, v[80:83] offset:34816
    ds_write_b128 v248, v[84:87] offset:35840
    v_mov_b32 v250, 14
    ds_write_b32 v246, v250
    s_xor_b32 s46, s7, 1
    s_mul_i32 s46, s46, 40960
    s_add_u32 s46, s46, s63
    s_mov_b32 m0, 8192
    s_nop 0
    buffer_load_dwordx4 v238, s[64:67], s46 offen lds
    s_xor_b32 s46, s7, 1
    s_mul_i32 s46, s46, 40960
    s_add_u32 s46, s46, s63
    s_mov_b32 m0, 9216
    s_nop 0
    buffer_load_dwordx4 v239, s[64:67], s46 offen lds
    s_xor_b32 s46, s7, 2
    s_mul_i32 s46, s46, 40960
    s_add_u32 s46, s46, s63
    s_mov_b32 m0, 10240
    s_nop 0
    buffer_load_dwordx4 v235, s[64:67], s46 offen lds
    s_xor_b32 s46, s7, 2
    s_mul_i32 s46, s46, 40960
    s_add_u32 s46, s46, s63
    s_mov_b32 m0, 11264
    s_nop 0
    buffer_load_dwordx4 v236, s[64:67], s46 offen lds
    s_xor_b32 s46, s7, 4
    s_mul_i32 s46, s46, 40960
    s_add_u32 s46, s46, s63
    s_mov_b32 m0, 24576
    s_nop 0
    buffer_load_dwordx4 v239, s[64:67], s46 offen lds
    s_xor_b32 s46, s7, 5
    s_mul_i32 s46, s46, 40960
    s_add_u32 s46, s46, s63
    s_mov_b32 m0, 25600
    s_nop 0
    buffer_load_dwordx4 v235, s[64:67], s46 offen lds
    s_xor_b32 s46, s7, 5
    s_mul_i32 s46, s46, 40960
    s_add_u32 s46, s46, s63
    s_mov_b32 m0, 26624
    s_nop 0
    buffer_load_dwordx4 v236, s[64:67], s46 offen lds
    s_xor_b32 s46, s7, 5
    s_mul_i32 s46, s46, 40960
    s_add_u32 s46, s46, s63
    s_mov_b32 m0, 27648
    s_nop 0
    buffer_load_dwordx4 v237, s[64:67], s46 offen lds
    s_xor_b32 s46, s7, 14
    s_mul_i32 s46, s46, 40960
    s_add_u32 s46, s46, s63
    s_mov_b32 m0, 73728
    s_nop 0
    buffer_load_dwordx4 v237, s[64:67], s46 offen lds
    s_xor_b32 s46, s7, 14
    s_mul_i32 s46, s46, 40960
    s_add_u32 s46, s46, s63
    s_mov_b32 m0, 74752
    s_nop 0
    buffer_load_dwordx4 v238, s[64:67], s46 offen lds
    s_xor_b32 s46, s7, 14
    s_mul_i32 s46, s46, 40960
    s_add_u32 s46, s46, s63
    s_mov_b32 m0, 75776
    s_nop 0
    buffer_load_dwordx4 v239, s[64:67], s46 offen lds
    s_xor_b32 s46, s7, 15
    s_mul_i32 s46, s46, 40960
    s_add_u32 s46, s46, s63
    s_mov_b32 m0, 76800
    s_nop 0
    buffer_load_dwordx4 v235, s[64:67], s46 offen lds
    s_mov_b32 s46, 14
    s_call_b64 s[90:91], K1_FC
    s_waitcnt vmcnt(17)
    ds_write_b128 v248, v[88:91] offset:49152
    ds_write_b128 v248, v[92:95] offset:50176
    ds_write_b128 v248, v[96:99] offset:51200
    ds_write_b128 v248, v[100:103] offset:52224
    v_mov_b32 v250, 15
    ds_write_b32 v246, v250
    s_xor_b32 s46, s7, 8
    s_mul_i32 s46, s46, 40960
    s_add_u32 s46, s46, s63
    s_mov_b32 m0, 40960
    s_nop 0
    buffer_load_dwordx4 v235, s[64:67], s46 offen lds
    s_xor_b32 s46, s7, 8
    s_mul_i32 s46, s46, 40960
    s_add_u32 s46, s46, s63
    s_mov_b32 m0, 41984
    s_nop 0
    buffer_load_dwordx4 v236, s[64:67], s46 offen lds
    s_xor_b32 s46, s7, 8
    s_mul_i32 s46, s46, 40960
    s_add_u32 s46, s46, s63
    s_mov_b32 m0, 43008
    s_nop 0
    buffer_load_dwordx4 v237, s[64:67], s46 offen lds
    s_xor_b32 s46, s7, 8
    s_mul_i32 s46, s46, 40960
    s_add_u32 s46, s46, s63
    s_mov_b32 m0, 44032
    s_nop 0
    buffer_load_dwordx4 v238, s[64:67], s46 offen lds
    s_xor_b32 s46, s7, 17
    s_mul_i32 s46, s46, 40960
    s_add_u32 s46, s46, s63
    s_mov_b32 m0, 90112
    s_nop 0
    buffer_load_dwordx4 v238, s[64:67], s46 offen lds
    s_xor_b32 s46, s7, 17
    s_mul_i32 s46, s46, 40960
    s_add_u32 s46, s46, s63
    s_mov_b32 m0, 91136
    s_nop 0
    buffer_load_dwordx4 v239, s[64:67], s46 offen lds
    s_xor_b32 s46, s7, 18
    s_mul_i32 s46, s46, 40960
    s_add_u32 s46, s46, s63
    s_mov_b32 m0, 92160
    s_nop 0
    buffer_load_dwordx4 v235, s[64:67], s46 offen lds
    s_xor_b32 s46, s7, 18
    s_mul_i32 s46, s46, 40960
    s_add_u32 s46, s46, s63
    s_mov_b32 m0, 93184
    s_nop 0
    buffer_load_dwordx4 v236, s[64:67], s46 offen lds
    s_xor_b32 s46, s7, 24
    s_mul_i32 s46, s46, 40960
    s_add_u32 s46, s46, s63
    buffer_load_dwordx4 v[104:107], v235, s[64:67], s46 offen
    s_xor_b32 s46, s7, 24
    s_mul_i32 s46, s46, 40960
    s_add_u32 s46, s46, s63
    buffer_load_dwordx4 v[108:111], v236, s[64:67], s46 offen
    s_xor_b32 s46, s7, 24
    s_mul_i32 s46, s46, 40960
    s_add_u32 s46, s46, s63
    buffer_load_dwordx4 v[112:115], v237, s[64:67], s46 offen
    s_xor_b32 s46, s7, 24
    s_mul_i32 s46, s46, 40960
    s_add_u32 s46, s46, s63
    buffer_load_dwordx4 v[116:119], v238, s[64:67], s46 offen
    s_waitcnt vmcnt(25)
    s_mov_b32 s46, 15
    s_call_b64 s[90:91], K1_FC
    s_xor_b32 s46, s7, 11
    s_mul_i32 s46, s46, 40960
    s_add_u32 s46, s46, s63
    s_mov_b32 m0, 57344
    s_nop 0
    buffer_load_dwordx4 v236, s[64:67], s46 offen lds
    s_xor_b32 s46, s7, 11
    s_mul_i32 s46, s46, 40960
    s_add_u32 s46, s46, s63
    s_mov_b32 m0, 58368
    s_nop 0
    buffer_load_dwordx4 v237, s[64:67], s46 offen lds
    s_xor_b32 s46, s7, 11
    s_mul_i32 s46, s46, 40960
    s_add_u32 s46, s46, s63
    s_mov_b32 m0, 59392
    s_nop 0
    buffer_load_dwordx4 v238, s[64:67], s46 offen lds
    s_xor_b32 s46, s7, 11
    s_mul_i32 s46, s46, 40960
    s_add_u32 s46, s46, s63
    s_mov_b32 m0, 60416
    s_nop 0
    buffer_load_dwordx4 v239, s[64:67], s46 offen lds
    s_xor_b32 s46, s7, 20
    s_mul_i32 s46, s46, 40960
    s_add_u32 s46, s46, s63
    s_mov_b32 m0, 106496
    s_nop 0
    buffer_load_dwordx4 v239, s[64:67], s46 offen lds
    s_xor_b32 s46, s7, 21
    s_mul_i32 s46, s46, 40960
    s_add_u32 s46, s46, s63
    s_mov_b32 m0, 107520
    s_nop 0
    buffer_load_dwordx4 v235, s[64:67], s46 offen lds
    s_xor_b32 s46, s7, 21
    s_mul_i32 s46, s46, 40960
    s_add_u32 s46, s46, s63
    s_mov_b32 m0, 108544
    s_nop 0
    buffer_load_dwordx4 v236, s[64:67], s46 offen lds
    s_xor_b32 s46, s7, 21
    s_mul_i32 s46, s46, 40960
    s_add_u32 s46, s46, s63
    s_mov_b32 m0, 109568
    s_nop 0
    buffer_load_dwordx4 v237, s[64:67], s46 offen lds
    v_lshlrev_b32 v229, 4, v255
    s_lshl_b32 s46, s77, 17
    v_add_u32 v230, s46, v229
    v_xor_b32 v229, 0x20000, v230
    s_lshl_b32 s47, s42, 20
    s_lshl_b32 s46, s76, 18
    s_add_u32 s47, s47, s46
    s_lshl_b32 s46, s56, 15
    s_add_u32 s47, s47, s46
    s_lshl_b32 s46, s10, 14
    s_add_u32 s47, s47, s46
    s_mov_b32 s83, 0
    s_mov_b32 s85, 0
    s_mov_b32 s86, -1
    s_mov_b32 s8, 1
    v_lshrrev_b32 v231, 2, v255
    v_mul_u32_u24 v231, 160, v231
    v_and_b32 v232, 3, v255
    v_lshl_add_u32 v231, v232, 3, v231
    v_lshlrev_b32 v234, 13, v255
    v_and_b32 v228, 31, v255
    v_lshlrev_b32 v228, 7, v228
    v_lshrrev_b32 v227, 5, v255
    v_lshl_add_u32 v228, v227, 17, v228
    s_mov_b32 s4, 0
    s_mul_i32 s46, s10, 81920
    v_add_u32 v231, s46, v231
    s_mov_b32 s80, 0
    s_mov_b32 s81, 0
    s_mov_b32 s82, 0
    s_mov_b32 s84, 0
    s_mov_b32 s11, 0
    s_mov_b32 s49, 0
    s_mov_b32 s6, 0
    s_buffer_load_dword s12, s[36:39], s78 glc
    s_waitcnt vmcnt(32)
    s_waitcnt vmcnt(8)
    s_mov_b32 s46, 16
    s_call_b64 s[90:91], K1_FC
    ds_write_b128 v17, v[20:23]
    ds_write_b128 v248, v[104:107] offset:49152
    ds_write_b128 v248, v[108:111] offset:50176
    ds_write_b128 v248, v[112:115] offset:51200
    ds_write_b128 v248, v[116:119] offset:52224
    s_mov_b32 s5, 2
    s_waitcnt lgkmcnt(0)
    s_call_b64 s[90:91], K1_SVC
    s_mov_b32 s46, s85
    s_call_b64 s[90:91], K1_WV
    s_barrier
    s_setprio 1
    s_branch K1_B0
K1_L3:
    s_waitcnt vmcnt(20)
    s_waitcnt vmcnt(12)
    v_and_b32 v246, 3, v255
    v_lshlrev_b32 v246, 3, v246
    v_add_u32 v246, 134240, v246
    v_mov_b32 v250, 0
    v_mov_b32 v251, 0
    ds_write_b64 v246, v[250:251]
    s_waitcnt lgkmcnt(0)
    s_barrier
    s_mov_b32 s46, 49152
    s_add_u32 m0, s45, 114688
    s_nop 0
    buffer_load_dwordx4 v14, s[32:35], s46 offen offset:0 nt lds
    buffer_load_dwordx4 v9, s[32:35], s46 offen offset:1024 nt lds
    buffer_load_dwordx4 v14, s[32:35], s46 offen offset:2048 nt lds
    buffer_load_dwordx4 v9, s[32:35], s46 offen offset:3072 nt lds
    s_waitcnt vmcnt(12)
    v_mov_b32 v250, 1
    ds_write_b32 v246, v250
    s_mov_b32 s46, 65536
    s_add_u32 m0, s45, 0
    s_nop 0
    buffer_load_dwordx4 v10, s[28:31], s46 offen offset:0 nt lds
    buffer_load_dwordx4 v11, s[28:31], s46 offen offset:1024 nt lds
    buffer_load_dwordx4 v12, s[28:31], s46 offen offset:2048 nt lds
    buffer_load_dwordx4 v13, s[28:31], s46 offen offset:3072 nt lds
    s_waitcnt vmcnt(8)
    v_mov_b32 v250, 2
    ds_write_b32 v246, v250
    v_mov_b32 v2, 0
    v_lshlrev_b32 v3, 9, v255
    s_mov_b64 exec, 1023
    buffer_store_dword v2, v3, s[36:39], s54 offen sc0 sc1
    s_mov_b64 exec, -1
    s_mov_b32 s46, 1
    s_call_b64 s[90:91], K1_FC
    s_mov_b32 s46, 65536
    s_add_u32 m0, s45, 65536
    s_nop 0
    buffer_load_dwordx4 v14, s[32:35], s46 offen offset:0 nt lds
    buffer_load_dwordx4 v9, s[32:35], s46 offen offset:1024 nt lds
    buffer_load_dwordx4 v14, s[32:35], s46 offen offset:2048 nt lds
    buffer_load_dwordx4 v9, s[32:35], s46 offen offset:3072 nt lds
    s_mov_b32 s46, 81920
    s_add_u32 m0, s45, 16384
    s_nop 0
    buffer_load_dwordx4 v10, s[28:31], s46 offen offset:0 nt lds
    buffer_load_dwordx4 v11, s[28:31], s46 offen offset:1024 nt lds
    buffer_load_dwordx4 v12, s[28:31], s46 offen offset:2048 nt lds
    buffer_load_dwordx4 v13, s[28:31], s46 offen offset:3072 nt lds
    s_waitcnt vmcnt(9)
    v_mov_b32 v250, 3
    ds_write_b32 v246, v250
    s_mov_b32 s46, 2
    s_call_b64 s[90:91], K1_FC
    s_mov_b32 s46, 81920
    s_add_u32 m0, s45, 81920
    s_nop 0
    buffer_load_dwordx4 v14, s[32:35], s46 offen offset:0 nt lds
    buffer_load_dwordx4 v9, s[32:35], s46 offen offset:1024 nt lds
    buffer_load_dwordx4 v14, s[32:35], s46 offen offset:2048 nt lds
    buffer_load_dwordx4 v9, s[32:35], s46 offen offset:3072 nt lds
    s_mov_b32 s46, 98304
    s_add_u32 m0, s45, 32768
    s_nop 0
    buffer_load_dwordx4 v10, s[28:31], s46 offen offset:0 nt lds
    buffer_load_dwordx4 v11, s[28:31], s46 offen offset:1024 nt lds
    buffer_load_dwordx4 v12, s[28:31], s46 offen offset:2048 nt lds
    buffer_load_dwordx4 v13, s[28:31], s46 offen offset:3072 nt lds
    s_waitcnt vmcnt(8)
    v_mov_b32 v250, 4
    ds_write_b32 v246, v250
    s_mov_b32 s46, 3
    s_call_b64 s[90:91], K1_FC
    s_mov_b32 s46, 98304
    s_add_u32 m0, s45, 98304
    s_nop 0
    buffer_load_dwordx4 v14, s[32:35], s46 offen offset:0 nt lds
    buffer_load_dwordx4 v9, s[32:35], s46 offen offset:1024 nt lds
    buffer_load_dwordx4 v14, s[32:35], s46 offen offset:2048 nt lds
    buffer_load_dwordx4 v9, s[32:35], s46 offen offset:3072 nt lds
    s_mov_b32 s46, 114688
    s_add_u32 m0, s45, 49152
    s_nop 0
    buffer_load_dwordx4 v10, s[28:31], s46 offen offset:0 nt lds
    buffer_load_dwordx4 v11, s[28:31], s46 offen offset:1024 nt lds
    buffer_load_dwordx4 v12, s[28:31], s46 offen offset:2048 nt lds
    buffer_load_dwordx4 v13, s[28:31], s46 offen offset:3072 nt lds
    s_waitcnt vmcnt(8)
    v_mov_b32 v250, 5
    ds_write_b32 v246, v250
    v_mov_b32 v2, 1
    v_mov_b32 v5, 4
    s_lshl_b32 s46, s42, 4
    s_mov_b64 exec, 1
    buffer_atomic_add v2, v5, s[68:71], s46 offen sc1
    s_mov_b64 exec, -1
    s_mov_b32 s46, 4
    s_call_b64 s[90:91], K1_FC
    s_mov_b32 s46, 114688
    s_add_u32 m0, s45, 114688
    s_nop 0
    buffer_load_dwordx4 v14, s[32:35], s46 offen offset:0 nt lds
    buffer_load_dwordx4 v9, s[32:35], s46 offen offset:1024 nt lds
    buffer_load_dwordx4 v14, s[32:35], s46 offen offset:2048 nt lds
    buffer_load_dwordx4 v9, s[32:35], s46 offen offset:3072 nt lds
    s_mov_b32 s46, 131072
    s_add_u32 m0, s45, 0
    s_nop 0
    buffer_load_dwordx4 v10, s[28:31], s46 offen offset:0 nt lds
    buffer_load_dwordx4 v11, s[28:31], s46 offen offset:1024 nt lds
    buffer_load_dwordx4 v12, s[28:31], s46 offen offset:2048 nt lds
    buffer_load_dwordx4 v13, s[28:31], s46 offen offset:3072 nt lds
    s_waitcnt vmcnt(9)
    v_mov_b32 v250, 6
    ds_write_b32 v246, v250
    s_and_b32 s46, s42, 3
    s_lshl_b32 s46, s46, 3
    s_add_u32 s46, s46, s57
    s_lshl_b32 s62, s56, 5
    s_add_u32 s46, s46, s62
    s_mul_i32 s46, s46, 40960
    s_add_u32 s46, s46, 24576
    v_lshlrev_b32 v19, 7, v255
    buffer_load_dword v18, v19, s[64:67], s46 offen
    s_mov_b32 s46, 5
    s_call_b64 s[90:91], K1_FC
    s_mov_b32 s46, 131072
    s_add_u32 m0, s45, 65536
    s_nop 0
    buffer_load_dwordx4 v14, s[32:35], s46 offen offset:0 nt lds
    buffer_load_dwordx4 v9, s[32:35], s46 offen offset:1024 nt lds
    buffer_load_dwordx4 v14, s[32:35], s46 offen offset:2048 nt lds
    buffer_load_dwordx4 v9, s[32:35], s46 offen offset:3072 nt lds
    s_mov_b32 s46, 147456
    s_add_u32 m0, s45, 16384
    s_nop 0
    buffer_load_dwordx4 v10, s[28:31], s46 offen offset:0 nt lds
    buffer_load_dwordx4 v11, s[28:31], s46 offen offset:1024 nt lds
    buffer_load_dwordx4 v12, s[28:31], s46 offen offset:2048 nt lds
    buffer_load_dwordx4 v13, s[28:31], s46 offen offset:3072 nt lds
    s_waitcnt vmcnt(9)
    v_mov_b32 v250, 7
    ds_write_b32 v246, v250
    s_mov_b32 s46, 6
    s_call_b64 s[90:91], K1_FC
    s_mov_b32 s46, 147456
    s_add_u32 m0, s45, 81920
    s_nop 0
    buffer_load_dwordx4 v14, s[32:35], s46 offen offset:0 nt lds
    buffer_load_dwordx4 v9, s[32:35], s46 offen offset:1024 nt lds
    buffer_load_dwordx4 v14, s[32:35], s46 offen offset:2048 nt lds
    buffer_load_dwordx4 v9, s[32:35], s46 offen offset:3072 nt lds
    s_mov_b32 s46, 163840
    s_add_u32 m0, s45, 32768
    s_nop 0
    buffer_load_dwordx4 v10, s[28:31], s46 offen offset:0 nt lds
    buffer_load_dwordx4 v11, s[28:31], s46 offen offset:1024 nt lds
    buffer_load_dwordx4 v12, s[28:31], s46 offen offset:2048 nt lds
    buffer_load_dwordx4 v13, s[28:31], s46 offen offset:3072 nt lds
    s_waitcnt vmcnt(8)
    v_mov_b32 v250, 8
    ds_write_b32 v246, v250
    s_lshl_b32 s46, s42, 4
    buffer_load_dword v4, v5, s[68:71], s46 offen sc0 sc1
    s_mov_b32 s46, 7
    s_call_b64 s[90:91], K1_FC
    s_mov_b32 s46, 163840
    s_add_u32 m0, s45, 98304
    s_nop 0
    buffer_load_dwordx4 v14, s[32:35], s46 offen offset:0 nt lds
    buffer_load_dwordx4 v9, s[32:35], s46 offen offset:1024 nt lds
    buffer_load_dwordx4 v14, s[32:35], s46 offen offset:2048 nt lds
    buffer_load_dwordx4 v9, s[32:35], s46 offen offset:3072 nt lds
    s_mov_b32 s46, 180224
    s_add_u32 m0, s45, 49152
    s_nop 0
    buffer_load_dwordx4 v10, s[28:31], s46 offen offset:0 nt lds
    buffer_load_dwordx4 v11, s[28:31], s46 offen offset:1024 nt lds
    buffer_load_dwordx4 v12, s[28:31], s46 offen offset:2048 nt lds
    buffer_load_dwordx4 v13, s[28:31], s46 offen offset:3072 nt lds
    s_waitcnt vmcnt(9)
    v_mov_b32 v250, 9
    ds_write_b32 v246, v250
    s_mov_b32 s46, 8
    s_call_b64 s[90:91], K1_FC
    s_mov_b32 s46, 180224
    s_add_u32 m0, s45, 114688
    s_nop 0
    buffer_load_dwordx4 v14, s[32:35], s46 offen offset:0 nt lds
    buffer_load_dwordx4 v9, s[32:35], s46 offen offset:1024 nt lds
    buffer_load_dwordx4 v14, s[32:35], s46 offen offset:2048 nt lds
    buffer_load_dwordx4 v9, s[32:35], s46 offen offset:3072 nt lds
    s_mov_b32 s46, 196608
    s_add_u32 m0, s45, 0
    s_nop 0
    buffer_load_dwordx4 v10, s[28:31], s46 offen offset:0 nt lds
    buffer_load_dwordx4 v11, s[28:31], s46 offen offset:1024 nt lds
    buffer_load_dwordx4 v12, s[28:31], s46 offen offset:2048 nt lds
    buffer_load_dwordx4 v13, s[28:31], s46 offen offset:3072 nt lds
    s_waitcnt vmcnt(8)
    v_mov_b32 v250, 10
    ds_write_b32 v246, v250
    s_xor_b32 s46, s7, 27
    s_mul_i32 s46, s46, 40960
    s_add_u32 s46, s46, s63
    s_mov_b32 m0, 138240
    s_nop 0
    buffer_load_dwordx4 v235, s[64:67], s46 offen lds
    s_xor_b32 s46, s7, 27
    s_mul_i32 s46, s46, 40960
    s_add_u32 s46, s46, s63
    s_mov_b32 m0, 142336
    s_nop 0
    buffer_load_dwordx4 v239, s[64:67], s46 offen lds
    s_xor_b32 s46, s7, 28
    s_mul_i32 s46, s46, 40960
    s_add_u32 s46, s46, s63
    s_mov_b32 m0, 146432
    s_nop 0
    buffer_load_dwordx4 v238, s[64:67], s46 offen lds
    s_mov_b32 s46, 9
    s_call_b64 s[90:91], K1_FC
    s_mov_b32 s46, 196608
    s_add_u32 m0, s45, 65536
    s_nop 0
    buffer_load_dwordx4 v14, s[32:35], s46 offen offset:0 nt lds
    buffer_load_dwordx4 v9, s[32:35], s46 offen offset:1024 nt lds
    buffer_load_dwordx4 v14, s[32:35], s46 offen offset:2048 nt lds
    buffer_load_dwordx4 v9, s[32:35], s46 offen offset:3072 nt lds
    s_mov_b32 s46, 212992
    s_add_u32 m0, s45, 16384
    s_nop 0
    buffer_load_dwordx4 v10, s[28:31], s46 offen offset:0 nt lds
    buffer_load_dwordx4 v11, s[28:31], s46 offen offset:1024 nt lds
    buffer_load_dwordx4 v12, s[28:31], s46 offen offset:2048 nt lds
    buffer_load_dwordx4 v13, s[28:31], s46 offen offset:3072 nt lds
    s_waitcnt vmcnt(11)
    v_mov_b32 v250, 11
    ds_write_b32 v246, v250
    s_mov_b32 s46, 229376
    buffer_load_dwordx4 v[24:27], v10, s[28:31], s46 offen offset:0 nt
    buffer_load_dwordx4 v[28:31], v11, s[28:31], s46 offen offset:1024 nt
    buffer_load_dwordx4 v[32:35], v12, s[28:31], s46 offen offset:2048 nt
    buffer_load_dwordx4 v[36:39], v13, s[28:31], s46 offen offset:3072 nt
    s_mov_b32 s46, 212992
    buffer_load_dwordx4 v[40:43], v14, s[32:35], s46 offen offset:0 nt
    buffer_load_dwordx4 v[44:47], v9, s[32:35], s46 offen offset:1024 nt
    buffer_load_dwordx4 v[48:51], v14, s[32:35], s46 offen offset:2048 nt
    buffer_load_dwordx4 v[52:55], v9, s[32:35], s46 offen offset:3072 nt
    s_waitcnt vmcnt(8)
    v_mov_b32 v250, 12
    ds_write_b32 v246, v250
    s_mov_b32 s46, 10
    s_call_b64 s[90:91], K1_FC
    s_mov_b32 s46, 245760
    buffer_load_dwordx4 v[56:59], v10, s[28:31], s46 offen offset:0 nt
    buffer_load_dwordx4 v[60:63], v11, s[28:31], s46 offen offset:1024 nt
    buffer_load_dwordx4 v[64:67], v12, s[28:31], s46 offen offset:2048 nt
    buffer_load_dwordx4 v[68:71], v13, s[28:31], s46 offen offset:3072 nt
    s_mov_b32 s46, 229376
    buffer_load_dwordx4 v[72:75], v14, s[32:35], s46 offen offset:0 nt
    buffer_load_dwordx4 v[76:79], v9, s[32:35], s46 offen offset:1024 nt
    buffer_load_dwordx4 v[80:83], v14, s[32:35], s46 offen offset:2048 nt
    buffer_load_dwordx4 v[84:87], v9, s[32:35], s46 offen offset:3072 nt
    s_mov_b32 s46, 245760
    buffer_load_dwordx4 v[88:91], v14, s[32:35], s46 offen offset:0 nt
    buffer_load_dwordx4 v[92:95], v9, s[32:35], s46 offen offset:1024 nt
    buffer_load_dwordx4 v[96:99], v14, s[32:35], s46 offen offset:2048 nt
    buffer_load_dwordx4 v[100:103], v9, s[32:35], s46 offen offset:3072 nt
    s_xor_b32 s46, s7, 31
    s_mul_i32 s46, s46, 40960
    s_add_u32 s46, s46, s63
    s_mov_b32 m0, 159744
    s_nop 0
    buffer_load_dwordx4 v236, s[64:67], s46 offen lds
    s_xor_b32 s46, s7, 31
    s_mul_i32 s46, s46, 40960
    s_add_u32 s46, s46, s63
    s_mov_b32 m0, 160768
    s_nop 0
    buffer_load_dwordx4 v237, s[64:67], s46 offen lds
    s_xor_b32 s46, s7, 31
    s_mul_i32 s46, s46, 40960
    s_add_u32 s46, s46, s63
    s_mov_b32 m0, 161792
    s_nop 0
    buffer_load_dwordx4 v238, s[64:67], s46 offen lds
    s_xor_b32 s46, s7, 31
    s_mul_i32 s46, s46, 40960
    s_add_u32 s46, s46, s63
    s_mov_b32 m0, 162816
    s_nop 0
    buffer_load_dwordx4 v239, s[64:67], s46 offen lds
    s_xor_b32 s46, s7, 26
    s_mul_i32 s46, s46, 40960
    s_add_u32 s46, s46, s63
    buffer_load_dwordx4 v[20:23], v236, s[64:67], s46 offen
    v_lshlrev_b32 v17, 4, v255
    v_add_u32 v17, 134144, v17
    s_lshl_b32 s46, s42, 4
    s_mov_b32 s62, 0
K1_POLL0:
    v_cmp_le_u32 vcc, 32, v4
    s_add_u32 s62, s62, 1
    s_cmp_gt_u32 s62, 400000
    s_cbranch_scc1 K1_POLL0_DONE
    s_cmp_eq_u64 vcc, -1
    s_cbranch_scc1 K1_POLL0_DONE
    buffer_load_dword v4, v5, s[68:71], s46 offen sc0 sc1
    s_waitcnt vmcnt(0)
    s_branch K1_POLL0
K1_POLL0_DONE:
    s_mov_b32 s46, 11
    s_call_b64 s[90:91], K1_FC
    s_mov_b32 s46, 12
    s_call_b64 s[90:91], K1_FC
    s_waitcnt vmcnt(21)
    ds_write_b128 v247, v[24:27] offset:32768
    ds_write_b128 v247, v[28:31] offset:33792
    ds_write_b128 v247, v[32:35] offset:34816
    ds_write_b128 v247, v[36:39] offset:35840
    s_waitcnt vmcnt(17)
    ds_write_b128 v248, v[40:43] offset:16384
    ds_write_b128 v248, v[44:47] offset:17408
    ds_write_b128 v248, v[48:51] offset:18432
    ds_write_b128 v248, v[52:55] offset:19456
    v_mov_b32 v250, 13
    ds_write_b32 v246, v250
    s_mov_b32 s46, 13
    s_call_b64 s[90:91], K1_FC
    s_waitcnt vmcnt(13)
    ds_write_b128 v247, v[56:59] offset:49152
    ds_write_b128 v247, v[60:63] offset:50176
    ds_write_b128 v247, v[64:67] offset:51200
    ds_write_b128 v247, v[68:71] offset:52224
    s_waitcnt vmcnt(9)
    ds_write_b128 v248, v[72:75] offset:32768
    ds_write_b128 v248, v[76:79] offset:33792
    ds_write_b128 v248, v[80:83] offset:34816
    ds_write_b128 v248, v[84:87] offset:35840
    v_mov_b32 v250, 14
    ds_write_b32 v246, v250
    s_xor_b32 s46, s7, 2
    s_mul_i32 s46, s46, 40960
    s_add_u32 s46, s46, s63
    s_mov_b32 m0, 12288
    s_nop 0
    buffer_load_dwordx4 v237, s[64:67], s46 offen lds
    s_xor_b32 s46, s7, 2
    s_mul_i32 s46, s46, 40960
    s_add_u32 s46, s46, s63
    s_mov_b32 m0, 13312
    s_nop 0
    buffer_load_dwordx4 v238, s[64:67], s46 offen lds
    s_xor_b32 s46, s7, 2
    s_mul_i32 s46, s46, 40960
    s_add_u32 s46, s46, s63
    s_mov_b32 m0, 14336
    s_nop 0
    buffer_load_dwordx4 v239, s[64:67], s46 offen lds
    s_xor_b32 s46, s7, 3
    s_mul_i32 s46, s46, 40960
    s_add_u32 s46, s46, s63
    s_mov_b32 m0, 15360
    s_nop 0
    buffer_load_dwordx4 v235, s[64:67], s46 offen lds
    s_xor_b32 s46, s7, 5
    s_mul_i32 s46, s46, 40960
    s_add_u32 s46, s46, s63
    s_mov_b32 m0, 28672
    s_nop 0
    buffer_load_dwordx4 v238, s[64:67], s46 offen lds
    s_xor_b32 s46, s7, 5
    s_mul_i32 s46, s46, 40960
    s_add_u32 s46, s46, s63
    s_mov_b32 m0, 29696
    s_nop 0
    buffer_load_dwordx4 v239, s[64:67], s46 offen lds
    s_xor_b32 s46, s7, 6
    s_mul_i32 s46, s46, 40960
    s_add_u32 s46, s46, s63
    s_mov_b32 m0, 30720
    s_nop 0
    buffer_load_dwordx4 v235, s[64:67], s46 offen lds
    s_xor_b32 s46, s7, 6
    s_mul_i32 s46, s46, 40960
    s_add_u32 s46, s46, s63
    s_mov_b32 m0, 31744
    s_nop 0
    buffer_load_dwordx4 v236, s[64:67], s46 offen lds
    s_xor_b32 s46, s7, 15
    s_mul_i32 s46, s46, 40960
    s_add_u32 s46, s46, s63
    s_mov_b32 m0, 77824
    s_nop 0
    buffer_load_dwordx4 v236, s[64:67], s46 offen lds
    s_xor_b32 s46, s7, 15
    s_mul_i32 s46, s46, 40960
    s_add_u32 s46, s46, s63
    s_mov_b32 m0, 78848
    s_nop 0
    buffer_load_dwordx4 v237, s[64:67], s46 offen lds
    s_xor_b32 s46, s7, 15
    s_mul_i32 s46, s46, 40960
    s_add_u32 s46, s46, s63
    s_mov_b32 m0, 79872
    s_nop 0
    buffer_load_dwordx4 v238, s[64:67], s46 offen lds
    s_xor_b32 s46, s7, 15
    s_mul_i32 s46, s46, 40960
    s_add_u32 s46, s46, s63
    s_mov_b32 m0, 80896
    s_nop 0
    buffer_load_dwordx4 v239, s[64:67], s46 offen lds
    s_mov_b32 s46, 14
    s_call_b64 s[90:91], K1_FC
    s_waitcnt vmcnt(17)
    ds_write_b128 v248, v[88:91] offset:49152
    ds_write_b128 v248, v[92:95] offset:50176
    ds_write_b128 v248, v[96:99] offset:51200
    ds_write_b128 v248, v[100:103] offset:52224
    v_mov_b32 v250, 15
    ds_write_b32 v246, v250
    s_xor_b32 s46, s7, 8
    s_mul_i32 s46, s46, 40960
    s_add_u32 s46, s46, s63
    s_mov_b32 m0, 45056
    s_nop 0
    buffer_load_dwordx4 v239, s[64:67], s46 offen lds
    s_xor_b32 s46, s7, 9
    s_mul_i32 s46, s46, 40960
    s_add_u32 s46, s46, s63
    s_mov_b32 m0, 46080
    s_nop 0
    buffer_load_dwordx4 v235, s[64:67], s46 offen lds
    s_xor_b32 s46, s7, 9
    s_mul_i32 s46, s46, 40960
    s_add_u32 s46, s46, s63
    s_mov_b32 m0, 47104
    s_nop 0
    buffer_load_dwordx4 v236, s[64:67], s46 offen lds
    s_xor_b32 s46, s7, 9
    s_mul_i32 s46, s46, 40960
    s_add_u32 s46, s46, s63
    s_mov_b32 m0, 48128
    s_nop 0
    buffer_load_dwordx4 v237, s[64:67], s46 offen lds
    s_xor_b32 s46, s7, 18
    s_mul_i32 s46, s46, 40960
    s_add_u32 s46, s46, s63
    s_mov_b32 m0, 94208
    s_nop 0
    buffer_load_dwordx4 v237, s[64:67], s46 offen lds
    s_xor_b32 s46, s7, 18
    s_mul_i32 s46, s46, 40960
    s_add_u32 s46, s46, s63
    s_mov_b32 m0, 95232
    s_nop 0
    buffer_load_dwordx4 v238, s[64:67], s46 offen lds
    s_xor_b32 s46, s7, 18
    s_mul_i32 s46, s46, 40960
    s_add_u32 s46, s46, s63
    s_mov_b32 m0, 96256
    s_nop 0
    buffer_load_dwordx4 v239, s[64:67], s46 offen lds
    s_xor_b32 s46, s7, 19
    s_mul_i32 s46, s46, 40960
    s_add_u32 s46, s46, s63
    s_mov_b32 m0, 97280
    s_nop 0
    buffer_load_dwordx4 v235, s[64:67], s46 offen lds
    s_xor_b32 s46, s7, 24
    s_mul_i32 s46, s46, 40960
    s_add_u32 s46, s46, s63
    buffer_load_dwordx4 v[104:107], v239, s[64:67], s46 offen
    s_xor_b32 s46, s7, 25
    s_mul_i32 s46, s46, 40960
    s_add_u32 s46, s46, s63
    buffer_load_dwordx4 v[108:111], v235, s[64:67], s46 offen
    s_xor_b32 s46, s7, 25
    s_mul_i32 s46, s46, 40960
    s_add_u32 s46, s46, s63
    buffer_load_dwordx4 v[112:115], v236, s[64:67], s46 offen
    s_xor_b32 s46, s7, 25
    s_mul_i32 s46, s46, 40960
    s_add_u32 s46, s46, s63
    buffer_load_dwordx4 v[116:119], v237, s[64:67], s46 offen
    s_waitcnt vmcnt(25)
    s_mov_b32 s46, 15
    s_call_b64 s[90:91], K1_FC
    s_xor_b32 s46, s7, 12
    s_mul_i32 s46, s46, 40960
    s_add_u32 s46, s46, s63
    s_mov_b32 m0, 61440
    s_nop 0
    buffer_load_dwordx4 v235, s[64:67], s46 offen lds
    s_xor_b32 s46, s7, 12
    s_mul_i32 s46, s46, 40960
    s_add_u32 s46, s46, s63
    s_mov_b32 m0, 62464
    s_nop 0
    buffer_load_dwordx4 v236, s[64:67], s46 offen lds
    s_xor_b32 s46, s7, 12
    s_mul_i32 s46, s46, 40960
    s_add_u32 s46, s46, s63
    s_mov_b32 m0, 63488
    s_nop 0
    buffer_load_dwordx4 v237, s[64:67], s46 offen lds
    s_xor_b32 s46, s7, 12
    s_mul_i32 s46, s46, 40960
    s_add_u32 s46, s46, s63
    s_mov_b32 m0, 64512
    s_nop 0
    buffer_load_dwordx4 v238, s[64:67], s46 offen lds
    s_xor_b32 s46, s7, 21
    s_mul_i32 s46, s46, 40960
    s_add_u32 s46, s46, s63
    s_mov_b32 m0, 110592
    s_nop 0
    buffer_load_dwordx4 v238, s[64:67], s46 offen lds
    s_xor_b32 s46, s7, 21
    s_mul_i32 s46, s46, 40960
    s_add_u32 s46, s46, s63
    s_mov_b32 m0, 111616
    s_nop 0
    buffer_load_dwordx4 v239, s[64:67], s46 offen lds
    s_xor_b32 s46, s7, 22
    s_mul_i32 s46, s46, 40960
    s_add_u32 s46, s46, s63
    s_mov_b32 m0, 112640
    s_nop 0
    buffer_load_dwordx4 v235, s[64:67], s46 offen lds
    s_xor_b32 s46, s7, 22
    s_mul_i32 s46, s46, 40960
    s_add_u32 s46, s46, s63
    s_mov_b32 m0, 113664
    s_nop 0
    buffer_load_dwordx4 v236, s[64:67], s46 offen lds
    v_lshlrev_b32 v229, 4, v255
    s_lshl_b32 s46, s77, 17
    v_add_u32 v230, s46, v229
    v_xor_b32 v229, 0x20000, v230
    s_lshl_b32 s47, s42, 20
    s_lshl_b32 s46, s76, 18
    s_add_u32 s47, s47, s46
    s_lshl_b32 s46, s56, 15
    s_add_u32 s47, s47, s46
    s_lshl_b32 s46, s10, 14
    s_add_u32 s47, s47, s46
    s_mov_b32 s83, 0
    s_mov_b32 s85, 0
    s_mov_b32 s86, -1
    s_mov_b32 s8, 1
    v_lshrrev_b32 v231, 2, v255
    v_mul_u32_u24 v231, 160, v231
    v_and_b32 v232, 3, v255
    v_lshl_add_u32 v231, v232, 3, v231
    v_lshlrev_b32 v234, 13, v255
    v_and_b32 v228, 31, v255
    v_lshlrev_b32 v228, 7, v228
    v_lshrrev_b32 v227, 5, v255
    v_lshl_add_u32 v228, v227, 17, v228
    s_mov_b32 s4, 0
    s_mul_i32 s46, s10, 81920
    v_add_u32 v231, s46, v231
    s_mov_b32 s80, 0
    s_mov_b32 s81, 0
    s_mov_b32 s82, 0
    s_mov_b32 s84, 0
    s_mov_b32 s11, 0
    s_mov_b32 s49, 0
    s_mov_b32 s6, 0
    s_buffer_load_dword s12, s[36:39], s78 glc
    s_waitcnt vmcnt(32)
    s_waitcnt vmcnt(8)
    s_mov_b32 s46, 16
    s_call_b64 s[90:91], K1_FC
    ds_write_b128 v17, v[20:23]
    ds_write_b128 v248, v[104:107] offset:49152
    ds_write_b128 v248, v[108:111] offset:50176
    ds_write_b128 v248, v[112:115] offset:51200
    ds_write_b128 v248, v[116:119] offset:52224
    s_mov_b32 s5, 2
    s_waitcnt lgkmcnt(0)
    s_call_b64 s[90:91], K1_SVC
    s_mov_b32 s46, s85
    s_call_b64 s[90:91], K1_WV
    s_barrier
    s_setprio 1
    s_branch K1_B0
K1_LL0:
    v_and_b32 v246, 3, v255
    v_lshlrev_b32 v246, 3, v246
    v_add_u32 v246, 131072, v246
    v_mov_b32 v250, 2
    v_mov_b32 v251, 0
    ds_write_b64 v246, v[250:251]
    s_waitcnt lgkmcnt(0)
    s_barrier
    s_waitcnt vmcnt(16)
    ds_write_b128 v247, v[88:91] offset:0
    ds_write_b128 v247, v[92:95] offset:1024
    ds_write_b128 v247, v[96:99] offset:2048
    ds_write_b128 v247, v[100:103] offset:3072
    v_mov_b32 v250, 3
    ds_write_b32 v246, v250
    s_mov_b32 s46, 98304
    buffer_load_dwordx4 v[168:171], v14, s[32:35], s46 offen offset:0 nt
    buffer_load_dwordx4 v[172:175], v9, s[32:35], s46 offen offset:1024 nt
    buffer_load_dwordx4 v[176:179], v14, s[32:35], s46 offen offset:2048 nt
    buffer_load_dwordx4 v[180:183], v9, s[32:35], s46 offen offset:3072 nt
    s_mov_b32 s46, 1
    s_call_b64 s[90:91], K1_FC
    s_waitcnt vmcnt(16)
    ds_write_b128 v248, v[104:107] offset:0
    ds_write_b128 v248, v[108:111] offset:1024
    ds_write_b128 v248, v[112:115] offset:2048
    ds_write_b128 v248, v[116:119] offset:3072
    s_waitcnt vmcnt(12)
    ds_write_b128 v247, v[120:123] offset:16384
    ds_write_b128 v247, v[124:127] offset:17408
    ds_write_b128 v247, v[128:131] offset:18432
    ds_write_b128 v247, v[132:135] offset:19456
    v_mov_b32 v250, 4
    ds_write_b32 v246, v250
    s_mov_b32 s46, 114688
    buffer_load_dwordx4 v[184:187], v10, s[28:31], s46 offen offset:0 nt
    buffer_load_dwordx4 v[188:191], v11, s[28:31], s46 offen offset:1024 nt
    buffer_load_dwordx4 v[192:195], v12, s[28:31], s46 offen offset:2048 nt
    buffer_load_dwordx4 v[196:199], v13, s[28:31], s46 offen offset:3072 nt
    s_and_b32 s46, s42, 3
    s_lshl_b32 s46, s46, 3
    s_add_u32 s46, s46, s57
    s_lshl_b32 s62, s56, 5
    s_add_u32 s46, s46, s62
    s_mul_i32 s46, s46, 40960
    s_add_u32 s46, s46, 0
    v_lshlrev_b32 v19, 7, v255
    buffer_load_dword v18, v19, s[64:67], s46 offen
    s_mov_b32 s46, 2
    s_call_b64 s[90:91], K1_FC
    s_waitcnt vmcnt(13)
    ds_write_b128 v248, v[136:139] offset:16384
    ds_write_b128 v248, v[140:143] offset:17408
    ds_write_b128 v248, v[144:147] offset:18432
    ds_write_b128 v248, v[148:151] offset:19456
    s_mov_b32 s46, 114688
    buffer_load_dwordx4 v[200:203], v14, s[32:35], s46 offen offset:0 nt
    buffer_load_dwordx4 v[204:207], v9, s[32:35], s46 offen offset:1024 nt
    buffer_load_dwordx4 v[208:211], v14, s[32:35], s46 offen offset:2048 nt
    buffer_load_dwordx4 v[212:215], v9, s[32:35], s46 offen offset:3072 nt
    s_mov_b32 s46, 3
    s_call_b64 s[90:91], K1_FC
    s_waitcnt vmcnt(13)
    ds_write_b128 v247, v[152:155] offset:32768
    ds_write_b128 v247, v[156:159] offset:33792
    ds_write_b128 v247, v[160:163] offset:34816
    ds_write_b128 v247, v[164:167] offset:35840
    v_mov_b32 v250, 5
    ds_write_b32 v246, v250
    s_mov_b32 s46, 131072
    buffer_load_dwordx4 v[24:27], v10, s[28:31], s46 offen offset:0 nt
    buffer_load_dwordx4 v[28:31], v11, s[28:31], s46 offen offset:1024 nt
    buffer_load_dwordx4 v[32:35], v12, s[28:31], s46 offen offset:2048 nt
    buffer_load_dwordx4 v[36:39], v13, s[28:31], s46 offen offset:3072 nt
    s_mov_b32 s46, 4
    s_call_b64 s[90:91], K1_FC
    s_waitcnt vmcnt(13)
    ds_write_b128 v248, v[168:171] offset:32768
    ds_write_b128 v248, v[172:175] offset:33792
    ds_write_b128 v248, v[176:179] offset:34816
    ds_write_b128 v248, v[180:183] offset:35840
    s_mov_b32 s46, 131072
    buffer_load_dwordx4 v[40:43], v14, s[32:35], s46 offen offset:0 nt
    buffer_load_dwordx4 v[44:47], v9, s[32:35], s46 offen offset:1024 nt
    buffer_load_dwordx4 v[48:51], v14, s[32:35], s46 offen offset:2048 nt
    buffer_load_dwordx4 v[52:55], v9, s[32:35], s46 offen offset:3072 nt
    s_mov_b32 s46, 147456
    buffer_load_dwordx4 v[56:59], v10, s[28:31], s46 offen offset:0 nt
    buffer_load_dwordx4 v[60:63], v11, s[28:31], s46 offen offset:1024 nt
    buffer_load_dwordx4 v[64:67], v12, s[28:31], s46 offen offset:2048 nt
    buffer_load_dwordx4 v[68:71], v13, s[28:31], s46 offen offset:3072 nt
    s_mov_b32 s46, 5
    s_call_b64 s[90:91], K1_FC
    s_waitcnt vmcnt(17)
    ds_write_b128 v247, v[184:187] offset:49152
    ds_write_b128 v247, v[188:191] offset:50176
    ds_write_b128 v247, v[192:195] offset:51200
    ds_write_b128 v247, v[196:199] offset:52224
    v_mov_b32 v250, 6
    ds_write_b32 v246, v250
    s_mov_b32 s46, 147456
    buffer_load_dwordx4 v[72:75], v14, s[32:35], s46 offen offset:0 nt
    buffer_load_dwordx4 v[76:79], v9, s[32:35], s46 offen offset:1024 nt
    buffer_load_dwordx4 v[80:83], v14, s[32:35], s46 offen offset:2048 nt
    buffer_load_dwordx4 v[84:87], v9, s[32:35], s46 offen offset:3072 nt
    s_and_b32 s46, s42, 3
    s_lshl_b32 s46, s46, 3
    s_add_u32 s46, s46, s57
    s_lshl_b32 s62, s56, 5
    s_add_u32 s46, s46, s62
    s_mul_i32 s46, s46, 40960
    s_add_u32 s46, s46, 32768
    v_lshlrev_b32 v19, 7, v255
    buffer_load_dword v18, v19, s[64:67], s46 offen
    s_mov_b32 s46, 6
    s_call_b64 s[90:91], K1_FC
    s_waitcnt vmcnt(17)
    ds_write_b128 v248, v[200:203] offset:49152
    ds_write_b128 v248, v[204:207] offset:50176
    ds_write_b128 v248, v[208:211] offset:51200
    ds_write_b128 v248, v[212:215] offset:52224
    s_waitcnt vmcnt(13)
    ds_write_b128 v247, v[24:27] offset:0
    ds_write_b128 v247, v[28:31] offset:1024
    ds_write_b128 v247, v[32:35] offset:2048
    ds_write_b128 v247, v[36:39] offset:3072
    v_mov_b32 v250, 7
    ds_write_b32 v246, v250
    s_mov_b32 s46, 163840
    s_add_u32 m0, s45, 32768
    s_nop 0
    buffer_load_dwordx4 v10, s[28:31], s46 offen offset:0 nt lds
    buffer_load_dwordx4 v11, s[28:31], s46 offen offset:1024 nt lds
    buffer_load_dwordx4 v12, s[28:31], s46 offen offset:2048 nt lds
    buffer_load_dwordx4 v13, s[28:31], s46 offen offset:3072 nt lds
    s_mov_b32 s46, 7
    s_call_b64 s[90:91], K1_FC
    s_waitcnt vmcnt(13)
    ds_write_b128 v248, v[40:43] offset:0
    ds_write_b128 v248, v[44:47] offset:1024
    ds_write_b128 v248, v[48:51] offset:2048
    ds_write_b128 v248, v[52:55] offset:3072
    s_waitcnt vmcnt(9)
    ds_write_b128 v247, v[56:59] offset:16384
    ds_write_b128 v247, v[60:63] offset:17408
    ds_write_b128 v247, v[64:67] offset:18432
    ds_write_b128 v247, v[68:71] offset:19456
    v_mov_b32 v250, 8
    ds_write_b32 v246, v250
    s_mov_b32 s46, 163840
    s_add_u32 m0, s45, 98304
    s_nop 0
    buffer_load_dwordx4 v14, s[32:35], s46 offen offset:0 nt lds
    buffer_load_dwordx4 v9, s[32:35], s46 offen offset:1024 nt lds
    buffer_load_dwordx4 v14, s[32:35], s46 offen offset:2048 nt lds
    buffer_load_dwordx4 v9, s[32:35], s46 offen offset:3072 nt lds
    s_mov_b32 s46, 180224
    s_add_u32 m0, s45, 49152
    s_nop 0
    buffer_load_dwordx4 v10, s[28:31], s46 offen offset:0 nt lds
    buffer_load_dwordx4 v11, s[28:31], s46 offen offset:1024 nt lds
    buffer_load_dwordx4 v12, s[28:31], s46 offen offset:2048 nt lds
    buffer_load_dwordx4 v13, s[28:31], s46 offen offset:3072 nt lds
    s_mov_b32 s46, 8
    s_call_b64 s[90:91], K1_FC
    s_waitcnt vmcnt(13)
    ds_write_b128 v248, v[72:75] offset:16384
    ds_write_b128 v248, v[76:79] offset:17408
    ds_write_b128 v248, v[80:83] offset:18432
    ds_write_b128 v248, v[84:87] offset:19456
    s_mov_b32 s46, 180224
    s_add_u32 m0, s45, 114688
    s_nop 0
    buffer_load_dwordx4 v14, s[32:35], s46 offen offset:0 nt lds
    buffer_load_dwordx4 v9, s[32:35], s46 offen offset:1024 nt lds
    buffer_load_dwordx4 v14, s[32:35], s46 offen offset:2048 nt lds
    buffer_load_dwordx4 v9, s[32:35], s46 offen offset:3072 nt lds
    s_waitcnt vmcnt(12)
    v_mov_b32 v250, 9
    ds_write_b32 v246, v250
    s_mov_b32 s46, 196608
    s_add_u32 m0, s45, 0
    s_nop 0
    buffer_load_dwordx4 v10, s[28:31], s46 offen offset:0 nt lds
    buffer_load_dwordx4 v11, s[28:31], s46 offen offset:1024 nt lds
    buffer_load_dwordx4 v12, s[28:31], s46 offen offset:2048 nt lds
    buffer_load_dwordx4 v13, s[28:31], s46 offen offset:3072 nt lds
    s_waitcnt vmcnt(8)
    v_mov_b32 v250, 10
    ds_write_b32 v246, v250
    s_xor_b32 s46, s7, 26
    s_mul_i32 s46, s46, 40960
    s_add_u32 s46, s46, s63
    s_mov_b32 m0, 135168
    s_nop 0
    buffer_load_dwordx4 v237, s[64:67], s46 offen lds
    s_xor_b32 s46, s7, 27
    s_mul_i32 s46, s46, 40960
    s_add_u32 s46, s46, s63
    s_mov_b32 m0, 139264
    s_nop 0
    buffer_load_dwordx4 v236, s[64:67], s46 offen lds
    s_xor_b32 s46, s7, 28
    s_mul_i32 s46, s46, 40960
    s_add_u32 s46, s46, s63
    s_mov_b32 m0, 143360
    s_nop 0
    buffer_load_dwordx4 v235, s[64:67], s46 offen lds
    s_mov_b32 s46, 9
    s_call_b64 s[90:91], K1_FC
    s_mov_b32 s46, 196608
    s_add_u32 m0, s45, 65536
    s_nop 0
    buffer_load_dwordx4 v14, s[32:35], s46 offen offset:0 nt lds
    buffer_load_dwordx4 v9, s[32:35], s46 offen offset:1024 nt lds
    buffer_load_dwordx4 v14, s[32:35], s46 offen offset:2048 nt lds
    buffer_load_dwordx4 v9, s[32:35], s46 offen offset:3072 nt lds
    s_mov_b32 s46, 212992
    s_add_u32 m0, s45, 16384
    s_nop 0
    buffer_load_dwordx4 v10, s[28:31], s46 offen offset:0 nt lds
    buffer_load_dwordx4 v11, s[28:31], s46 offen offset:1024 nt lds
    buffer_load_dwordx4 v12, s[28:31], s46 offen offset:2048 nt lds
    buffer_load_dwordx4 v13, s[28:31], s46 offen offset:3072 nt lds
    s_waitcnt vmcnt(11)
    v_mov_b32 v250, 11
    ds_write_b32 v246, v250
    s_mov_b32 s46, 10
    s_call_b64 s[90:91], K1_FC
    s_mov_b32 s46, 212992
    s_add_u32 m0, s45, 81920
    s_nop 0
    buffer_load_dwordx4 v14, s[32:35], s46 offen offset:0 nt lds
    buffer_load_dwordx4 v9, s[32:35], s46 offen offset:1024 nt lds
    buffer_load_dwordx4 v14, s[32:35], s46 offen offset:2048 nt lds
    buffer_load_dwordx4 v9, s[32:35], s46 offen offset:3072 nt lds
    s_mov_b32 s46, 229376
    s_add_u32 m0, s45, 32768
    s_nop 0
    buffer_load_dwordx4 v10, s[28:31], s46 offen offset:0 nt lds
    buffer_load_dwordx4 v11, s[28:31], s46 offen offset:1024 nt lds
    buffer_load_dwordx4 v12, s[28:31], s46 offen offset:2048 nt lds
    buffer_load_dwordx4 v13, s[28:31], s46 offen offset:3072 nt lds
    s_waitcnt vmcnt(8)
    v_mov_b32 v250, 12
    ds_write_b32 v246, v250
    s_xor_b32 s46, s7, 28
    s_mul_i32 s46, s46, 40960
    s_add_u32 s46, s46, s63
    s_mov_b32 m0, 147456
    s_nop 0
    buffer_load_dwordx4 v239, s[64:67], s46 offen lds
    s_xor_b32 s46, s7, 29
    s_mul_i32 s46, s46, 40960
    s_add_u32 s46, s46, s63
    s_mov_b32 m0, 148480
    s_nop 0
    buffer_load_dwordx4 v235, s[64:67], s46 offen lds
    s_xor_b32 s46, s7, 29
    s_mul_i32 s46, s46, 40960
    s_add_u32 s46, s46, s63
    s_mov_b32 m0, 149504
    s_nop 0
    buffer_load_dwordx4 v236, s[64:67], s46 offen lds
    s_xor_b32 s46, s7, 29
    s_mul_i32 s46, s46, 40960
    s_add_u32 s46, s46, s63
    s_mov_b32 m0, 150528
    s_nop 0
    buffer_load_dwordx4 v237, s[64:67], s46 offen lds
    s_xor_b32 s46, s7, 25
    s_mul_i32 s46, s46, 40960
    s_add_u32 s46, s46, s63
    buffer_load_dwordx4 v[20:23], v238, s[64:67], s46 offen
    v_lshlrev_b32 v17, 4, v255
    v_add_u32 v17, 131072, v17
    s_mov_b32 s46, 11
    s_call_b64 s[90:91], K1_FC
    s_mov_b32 s46, 229376
    s_add_u32 m0, s45, 98304
    s_nop 0
    buffer_load_dwordx4 v14, s[32:35], s46 offen offset:0 nt lds
    buffer_load_dwordx4 v9, s[32:35], s46 offen offset:1024 nt lds
    buffer_load_dwordx4 v14, s[32:35], s46 offen offset:2048 nt lds
    buffer_load_dwordx4 v9, s[32:35], s46 offen offset:3072 nt lds
    s_waitcnt vmcnt(9)
    v_mov_b32 v250, 13
    ds_write_b32 v246, v250
    s_mov_b32 s46, 245760
    s_add_u32 m0, s45, 49152
    s_nop 0
    buffer_load_dwordx4 v10, s[28:31], s46 offen offset:0 nt lds
    buffer_load_dwordx4 v11, s[28:31], s46 offen offset:1024 nt lds
    buffer_load_dwordx4 v12, s[28:31], s46 offen offset:2048 nt lds
    buffer_load_dwordx4 v13, s[28:31], s46 offen offset:3072 nt lds
    s_mov_b32 s46, 12
    s_call_b64 s[90:91], K1_FC
    s_mov_b32 s46, 245760
    s_add_u32 m0, s45, 114688
    s_nop 0
    buffer_load_dwordx4 v14, s[32:35], s46 offen offset:0 nt lds
    buffer_load_dwordx4 v9, s[32:35], s46 offen offset:1024 nt lds
    buffer_load_dwordx4 v14, s[32:35], s46 offen offset:2048 nt lds
    buffer_load_dwordx4 v9, s[32:35], s46 offen offset:3072 nt lds
    s_waitcnt vmcnt(4)
    v_mov_b32 v250, 14
    ds_write_b32 v246, v250
    s_mov_b32 s46, 13
    s_call_b64 s[90:91], K1_FC
    s_xor_b32 s46, s7, 0
    s_mul_i32 s46, s46, 40960
    s_add_u32 s46, s46, s63
    s_mov_b32 m0, 0
    s_nop 0
    buffer_load_dwordx4 v235, s[64:67], s46 offen lds
    s_xor_b32 s46, s7, 0
    s_mul_i32 s46, s46, 40960
    s_add_u32 s46, s46, s63
    s_mov_b32 m0, 1024
    s_nop 0
    buffer_load_dwordx4 v236, s[64:67], s46 offen lds
    s_xor_b32 s46, s7, 0
    s_mul_i32 s46, s46, 40960
    s_add_u32 s46, s46, s63
    s_mov_b32 m0, 2048
    s_nop 0
    buffer_load_dwordx4 v237, s[64:67], s46 offen lds
    s_xor_b32 s46, s7, 0
    s_mul_i32 s46, s46, 40960
    s_add_u32 s46, s46, s63
    s_mov_b32 m0, 3072
    s_nop 0
    buffer_load_dwordx4 v238, s[64:67], s46 offen lds
    s_xor_b32 s46, s7, 3
    s_mul_i32 s46, s46, 40960
    s_add_u32 s46, s46, s63
    s_mov_b32 m0, 16384
    s_nop 0
    buffer_load_dwordx4 v236, s[64:67], s46 offen lds
    s_xor_b32 s46, s7, 3
    s_mul_i32 s46, s46, 40960
    s_add_u32 s46, s46, s63
    s_mov_b32 m0, 17408
    s_nop 0
    buffer_load_dwordx4 v237, s[64:67], s46 offen lds
    s_xor_b32 s46, s7, 3
    s_mul_i32 s46, s46, 40960
    s_add_u32 s46, s46, s63
    s_mov_b32 m0, 18432
    s_nop 0
    buffer_load_dwordx4 v238, s[64:67], s46 offen lds
    s_xor_b32 s46, s7, 3
    s_mul_i32 s46, s46, 40960
    s_add_u32 s46, s46, s63
    s_mov_b32 m0, 19456
    s_nop 0
    buffer_load_dwordx4 v239, s[64:67], s46 offen lds
    s_waitcnt vmcnt(8)
    v_mov_b32 v250, 15
    ds_write_b32 v246, v250
    s_xor_b32 s46, s7, 12
    s_mul_i32 s46, s46, 40960
    s_add_u32 s46, s46, s63
    s_mov_b32 m0, 65536
    s_nop 0
    buffer_load_dwordx4 v239, s[64:67], s46 offen lds
    s_xor_b32 s46, s7, 13
    s_mul_i32 s46, s46, 40960
    s_add_u32 s46, s46, s63
    s_mov_b32 m0, 66560
    s_nop 0
    buffer_load_dwordx4 v235, s[64:67], s46 offen lds
    s_xor_b32 s46, s7, 13
    s_mul_i32 s46, s46, 40960
    s_add_u32 s46, s46, s63
    s_mov_b32 m0, 67584
    s_nop 0
    buffer_load_dwordx4 v236, s[64:67], s46 offen lds
    s_xor_b32 s46, s7, 13
    s_mul_i32 s46, s46, 40960
    s_add_u32 s46, s46, s63
    s_mov_b32 m0, 68608
    s_nop 0
    buffer_load_dwordx4 v237, s[64:67], s46 offen lds
    s_mov_b32 s46, 14
    s_call_b64 s[90:91], K1_FC
    s_xor_b32 s46, s7, 6
    s_mul_i32 s46, s46, 40960
    s_add_u32 s46, s46, s63
    s_mov_b32 m0, 32768
    s_nop 0
    buffer_load_dwordx4 v237, s[64:67], s46 offen lds
    s_xor_b32 s46, s7, 6
    s_mul_i32 s46, s46, 40960
    s_add_u32 s46, s46, s63
    s_mov_b32 m0, 33792
    s_nop 0
    buffer_load_dwordx4 v238, s[64:67], s46 offen lds
    s_xor_b32 s46, s7, 6
    s_mul_i32 s46, s46, 40960
    s_add_u32 s46, s46, s63
    s_mov_b32 m0, 34816
    s_nop 0
    buffer_load_dwordx4 v239, s[64:67], s46 offen lds
    s_xor_b32 s46, s7, 7
    s_mul_i32 s46, s46, 40960
    s_add_u32 s46, s46, s63
    s_mov_b32 m0, 35840
    s_nop 0
    buffer_load_dwordx4 v235, s[64:67], s46 offen lds
    s_xor_b32 s46, s7, 16
    s_mul_i32 s46, s46, 40960
    s_add_u32 s46, s46, s63
    s_mov_b32 m0, 81920
    s_nop 0
    buffer_load_dwordx4 v235, s[64:67], s46 offen lds
    s_xor_b32 s46, s7, 16
    s_mul_i32 s46, s46, 40960
    s_add_u32 s46, s46, s63
    s_mov_b32 m0, 82944
    s_nop 0
    buffer_load_dwordx4 v236, s[64:67], s46 offen lds
    s_xor_b32 s46, s7, 16
    s_mul_i32 s46, s46, 40960
    s_add_u32 s46, s46, s63
    s_mov_b32 m0, 83968
    s_nop 0
    buffer_load_dwordx4 v237, s[64:67], s46 offen lds
    s_xor_b32 s46, s7, 16
    s_mul_i32 s46, s46, 40960
    s_add_u32 s46, s46, s63
    s_mov_b32 m0, 84992
    s_nop 0
    buffer_load_dwordx4 v238, s[64:67], s46 offen lds
    s_xor_b32 s46, s7, 22
    s_mul_i32 s46, s46, 40960
    s_add_u32 s46, s46, s63
    buffer_load_dwordx4 v[88:91], v237, s[64:67], s46 offen
    s_xor_b32 s46, s7, 22
    s_mul_i32 s46, s46, 40960
    s_add_u32 s46, s46, s63
    buffer_load_dwordx4 v[92:95], v238, s[64:67], s46 offen
    s_xor_b32 s46, s7, 22
    s_mul_i32 s46, s46, 40960
    s_add_u32 s46, s46, s63
    buffer_load_dwordx4 v[96:99], v239, s[64:67], s46 offen
    s_xor_b32 s46, s7, 23
    s_mul_i32 s46, s46, 40960
    s_add_u32 s46, s46, s63
    buffer_load_dwordx4 v[100:103], v235, s[64:67], s46 offen
    s_mov_b32 s46, 15
    s_call_b64 s[90:91], K1_FC
    s_xor_b32 s46, s7, 9
    s_mul_i32 s46, s46, 40960
    s_add_u32 s46, s46, s63
    s_mov_b32 m0, 49152
    s_nop 0
    buffer_load_dwordx4 v238, s[64:67], s46 offen lds
    s_xor_b32 s46, s7, 9
    s_mul_i32 s46, s46, 40960
    s_add_u32 s46, s46, s63
    s_mov_b32 m0, 50176
    s_nop 0
    buffer_load_dwordx4 v239, s[64:67], s46 offen lds
    s_xor_b32 s46, s7, 10
    s_mul_i32 s46, s46, 40960
    s_add_u32 s46, s46, s63
    s_mov_b32 m0, 51200
    s_nop 0
    buffer_load_dwordx4 v235, s[64:67], s46 offen lds
    s_xor_b32 s46, s7, 10
    s_mul_i32 s46, s46, 40960
    s_add_u32 s46, s46, s63
    s_mov_b32 m0, 52224
    s_nop 0
    buffer_load_dwordx4 v236, s[64:67], s46 offen lds
    s_xor_b32 s46, s7, 19
    s_mul_i32 s46, s46, 40960
    s_add_u32 s46, s46, s63
    s_mov_b32 m0, 98304
    s_nop 0
    buffer_load_dwordx4 v236, s[64:67], s46 offen lds
    s_xor_b32 s46, s7, 19
    s_mul_i32 s46, s46, 40960
    s_add_u32 s46, s46, s63
    s_mov_b32 m0, 99328
    s_nop 0
    buffer_load_dwordx4 v237, s[64:67], s46 offen lds
    s_xor_b32 s46, s7, 19
    s_mul_i32 s46, s46, 40960
    s_add_u32 s46, s46, s63
    s_mov_b32 m0, 100352
    s_nop 0
    buffer_load_dwordx4 v238, s[64:67], s46 offen lds
    s_xor_b32 s46, s7, 19
    s_mul_i32 s46, s46, 40960
    s_add_u32 s46, s46, s63
    s_mov_b32 m0, 101376
    s_nop 0
    buffer_load_dwordx4 v239, s[64:67], s46 offen lds
    v_lshlrev_b32 v229, 4, v255
    s_lshl_b32 s46, s77, 17
    v_add_u32 v230, s46, v229
    v_xor_b32 v229, 0x20000, v230
    s_lshl_b32 s47, s42, 20
    s_lshl_b32 s46, s76, 18
    s_add_u32 s47, s47, s46
    s_lshl_b32 s46, s56, 15
    s_add_u32 s47, s47, s46
    s_lshl_b32 s46, s10, 14
    s_add_u32 s47, s47, s46
    s_mov_b32 s83, 0
    s_mov_b32 s85, 0
    s_mov_b32 s86, -1
    s_mov_b32 s8, 1
    v_lshrrev_b32 v231, 2, v255
    v_mul_u32_u24 v231, 160, v231
    v_and_b32 v232, 3, v255
    v_lshl_add_u32 v231, v232, 3, v231
    v_lshlrev_b32 v234, 13, v255
    v_and_b32 v228, 31, v255
    v_lshlrev_b32 v228, 7, v228
    v_lshrrev_b32 v227, 5, v255
    v_lshl_add_u32 v228, v227, 17, v228
    s_mov_b32 s4, 0
    s_mul_i32 s46, s10, 81920
    v_add_u32 v231, s46, v231
    s_mov_b32 s80, 0
    s_mov_b32 s81, 0
    s_mov_b32 s82, 0
    s_mov_b32 s84, 0
    s_mov_b32 s11, 0
    s_mov_b32 s49, 0
    s_mov_b32 s6, 0
    s_buffer_load_dword s12, s[36:39], s78 glc
    s_waitcnt vmcnt(8)
    s_mov_b32 s46, 16
    s_call_b64 s[90:91], K1_FC
    ds_write_b128 v17, v[20:23]
    ds_write_b128 v248, v[88:91] offset:49152
    ds_write_b128 v248, v[92:95] offset:50176
    ds_write_b128 v248, v[96:99] offset:51200
    ds_write_b128 v248, v[100:103] offset:52224
    s_mov_b32 s5, 2
    s_waitcnt lgkmcnt(0)
    s_call_b64 s[90:91], K1_SVC
    s_mov_b32 s46, s85
    s_call_b64 s[90:91], K1_WV
    s_barrier
    s_setprio 1
    s_branch K1_B0
K1_LL1:
    v_and_b32 v246, 3, v255
    v_lshlrev_b32 v246, 3, v246
    v_add_u32 v246, 132128, v246
    v_mov_b32 v250, 2
    v_mov_b32 v251, 0
    ds_write_b64 v246, v[250:251]
    s_waitcnt lgkmcnt(0)
    s_barrier
    s_waitcnt vmcnt(16)
    ds_write_b128 v247, v[88:91] offset:0
    ds_write_b128 v247, v[92:95] offset:1024
    ds_write_b128 v247, v[96:99] offset:2048
    ds_write_b128 v247, v[100:103] offset:3072
    v_mov_b32 v250, 3
    ds_write_b32 v246, v250
    s_mov_b32 s46, 98304
    buffer_load_dwordx4 v[168:171], v14, s[32:35], s46 offen offset:0 nt
    buffer_load_dwordx4 v[172:175], v9, s[32:35], s46 offen offset:1024 nt
    buffer_load_dwordx4 v[176:179], v14, s[32:35], s46 offen offset:2048 nt
    buffer_load_dwordx4 v[180:183], v9, s[32:35], s46 offen offset:3072 nt
    s_mov_b32 s46, 1
    s_call_b64 s[90:91], K1_FC
    s_waitcnt vmcnt(16)
    ds_write_b128 v248, v[104:107] offset:0
    ds_write_b128 v248, v[108:111] offset:1024
    ds_write_b128 v248, v[112:115] offset:2048
    ds_write_b128 v248, v[116:119] offset:3072
    s_waitcnt vmcnt(12)
    ds_write_b128 v247, v[120:123] offset:16384
    ds_write_b128 v247, v[124:127] offset:17408
    ds_write_b128 v247, v[128:131] offset:18432
    ds_write_b128 v247, v[132:135] offset:19456
    v_mov_b32 v250, 4
    ds_write_b32 v246, v250
    s_mov_b32 s46, 114688
    buffer_load_dwordx4 v[184:187], v10, s[28:31], s46 offen offset:0 nt
    buffer_load_dwordx4 v[188:191], v11, s[28:31], s46 offen offset:1024 nt
    buffer_load_dwordx4 v[192:195], v12, s[28:31], s46 offen offset:2048 nt
    buffer_load_dwordx4 v[196:199], v13, s[28:31], s46 offen offset:3072 nt
    s_mov_b32 s46, 2
    s_call_b64 s[90:91], K1_FC
    s_waitcnt vmcnt(12)
    ds_write_b128 v248, v[136:139] offset:16384
    ds_write_b128 v248, v[140:143] offset:17408
    ds_write_b128 v248, v[144:147] offset:18432
    ds_write_b128 v248, v[148:151] offset:19456
    s_mov_b32 s46, 114688
    buffer_load_dwordx4 v[200:203], v14, s[32:35], s46 offen offset:0 nt
    buffer_load_dwordx4 v[204:207], v9, s[32:35], s46 offen offset:1024 nt
    buffer_load_dwordx4 v[208:211], v14, s[32:35], s46 offen offset:2048 nt
    buffer_load_dwordx4 v[212:215], v9, s[32:35], s46 offen offset:3072 nt
    s_and_b32 s46, s42, 3
    s_lshl_b32 s46, s46, 3
    s_add_u32 s46, s46, s57
    s_lshl_b32 s62, s56, 5
    s_add_u32 s46, s46, s62
    s_mul_i32 s46, s46, 40960
    s_add_u32 s46, s46, 8192
    v_lshlrev_b32 v19, 7, v255
    buffer_load_dword v18, v19, s[64:67], s46 offen
    s_mov_b32 s46, 3
    s_call_b64 s[90:91], K1_FC
    s_waitcnt vmcnt(13)
    ds_write_b128 v247, v[152:155] offset:32768
    ds_write_b128 v247, v[156:159] offset:33792
    ds_write_b128 v247, v[160:163] offset:34816
    ds_write_b128 v247, v[164:167] offset:35840
    v_mov_b32 v250, 5
    ds_write_b32 v246, v250
    s_mov_b32 s46, 131072
    buffer_load_dwordx4 v[24:27], v10, s[28:31], s46 offen offset:0 nt
    buffer_load_dwordx4 v[28:31], v11, s[28:31], s46 offen offset:1024 nt
    buffer_load_dwordx4 v[32:35], v12, s[28:31], s46 offen offset:2048 nt
    buffer_load_dwordx4 v[36:39], v13, s[28:31], s46 offen offset:3072 nt
    s_mov_b32 s46, 4
    s_call_b64 s[90:91], K1_FC
    s_waitcnt vmcnt(13)
    ds_write_b128 v248, v[168:171] offset:32768
    ds_write_b128 v248, v[172:175] offset:33792
    ds_write_b128 v248, v[176:179] offset:34816
    ds_write_b128 v248, v[180:183] offset:35840
    s_mov_b32 s46, 131072
    buffer_load_dwordx4 v[40:43], v14, s[32:35], s46 offen offset:0 nt
    buffer_load_dwordx4 v[44:47], v9, s[32:35], s46 offen offset:1024 nt
    buffer_load_dwordx4 v[48:51], v14, s[32:35], s46 offen offset:2048 nt
    buffer_load_dwordx4 v[52:55], v9, s[32:35], s46 offen offset:3072 nt
    s_mov_b32 s46, 147456
    buffer_load_dwordx4 v[56:59], v10, s[28:31], s46 offen offset:0 nt
    buffer_load_dwordx4 v[60:63], v11, s[28:31], s46 offen offset:1024 nt
    buffer_load_dwordx4 v[64:67], v12, s[28:31], s46 offen offset:2048 nt
    buffer_load_dwordx4 v[68:71], v13, s[28:31], s46 offen offset:3072 nt
    s_mov_b32 s46, 5
    s_call_b64 s[90:91], K1_FC
    s_waitcnt vmcnt(17)
    ds_write_b128 v247, v[184:187] offset:49152
    ds_write_b128 v247, v[188:191] offset:50176
    ds_write_b128 v247, v[192:195] offset:51200
    ds_write_b128 v247, v[196:199] offset:52224
    v_mov_b32 v250, 6
    ds_write_b32 v246, v250
    s_mov_b32 s46, 147456
    buffer_load_dwordx4 v[72:75], v14, s[32:35], s46 offen offset:0 nt
    buffer_load_dwordx4 v[76:79], v9, s[32:35], s46 offen offset:1024 nt
    buffer_load_dwordx4 v[80:83], v14, s[32:35], s46 offen offset:2048 nt
    buffer_load_dwordx4 v[84:87], v9, s[32:35], s46 offen offset:3072 nt
    s_mov_b32 s46, 6
    s_call_b64 s[90:91], K1_FC
    s_waitcnt vmcnt(17)
    ds_write_b128 v248, v[200:203] offset:49152
    ds_write_b128 v248, v[204:207] offset:50176
    ds_write_b128 v248, v[208:211] offset:51200
    ds_write_b128 v248, v[212:215] offset:52224
    s_waitcnt vmcnt(12)
    ds_write_b128 v247, v[24:27] offset:0
    ds_write_b128 v247, v[28:31] offset:1024
    ds_write_b128 v247, v[32:35] offset:2048
    ds_write_b128 v247, v[36:39] offset:3072
    v_mov_b32 v250, 7
    ds_write_b32 v246, v250
    s_mov_b32 s46, 163840
    s_add_u32 m0, s45, 32768
    s_nop 0
    buffer_load_dwordx4 v10, s[28:31], s46 offen offset:0 nt lds
    buffer_load_dwordx4 v11, s[28:31], s46 offen offset:1024 nt lds
    buffer_load_dwordx4 v12, s[28:31], s46 offen offset:2048 nt lds
    buffer_load_dwordx4 v13, s[28:31], s46 offen offset:3072 nt lds
    s_mov_b32 s46, 7
    s_call_b64 s[90:91], K1_FC
    s_waitcnt vmcnt(12)
    ds_write_b128 v248, v[40:43] offset:0
    ds_write_b128 v248, v[44:47] offset:1024
    ds_write_b128 v248, v[48:51] offset:2048
    ds_write_b128 v248, v[52:55] offset:3072
    s_waitcnt vmcnt(8)
    ds_write_b128 v247, v[56:59] offset:16384
    ds_write_b128 v247, v[60:63] offset:17408
    ds_write_b128 v247, v[64:67] offset:18432
    ds_write_b128 v247, v[68:71] offset:19456
    v_mov_b32 v250, 8
    ds_write_b32 v246, v250
    s_mov_b32 s46, 163840
    s_add_u32 m0, s45, 98304
    s_nop 0
    buffer_load_dwordx4 v14, s[32:35], s46 offen offset:0 nt lds
    buffer_load_dwordx4 v9, s[32:35], s46 offen offset:1024 nt lds
    buffer_load_dwordx4 v14, s[32:35], s46 offen offset:2048 nt lds
    buffer_load_dwordx4 v9, s[32:35], s46 offen offset:3072 nt lds
    s_mov_b32 s46, 180224
    s_add_u32 m0, s45, 49152
    s_nop 0
    buffer_load_dwordx4 v10, s[28:31], s46 offen offset:0 nt lds
    buffer_load_dwordx4 v11, s[28:31], s46 offen offset:1024 nt lds
    buffer_load_dwordx4 v12, s[28:31], s46 offen offset:2048 nt lds
    buffer_load_dwordx4 v13, s[28:31], s46 offen offset:3072 nt lds
    s_mov_b32 s46, 8
    s_call_b64 s[90:91], K1_FC
    s_waitcnt vmcnt(12)
    ds_write_b128 v248, v[72:75] offset:16384
    ds_write_b128 v248, v[76:79] offset:17408
    ds_write_b128 v248, v[80:83] offset:18432
    ds_write_b128 v248, v[84:87] offset:19456
    s_mov_b32 s46, 180224
    s_add_u32 m0, s45, 114688
    s_nop 0
    buffer_load_dwordx4 v14, s[32:35], s46 offen offset:0 nt lds
    buffer_load_dwordx4 v9, s[32:35], s46 offen offset:1024 nt lds
    buffer_load_dwordx4 v14, s[32:35], s46 offen offset:2048 nt lds
    buffer_load_dwordx4 v9, s[32:35], s46 offen offset:3072 nt lds
    s_waitcnt vmcnt(12)
    v_mov_b32 v250, 9
    ds_write_b32 v246, v250
    s_mov_b32 s46, 196608
    s_add_u32 m0, s45, 0
    s_nop 0
    buffer_load_dwordx4 v10, s[28:31], s46 offen offset:0 nt lds
    buffer_load_dwordx4 v11, s[28:31], s46 offen offset:1024 nt lds
    buffer_load_dwordx4 v12, s[28:31], s46 offen offset:2048 nt lds
    buffer_load_dwordx4 v13, s[28:31], s46 offen offset:3072 nt lds
    s_waitcnt vmcnt(8)
    v_mov_b32 v250, 10
    ds_write_b32 v246, v250
    s_xor_b32 s46, s7, 26
    s_mul_i32 s46, s46, 40960
    s_add_u32 s46, s46, s63
    s_mov_b32 m0, 136192
    s_nop 0
    buffer_load_dwordx4 v238, s[64:67], s46 offen lds
    s_xor_b32 s46, s7, 27
    s_mul_i32 s46, s46, 40960
    s_add_u32 s46, s46, s63
    s_mov_b32 m0, 140288
    s_nop 0
    buffer_load_dwordx4 v237, s[64:67], s46 offen lds
    s_xor_b32 s46, s7, 28
    s_mul_i32 s46, s46, 40960
    s_add_u32 s46, s46, s63
    s_mov_b32 m0, 144384
    s_nop 0
    buffer_load_dwordx4 v236, s[64:67], s46 offen lds
    s_mov_b32 s46, 9
    s_call_b64 s[90:91], K1_FC
    s_mov_b32 s46, 196608
    s_add_u32 m0, s45, 65536
    s_nop 0
    buffer_load_dwordx4 v14, s[32:35], s46 offen offset:0 nt lds
    buffer_load_dwordx4 v9, s[32:35], s46 offen offset:1024 nt lds
    buffer_load_dwordx4 v14, s[32:35], s46 offen offset:2048 nt lds
    buffer_load_dwordx4 v9, s[32:35], s46 offen offset:3072 nt lds
    s_mov_b32 s46, 212992
    s_add_u32 m0, s45, 16384
    s_nop 0
    buffer_load_dwordx4 v10, s[28:31], s46 offen offset:0 nt lds
    buffer_load_dwordx4 v11, s[28:31], s46 offen offset:1024 nt lds
    buffer_load_dwordx4 v12, s[28:31], s46 offen offset:2048 nt lds
    buffer_load_dwordx4 v13, s[28:31], s46 offen offset:3072 nt lds
    s_waitcnt vmcnt(11)
    v_mov_b32 v250, 11
    ds_write_b32 v246, v250
    s_mov_b32 s46, 10
    s_call_b64 s[90:91], K1_FC
    s_mov_b32 s46, 212992
    s_add_u32 m0, s45, 81920
    s_nop 0
    buffer_load_dwordx4 v14, s[32:35], s46 offen offset:0 nt lds
    buffer_load_dwordx4 v9, s[32:35], s46 offen offset:1024 nt lds
    buffer_load_dwordx4 v14, s[32:35], s46 offen offset:2048 nt lds
    buffer_load_dwordx4 v9, s[32:35], s46 offen offset:3072 nt lds
    s_mov_b32 s46, 229376
    s_add_u32 m0, s45, 32768
    s_nop 0
    buffer_load_dwordx4 v10, s[28:31], s46 offen offset:0 nt lds
    buffer_load_dwordx4 v11, s[28:31], s46 offen offset:1024 nt lds
    buffer_load_dwordx4 v12, s[28:31], s46 offen offset:2048 nt lds
    buffer_load_dwordx4 v13, s[28:31], s46 offen offset:3072 nt lds
    s_waitcnt vmcnt(8)
    v_mov_b32 v250, 12
    ds_write_b32 v246, v250
    s_xor_b32 s46, s7, 29
    s_mul_i32 s46, s46, 40960
    s_add_u32 s46, s46, s63
    s_mov_b32 m0, 151552
    s_nop 0
    buffer_load_dwordx4 v238, s[64:67], s46 offen lds
    s_xor_b32 s46, s7, 29
    s_mul_i32 s46, s46, 40960
    s_add_u32 s46, s46, s63
    s_mov_b32 m0, 152576
    s_nop 0
    buffer_load_dwordx4 v239, s[64:67], s46 offen lds
    s_xor_b32 s46, s7, 30
    s_mul_i32 s46, s46, 40960
    s_add_u32 s46, s46, s63
    s_mov_b32 m0, 153600
    s_nop 0
    buffer_load_dwordx4 v235, s[64:67], s46 offen lds
    s_xor_b32 s46, s7, 30
    s_mul_i32 s46, s46, 40960
    s_add_u32 s46, s46, s63
    s_mov_b32 m0, 154624
    s_nop 0
    buffer_load_dwordx4 v236, s[64:67], s46 offen lds
    s_xor_b32 s46, s7, 25
    s_mul_i32 s46, s46, 40960
    s_add_u32 s46, s46, s63
    buffer_load_dwordx4 v[20:23], v239, s[64:67], s46 offen
    v_lshlrev_b32 v17, 4, v255
    v_add_u32 v17, 132096, v17
    s_mov_b32 s46, 11
    s_call_b64 s[90:91], K1_FC
    s_mov_b32 s46, 229376
    s_add_u32 m0, s45, 98304
    s_nop 0
    buffer_load_dwordx4 v14, s[32:35], s46 offen offset:0 nt lds
    buffer_load_dwordx4 v9, s[32:35], s46 offen offset:1024 nt lds
    buffer_load_dwordx4 v14, s[32:35], s46 offen offset:2048 nt lds
    buffer_load_dwordx4 v9, s[32:35], s46 offen offset:3072 nt lds
    s_waitcnt vmcnt(9)
    v_mov_b32 v250, 13
    ds_write_b32 v246, v250
    s_mov_b32 s46, 245760
    s_add_u32 m0, s45, 49152
    s_nop 0
    buffer_load_dwordx4 v10, s[28:31], s46 offen offset:0 nt lds
    buffer_load_dwordx4 v11, s[28:31], s46 offen offset:1024 nt lds
    buffer_load_dwordx4 v12, s[28:31], s46 offen offset:2048 nt lds
    buffer_load_dwordx4 v13, s[28:31], s46 offen offset:3072 nt lds
    s_mov_b32 s46, 12
    s_call_b64 s[90:91], K1_FC
    s_mov_b32 s46, 245760
    s_add_u32 m0, s45, 114688
    s_nop 0
    buffer_load_dwordx4 v14, s[32:35], s46 offen offset:0 nt lds
    buffer_load_dwordx4 v9, s[32:35], s46 offen offset:1024 nt lds
    buffer_load_dwordx4 v14, s[32:35], s46 offen offset:2048 nt lds
    buffer_load_dwordx4 v9, s[32:35], s46 offen offset:3072 nt lds
    s_waitcnt vmcnt(4)
    v_mov_b32 v250, 14
    ds_write_b32 v246, v250
    s_mov_b32 s46, 13
    s_call_b64 s[90:91], K1_FC
    s_xor_b32 s46, s7, 0
    s_mul_i32 s46, s46, 40960
    s_add_u32 s46, s46, s63
    s_mov_b32 m0, 4096
    s_nop 0
    buffer_load_dwordx4 v239, s[64:67], s46 offen lds
    s_xor_b32 s46, s7, 1
    s_mul_i32 s46, s46, 40960
    s_add_u32 s46, s46, s63
    s_mov_b32 m0, 5120
    s_nop 0
    buffer_load_dwordx4 v235, s[64:67], s46 offen lds
    s_xor_b32 s46, s7, 1
    s_mul_i32 s46, s46, 40960
    s_add_u32 s46, s46, s63
    s_mov_b32 m0, 6144
    s_nop 0
    buffer_load_dwordx4 v236, s[64:67], s46 offen lds
    s_xor_b32 s46, s7, 1
    s_mul_i32 s46, s46, 40960
    s_add_u32 s46, s46, s63
    s_mov_b32 m0, 7168
    s_nop 0
    buffer_load_dwordx4 v237, s[64:67], s46 offen lds
    s_xor_b32 s46, s7, 4
    s_mul_i32 s46, s46, 40960
    s_add_u32 s46, s46, s63
    s_mov_b32 m0, 20480
    s_nop 0
    buffer_load_dwordx4 v235, s[64:67], s46 offen lds
    s_xor_b32 s46, s7, 4
    s_mul_i32 s46, s46, 40960
    s_add_u32 s46, s46, s63
    s_mov_b32 m0, 21504
    s_nop 0
    buffer_load_dwordx4 v236, s[64:67], s46 offen lds
    s_xor_b32 s46, s7, 4
    s_mul_i32 s46, s46, 40960
    s_add_u32 s46, s46, s63
    s_mov_b32 m0, 22528
    s_nop 0
    buffer_load_dwordx4 v237, s[64:67], s46 offen lds
    s_xor_b32 s46, s7, 4
    s_mul_i32 s46, s46, 40960
    s_add_u32 s46, s46, s63
    s_mov_b32 m0, 23552
    s_nop 0
    buffer_load_dwordx4 v238, s[64:67], s46 offen lds
    s_waitcnt vmcnt(8)
    v_mov_b32 v250, 15
    ds_write_b32 v246, v250
    s_xor_b32 s46, s7, 13
    s_mul_i32 s46, s46, 40960
    s_add_u32 s46, s46, s63
    s_mov_b32 m0, 69632
    s_nop 0
    buffer_load_dwordx4 v238, s[64:67], s46 offen lds
    s_xor_b32 s46, s7, 13
    s_mul_i32 s46, s46, 40960
    s_add_u32 s46, s46, s63
    s_mov_b32 m0, 70656
    s_nop 0
    buffer_load_dwordx4 v239, s[64:67], s46 offen lds
    s_xor_b32 s46, s7, 14
    s_mul_i32 s46, s46, 40960
    s_add_u32 s46, s46, s63
    s_mov_b32 m0, 71680
    s_nop 0
    buffer_load_dwordx4 v235, s[64:67], s46 offen lds
    s_xor_b32 s46, s7, 14
    s_mul_i32 s46, s46, 40960
    s_add_u32 s46, s46, s63
    s_mov_b32 m0, 72704
    s_nop 0
    buffer_load_dwordx4 v236, s[64:67], s46 offen lds
    s_mov_b32 s46, 14
    s_call_b64 s[90:91], K1_FC
    s_xor_b32 s46, s7, 7
    s_mul_i32 s46, s46, 40960
    s_add_u32 s46, s46, s63
    s_mov_b32 m0, 36864
    s_nop 0
    buffer_load_dwordx4 v236, s[64:67], s46 offen lds
    s_xor_b32 s46, s7, 7
    s_mul_i32 s46, s46, 40960
    s_add_u32 s46, s46, s63
    s_mov_b32 m0, 37888
    s_nop 0
    buffer_load_dwordx4 v237, s[64:67], s46 offen lds
    s_xor_b32 s46, s7, 7
    s_mul_i32 s46, s46, 40960
    s_add_u32 s46, s46, s63
    s_mov_b32 m0, 38912
    s_nop 0
    buffer_load_dwordx4 v238, s[64:67], s46 offen lds
    s_xor_b32 s46, s7, 7
    s_mul_i32 s46, s46, 40960
    s_add_u32 s46, s46, s63
    s_mov_b32 m0, 39936
    s_nop 0
    buffer_load_dwordx4 v239, s[64:67], s46 offen lds
    s_xor_b32 s46, s7, 16
    s_mul_i32 s46, s46, 40960
    s_add_u32 s46, s46, s63
    s_mov_b32 m0, 86016
    s_nop 0
    buffer_load_dwordx4 v239, s[64:67], s46 offen lds
    s_xor_b32 s46, s7, 17
    s_mul_i32 s46, s46, 40960
    s_add_u32 s46, s46, s63
    s_mov_b32 m0, 87040
    s_nop 0
    buffer_load_dwordx4 v235, s[64:67], s46 offen lds
    s_xor_b32 s46, s7, 17
    s_mul_i32 s46, s46, 40960
    s_add_u32 s46, s46, s63
    s_mov_b32 m0, 88064
    s_nop 0
    buffer_load_dwordx4 v236, s[64:67], s46 offen lds
    s_xor_b32 s46, s7, 17
    s_mul_i32 s46, s46, 40960
    s_add_u32 s46, s46, s63
    s_mov_b32 m0, 89088
    s_nop 0
    buffer_load_dwordx4 v237, s[64:67], s46 offen lds
    s_xor_b32 s46, s7, 23
    s_mul_i32 s46, s46, 40960
    s_add_u32 s46, s46, s63
    buffer_load_dwordx4 v[88:91], v236, s[64:67], s46 offen
    s_xor_b32 s46, s7, 23
    s_mul_i32 s46, s46, 40960
    s_add_u32 s46, s46, s63
    buffer_load_dwordx4 v[92:95], v237, s[64:67], s46 offen
    s_xor_b32 s46, s7, 23
    s_mul_i32 s46, s46, 40960
    s_add_u32 s46, s46, s63
    buffer_load_dwordx4 v[96:99], v238, s[64:67], s46 offen
    s_xor_b32 s46, s7, 23
    s_mul_i32 s46, s46, 40960
    s_add_u32 s46, s46, s63
    buffer_load_dwordx4 v[100:103], v239, s[64:67], s46 offen
    s_mov_b32 s46, 15
    s_call_b64 s[90:91], K1_FC
    s_xor_b32 s46, s7, 10
    s_mul_i32 s46, s46, 40960
    s_add_u32 s46, s46, s63
    s_mov_b32 m0, 53248
    s_nop 0
    buffer_load_dwordx4 v237, s[64:67], s46 offen lds
    s_xor_b32 s46, s7, 10
    s_mul_i32 s46, s46, 40960
    s_add_u32 s46, s46, s63
    s_mov_b32 m0, 54272
    s_nop 0
    buffer_load_dwordx4 v238, s[64:67], s46 offen lds
    s_xor_b32 s46, s7, 10
    s_mul_i32 s46, s46, 40960
    s_add_u32 s46, s46, s63
    s_mov_b32 m0, 55296
    s_nop 0
    buffer_load_dwordx4 v239, s[64:67], s46 offen lds
    s_xor_b32 s46, s7, 11
    s_mul_i32 s46, s46, 40960
    s_add_u32 s46, s46, s63
    s_mov_b32 m0, 56320
    s_nop 0
    buffer_load_dwordx4 v235, s[64:67], s46 offen lds
    s_xor_b32 s46, s7, 20
    s_mul_i32 s46, s46, 40960
    s_add_u32 s46, s46, s63
    s_mov_b32 m0, 102400
    s_nop 0
    buffer_load_dwordx4 v235, s[64:67], s46 offen lds
    s_xor_b32 s46, s7, 20
    s_mul_i32 s46, s46, 40960
    s_add_u32 s46, s46, s63
    s_mov_b32 m0, 103424
    s_nop 0
    buffer_load_dwordx4 v236, s[64:67], s46 offen lds
    s_xor_b32 s46, s7, 20
    s_mul_i32 s46, s46, 40960
    s_add_u32 s46, s46, s63
    s_mov_b32 m0, 104448
    s_nop 0
    buffer_load_dwordx4 v237, s[64:67], s46 offen lds
    s_xor_b32 s46, s7, 20
    s_mul_i32 s46, s46, 40960
    s_add_u32 s46, s46, s63
    s_mov_b32 m0, 105472
    s_nop 0
    buffer_load_dwordx4 v238, s[64:67], s46 offen lds
    v_lshlrev_b32 v229, 4, v255
    s_lshl_b32 s46, s77, 17
    v_add_u32 v230, s46, v229
    v_xor_b32 v229, 0x20000, v230
    s_lshl_b32 s47, s42, 20
    s_lshl_b32 s46, s76, 18
    s_add_u32 s47, s47, s46
    s_lshl_b32 s46, s56, 15
    s_add_u32 s47, s47, s46
    s_lshl_b32 s46, s10, 14
    s_add_u32 s47, s47, s46
    s_mov_b32 s83, 0
    s_mov_b32 s85, 0
    s_mov_b32 s86, -1
    s_mov_b32 s8, 1
    v_lshrrev_b32 v231, 2, v255
    v_mul_u32_u24 v231, 160, v231
    v_and_b32 v232, 3, v255
    v_lshl_add_u32 v231, v232, 3, v231
    v_lshlrev_b32 v234, 13, v255
    v_and_b32 v228, 31, v255
    v_lshlrev_b32 v228, 7, v228
    v_lshrrev_b32 v227, 5, v255
    v_lshl_add_u32 v228, v227, 17, v228
    s_mov_b32 s4, 0
    s_mul_i32 s46, s10, 81920
    v_add_u32 v231, s46, v231
    s_mov_b32 s80, 0
    s_mov_b32 s81, 0
    s_mov_b32 s82, 0
    s_mov_b32 s84, 0
    s_mov_b32 s11, 0
    s_mov_b32 s49, 0
    s_mov_b32 s6, 0
    s_buffer_load_dword s12, s[36:39], s78 glc
    s_waitcnt vmcnt(8)
    s_mov_b32 s46, 16
    s_call_b64 s[90:91], K1_FC
    ds_write_b128 v17, v[20:23]
    ds_write_b128 v248, v[88:91] offset:49152
    ds_write_b128 v248, v[92:95] offset:50176
    ds_write_b128 v248, v[96:99] offset:51200
    ds_write_b128 v248, v[100:103] offset:52224
    s_mov_b32 s5, 2
    s_waitcnt lgkmcnt(0)
    s_call_b64 s[90:91], K1_SVC
    s_mov_b32 s46, s85
    s_call_b64 s[90:91], K1_WV
    s_barrier
    s_setprio 1
    s_branch K1_B0
K1_LL2:
    v_and_b32 v246, 3, v255
    v_lshlrev_b32 v246, 3, v246
    v_add_u32 v246, 133184, v246
    v_mov_b32 v250, 2
    v_mov_b32 v251, 0
    ds_write_b64 v246, v[250:251]
    s_waitcnt lgkmcnt(0)
    s_barrier
    s_waitcnt vmcnt(16)
    ds_write_b128 v247, v[88:91] offset:0
    ds_write_b128 v247, v[92:95] offset:1024
    ds_write_b128 v247, v[96:99] offset:2048
    ds_write_b128 v247, v[100:103] offset:3072
    v_mov_b32 v250, 3
    ds_write_b32 v246, v250
    s_mov_b32 s46, 98304
    buffer_load_dwordx4 v[168:171], v14, s[32:35], s46 offen offset:0 nt
    buffer_load_dwordx4 v[172:175], v9, s[32:35], s46 offen offset:1024 nt
    buffer_load_dwordx4 v[176:179], v14, s[32:35], s46 offen offset:2048 nt
    buffer_load_dwordx4 v[180:183], v9, s[32:35], s46 offen offset:3072 nt
    s_mov_b32 s46, 1
    s_call_b64 s[90:91], K1_FC
    s_waitcnt vmcnt(16)
    ds_write_b128 v248, v[104:107] offset:0
    ds_write_b128 v248, v[108:111] offset:1024
    ds_write_b128 v248, v[112:115] offset:2048
    ds_write_b128 v248, v[116:119] offset:3072
    s_waitcnt vmcnt(12)
    ds_write_b128 v247, v[120:123] offset:16384
    ds_write_b128 v247, v[124:127] offset:17408
    ds_write_b128 v247, v[128:131] offset:18432
    ds_write_b128 v247, v[132:135] offset:19456
    v_mov_b32 v250, 4
    ds_write_b32 v246, v250
    s_mov_b32 s46, 114688
    buffer_load_dwordx4 v[184:187], v10, s[28:31], s46 offen offset:0 nt
    buffer_load_dwordx4 v[188:191], v11, s[28:31], s46 offen offset:1024 nt
    buffer_load_dwordx4 v[192:195], v12, s[28:31], s46 offen offset:2048 nt
    buffer_load_dwordx4 v[196:199], v13, s[28:31], s46 offen offset:3072 nt
    s_mov_b32 s46, 2
    s_call_b64 s[90:91], K1_FC
    s_waitcnt vmcnt(12)
    ds_write_b128 v248, v[136:139] offset:16384
    ds_write_b128 v248, v[140:143] offset:17408
    ds_write_b128 v248, v[144:147] offset:18432
    ds_write_b128 v248, v[148:151] offset:19456
    s_mov_b32 s46, 114688
    buffer_load_dwordx4 v[200:203], v14, s[32:35], s46 offen offset:0 nt
    buffer_load_dwordx4 v[204:207], v9, s[32:35], s46 offen offset:1024 nt
    buffer_load_dwordx4 v[208:211], v14, s[32:35], s46 offen offset:2048 nt
    buffer_load_dwordx4 v[212:215], v9, s[32:35], s46 offen offset:3072 nt
    s_mov_b32 s46, 3
    s_call_b64 s[90:91], K1_FC
    s_waitcnt vmcnt(12)
    ds_write_b128 v247, v[152:155] offset:32768
    ds_write_b128 v247, v[156:159] offset:33792
    ds_write_b128 v247, v[160:163] offset:34816
    ds_write_b128 v247, v[164:167] offset:35840
    v_mov_b32 v250, 5
    ds_write_b32 v246, v250
    s_mov_b32 s46, 131072
    buffer_load_dwordx4 v[24:27], v10, s[28:31], s46 offen offset:0 nt
    buffer_load_dwordx4 v[28:31], v11, s[28:31], s46 offen offset:1024 nt
    buffer_load_dwordx4 v[32:35], v12, s[28:31], s46 offen offset:2048 nt
    buffer_load_dwordx4 v[36:39], v13, s[28:31], s46 offen offset:3072 nt
    s_and_b32 s46, s42, 3
    s_lshl_b32 s46, s46, 3
    s_add_u32 s46, s46, s57
    s_lshl_b32 s62, s56, 5
    s_add_u32 s46, s46, s62
    s_mul_i32 s46, s46, 40960
    s_add_u32 s46, s46, 16384
    v_lshlrev_b32 v19, 7, v255
    buffer_load_dword v18, v19, s[64:67], s46 offen
    s_mov_b32 s46, 4
    s_call_b64 s[90:91], K1_FC
    s_waitcnt vmcnt(13)
    ds_write_b128 v248, v[168:171] offset:32768
    ds_write_b128 v248, v[172:175] offset:33792
    ds_write_b128 v248, v[176:179] offset:34816
    ds_write_b128 v248, v[180:183] offset:35840
    s_mov_b32 s46, 131072
    buffer_load_dwordx4 v[40:43], v14, s[32:35], s46 offen offset:0 nt
    buffer_load_dwordx4 v[44:47], v9, s[32:35], s46 offen offset:1024 nt
    buffer_load_dwordx4 v[48:51], v14, s[32:35], s46 offen offset:2048 nt
    buffer_load_dwordx4 v[52:55], v9, s[32:35], s46 offen offset:3072 nt
    s_mov_b32 s46, 147456
    buffer_load_dwordx4 v[56:59], v10, s[28:31], s46 offen offset:0 nt
    buffer_load_dwordx4 v[60:63], v11, s[28:31], s46 offen offset:1024 nt
    buffer_load_dwordx4 v[64:67], v12, s[28:31], s46 offen offset:2048 nt
    buffer_load_dwordx4 v[68:71], v13, s[28:31], s46 offen offset:3072 nt
    s_mov_b32 s46, 5
    s_call_b64 s[90:91], K1_FC
    s_waitcnt vmcnt(17)
    ds_write_b128 v247, v[184:187] offset:49152
    ds_write_b128 v247, v[188:191] offset:50176
    ds_write_b128 v247, v[192:195] offset:51200
    ds_write_b128 v247, v[196:199] offset:52224
    v_mov_b32 v250, 6
    ds_write_b32 v246, v250
    s_mov_b32 s46, 147456
    buffer_load_dwordx4 v[72:75], v14, s[32:35], s46 offen offset:0 nt
    buffer_load_dwordx4 v[76:79], v9, s[32:35], s46 offen offset:1024 nt
    buffer_load_dwordx4 v[80:83], v14, s[32:35], s46 offen offset:2048 nt
    buffer_load_dwordx4 v[84:87], v9, s[32:35], s46 offen offset:3072 nt
    s_mov_b32 s46, 6
    s_call_b64 s[90:91], K1_FC
    s_waitcnt vmcnt(17)
    ds_write_b128 v248, v[200:203] offset:49152
    ds_write_b128 v248, v[204:207] offset:50176
    ds_write_b128 v248, v[208:211] offset:51200
    ds_write_b128 v248, v[212:215] offset:52224
    s_waitcnt vmcnt(13)
    ds_write_b128 v247, v[24:27] offset:0
    ds_write_b128 v247, v[28:31] offset:1024
    ds_write_b128 v247, v[32:35] offset:2048
    ds_write_b128 v247, v[36:39] offset:3072
    v_mov_b32 v250, 7
    ds_write_b32 v246, v250
    s_mov_b32 s46, 163840
    s_add_u32 m0, s45, 32768
    s_nop 0
    buffer_load_dwordx4 v10, s[28:31], s46 offen offset:0 nt lds
    buffer_load_dwordx4 v11, s[28:31], s46 offen offset:1024 nt lds
    buffer_load_dwordx4 v12, s[28:31], s46 offen offset:2048 nt lds
    buffer_load_dwordx4 v13, s[28:31], s46 offen offset:3072 nt lds
    s_mov_b32 s46, 7
    s_call_b64 s[90:91], K1_FC
    s_waitcnt vmcnt(12)
    ds_write_b128 v248, v[40:43] offset:0
    ds_write_b128 v248, v[44:47] offset:1024
    ds_write_b128 v248, v[48:51] offset:2048
    ds_write_b128 v248, v[52:55] offset:3072
    s_waitcnt vmcnt(8)
    ds_write_b128 v247, v[56:59] offset:16384
    ds_write_b128 v247, v[60:63] offset:17408
    ds_write_b128 v247, v[64:67] offset:18432
    ds_write_b128 v247, v[68:71] offset:19456
    v_mov_b32 v250, 8
    ds_write_b32 v246, v250
    s_mov_b32 s46, 163840
    s_add_u32 m0, s45, 98304
    s_nop 0
    buffer_load_dwordx4 v14, s[32:35], s46 offen offset:0 nt lds
    buffer_load_dwordx4 v9, s[32:35], s46 offen offset:1024 nt lds
    buffer_load_dwordx4 v14, s[32:35], s46 offen offset:2048 nt lds
    buffer_load_dwordx4 v9, s[32:35], s46 offen offset:3072 nt lds
    s_mov_b32 s46, 180224
    s_add_u32 m0, s45, 49152
    s_nop 0
    buffer_load_dwordx4 v10, s[28:31], s46 offen offset:0 nt lds
    buffer_load_dwordx4 v11, s[28:31], s46 offen offset:1024 nt lds
    buffer_load_dwordx4 v12, s[28:31], s46 offen offset:2048 nt lds
    buffer_load_dwordx4 v13, s[28:31], s46 offen offset:3072 nt lds
    s_mov_b32 s46, 8
    s_call_b64 s[90:91], K1_FC
    s_waitcnt vmcnt(12)
    ds_write_b128 v248, v[72:75] offset:16384
    ds_write_b128 v248, v[76:79] offset:17408
    ds_write_b128 v248, v[80:83] offset:18432
    ds_write_b128 v248, v[84:87] offset:19456
    s_mov_b32 s46, 180224
    s_add_u32 m0, s45, 114688
    s_nop 0
    buffer_load_dwordx4 v14, s[32:35], s46 offen offset:0 nt lds
    buffer_load_dwordx4 v9, s[32:35], s46 offen offset:1024 nt lds
    buffer_load_dwordx4 v14, s[32:35], s46 offen offset:2048 nt lds
    buffer_load_dwordx4 v9, s[32:35], s46 offen offset:3072 nt lds
    s_waitcnt vmcnt(12)
    v_mov_b32 v250, 9
    ds_write_b32 v246, v250
    s_mov_b32 s46, 196608
    s_add_u32 m0, s45, 0
    s_nop 0
    buffer_load_dwordx4 v10, s[28:31], s46 offen offset:0 nt lds
    buffer_load_dwordx4 v11, s[28:31], s46 offen offset:1024 nt lds
    buffer_load_dwordx4 v12, s[28:31], s46 offen offset:2048 nt lds
    buffer_load_dwordx4 v13, s[28:31], s46 offen offset:3072 nt lds
    s_waitcnt vmcnt(8)
    v_mov_b32 v250, 10
    ds_write_b32 v246, v250
    s_xor_b32 s46, s7, 26
    s_mul_i32 s46, s46, 40960
    s_add_u32 s46, s46, s63
    s_mov_b32 m0, 137216
    s_nop 0
    buffer_load_dwordx4 v239, s[64:67], s46 offen lds
    s_xor_b32 s46, s7, 27
    s_mul_i32 s46, s46, 40960
    s_add_u32 s46, s46, s63
    s_mov_b32 m0, 141312
    s_nop 0
    buffer_load_dwordx4 v238, s[64:67], s46 offen lds
    s_xor_b32 s46, s7, 28
    s_mul_i32 s46, s46, 40960
    s_add_u32 s46, s46, s63
    s_mov_b32 m0, 145408
    s_nop 0
    buffer_load_dwordx4 v237, s[64:67], s46 offen lds
    s_mov_b32 s46, 9
    s_call_b64 s[90:91], K1_FC
    s_mov_b32 s46, 196608
    s_add_u32 m0, s45, 65536
    s_nop 0
    buffer_load_dwordx4 v14, s[32:35], s46 offen offset:0 nt lds
    buffer_load_dwordx4 v9, s[32:35], s46 offen offset:1024 nt lds
    buffer_load_dwordx4 v14, s[32:35], s46 offen offset:2048 nt lds
    buffer_load_dwordx4 v9, s[32:35], s46 offen offset:3072 nt lds
    s_mov_b32 s46, 212992
    s_add_u32 m0, s45, 16384
    s_nop 0
    buffer_load_dwordx4 v10, s[28:31], s46 offen offset:0 nt lds
    buffer_load_dwordx4 v11, s[28:31], s46 offen offset:1024 nt lds
    buffer_load_dwordx4 v12, s[28:31], s46 offen offset:2048 nt lds
    buffer_load_dwordx4 v13, s[28:31], s46 offen offset:3072 nt lds
    s_waitcnt vmcnt(11)
    v_mov_b32 v250, 11
    ds_write_b32 v246, v250
    s_mov_b32 s46, 10
    s_call_b64 s[90:91], K1_FC
    s_mov_b32 s46, 212992
    s_add_u32 m0, s45, 81920
    s_nop 0
    buffer_load_dwordx4 v14, s[32:35], s46 offen offset:0 nt lds
    buffer_load_dwordx4 v9, s[32:35], s46 offen offset:1024 nt lds
    buffer_load_dwordx4 v14, s[32:35], s46 offen offset:2048 nt lds
    buffer_load_dwordx4 v9, s[32:35], s46 offen offset:3072 nt lds
    s_mov_b32 s46, 229376
    s_add_u32 m0, s45, 32768
    s_nop 0
    buffer_load_dwordx4 v10, s[28:31], s46 offen offset:0 nt lds
    buffer_load_dwordx4 v11, s[28:31], s46 offen offset:1024 nt lds
    buffer_load_dwordx4 v12, s[28:31], s46 offen offset:2048 nt lds
    buffer_load_dwordx4 v13, s[28:31], s46 offen offset:3072 nt lds
    s_waitcnt vmcnt(8)
    v_mov_b32 v250, 12
    ds_write_b32 v246, v250
    s_xor_b32 s46, s7, 30
    s_mul_i32 s46, s46, 40960
    s_add_u32 s46, s46, s63
    s_mov_b32 m0, 155648
    s_nop 0
    buffer_load_dwordx4 v237, s[64:67], s46 offen lds
    s_xor_b32 s46, s7, 30
    s_mul_i32 s46, s46, 40960
    s_add_u32 s46, s46, s63
    s_mov_b32 m0, 156672
    s_nop 0
    buffer_load_dwordx4 v238, s[64:67], s46 offen lds
    s_xor_b32 s46, s7, 30
    s_mul_i32 s46, s46, 40960
    s_add_u32 s46, s46, s63
    s_mov_b32 m0, 157696
    s_nop 0
    buffer_load_dwordx4 v239, s[64:67], s46 offen lds
    s_xor_b32 s46, s7, 31
    s_mul_i32 s46, s46, 40960
    s_add_u32 s46, s46, s63
    s_mov_b32 m0, 158720
    s_nop 0
    buffer_load_dwordx4 v235, s[64:67], s46 offen lds
    s_xor_b32 s46, s7, 26
    s_mul_i32 s46, s46, 40960
    s_add_u32 s46, s46, s63
    buffer_load_dwordx4 v[20:23], v235, s[64:67], s46 offen
    v_lshlrev_b32 v17, 4, v255
    v_add_u32 v17, 133120, v17
    s_mov_b32 s46, 11
    s_call_b64 s[90:91], K1_FC
    s_mov_b32 s46, 229376
    s_add_u32 m0, s45, 98304
    s_nop 0
    buffer_load_dwordx4 v14, s[32:35], s46 offen offset:0 nt lds
    buffer_load_dwordx4 v9, s[32:35], s46 offen offset:1024 nt lds
    buffer_load_dwordx4 v14, s[32:35], s46 offen offset:2048 nt lds
    buffer_load_dwordx4 v9, s[32:35], s46 offen offset:3072 nt lds
    s_waitcnt vmcnt(9)
    v_mov_b32 v250, 13
    ds_write_b32 v246, v250
    s_mov_b32 s46, 245760
    s_add_u32 m0, s45, 49152
    s_nop 0
    buffer_load_dwordx4 v10, s[28:31], s46 offen offset:0 nt lds
    buffer_load_dwordx4 v11, s[28:31], s46 offen offset:1024 nt lds
    buffer_load_dwordx4 v12, s[28:31], s46 offen offset:2048 nt lds
    buffer_load_dwordx4 v13, s[28:31], s46 offen offset:3072 nt lds
    s_mov_b32 s46, 12
    s_call_b64 s[90:91], K1_FC
    s_mov_b32 s46, 245760
    s_add_u32 m0, s45, 114688
    s_nop 0
    buffer_load_dwordx4 v14, s[32:35], s46 offen offset:0 nt lds
    buffer_load_dwordx4 v9, s[32:35], s46 offen offset:1024 nt lds
    buffer_load_dwordx4 v14, s[32:35], s46 offen offset:2048 nt lds
    buffer_load_dwordx4 v9, s[32:35], s46 offen offset:3072 nt lds
    s_waitcnt vmcnt(4)
    v_mov_b32 v250, 14
    ds_write_b32 v246, v250
    s_mov_b32 s46, 13
    s_call_b64 s[90:91], K1_FC
    s_xor_b32 s46, s7, 1
    s_mul_i32 s46, s46, 40960
    s_add_u32 s46, s46, s63
    s_mov_b32 m0, 8192
    s_nop 0
    buffer_load_dwordx4 v238, s[64:67], s46 offen lds
    s_xor_b32 s46, s7, 1
    s_mul_i32 s46, s46, 40960
    s_add_u32 s46, s46, s63
    s_mov_b32 m0, 9216
    s_nop 0
    buffer_load_dwordx4 v239, s[64:67], s46 offen lds
    s_xor_b32 s46, s7, 2
    s_mul_i32 s46, s46, 40960
    s_add_u32 s46, s46, s63
    s_mov_b32 m0, 10240
    s_nop 0
    buffer_load_dwordx4 v235, s[64:67], s46 offen lds
    s_xor_b32 s46, s7, 2
    s_mul_i32 s46, s46, 40960
    s_add_u32 s46, s46, s63
    s_mov_b32 m0, 11264
    s_nop 0
    buffer_load_dwordx4 v236, s[64:67], s46 offen lds
    s_xor_b32 s46, s7, 4
    s_mul_i32 s46, s46, 40960
    s_add_u32 s46, s46, s63
    s_mov_b32 m0, 24576
    s_nop 0
    buffer_load_dwordx4 v239, s[64:67], s46 offen lds
    s_xor_b32 s46, s7, 5
    s_mul_i32 s46, s46, 40960
    s_add_u32 s46, s46, s63
    s_mov_b32 m0, 25600
    s_nop 0
    buffer_load_dwordx4 v235, s[64:67], s46 offen lds
    s_xor_b32 s46, s7, 5
    s_mul_i32 s46, s46, 40960
    s_add_u32 s46, s46, s63
    s_mov_b32 m0, 26624
    s_nop 0
    buffer_load_dwordx4 v236, s[64:67], s46 offen lds
    s_xor_b32 s46, s7, 5
    s_mul_i32 s46, s46, 40960
    s_add_u32 s46, s46, s63
    s_mov_b32 m0, 27648
    s_nop 0
    buffer_load_dwordx4 v237, s[64:67], s46 offen lds
    s_waitcnt vmcnt(8)
    v_mov_b32 v250, 15
    ds_write_b32 v246, v250
    s_xor_b32 s46, s7, 14
    s_mul_i32 s46, s46, 40960
    s_add_u32 s46, s46, s63
    s_mov_b32 m0, 73728
    s_nop 0
    buffer_load_dwordx4 v237, s[64:67], s46 offen lds
    s_xor_b32 s46, s7, 14
    s_mul_i32 s46, s46, 40960
    s_add_u32 s46, s46, s63
    s_mov_b32 m0, 74752
    s_nop 0
    buffer_load_dwordx4 v238, s[64:67], s46 offen lds
    s_xor_b32 s46, s7, 14
    s_mul_i32 s46, s46, 40960
    s_add_u32 s46, s46, s63
    s_mov_b32 m0, 75776
    s_nop 0
    buffer_load_dwordx4 v239, s[64:67], s46 offen lds
    s_xor_b32 s46, s7, 15
    s_mul_i32 s46, s46, 40960
    s_add_u32 s46, s46, s63
    s_mov_b32 m0, 76800
    s_nop 0
    buffer_load_dwordx4 v235, s[64:67], s46 offen lds
    s_mov_b32 s46, 14
    s_call_b64 s[90:91], K1_FC
    s_xor_b32 s46, s7, 8
    s_mul_i32 s46, s46, 40960
    s_add_u32 s46, s46, s63
    s_mov_b32 m0, 40960
    s_nop 0
    buffer_load_dwordx4 v235, s[64:67], s46 offen lds
    s_xor_b32 s46, s7, 8
    s_mul_i32 s46, s46, 40960
    s_add_u32 s46, s46, s63
    s_mov_b32 m0, 41984
    s_nop 0
    buffer_load_dwordx4 v236, s[64:67], s46 offen lds
    s_xor_b32 s46, s7, 8
    s_mul_i32 s46, s46, 40960
    s_add_u32 s46, s46, s63
    s_mov_b32 m0, 43008
    s_nop 0
    buffer_load_dwordx4 v237, s[64:67], s46 offen lds
    s_xor_b32 s46, s7, 8
    s_mul_i32 s46, s46, 40960
    s_add_u32 s46, s46, s63
    s_mov_b32 m0, 44032
    s_nop 0
    buffer_load_dwordx4 v238, s[64:67], s46 offen lds
    s_xor_b32 s46, s7, 17
    s_mul_i32 s46, s46, 40960
    s_add_u32 s46, s46, s63
    s_mov_b32 m0, 90112
    s_nop 0
    buffer_load_dwordx4 v238, s[64:67], s46 offen lds
    s_xor_b32 s46, s7, 17
    s_mul_i32 s46, s46, 40960
    s_add_u32 s46, s46, s63
    s_mov_b32 m0, 91136
    s_nop 0
    buffer_load_dwordx4 v239, s[64:67], s46 offen lds
    s_xor_b32 s46, s7, 18
    s_mul_i32 s46, s46, 40960
    s_add_u32 s46, s46, s63
    s_mov_b32 m0, 92160
    s_nop 0
    buffer_load_dwordx4 v235, s[64:67], s46 offen lds
    s_xor_b32 s46, s7, 18
    s_mul_i32 s46, s46, 40960
    s_add_u32 s46, s46, s63
    s_mov_b32 m0, 93184
    s_nop 0
    buffer_load_dwordx4 v236, s[64:67], s46 offen lds
    s_xor_b32 s46, s7, 24
    s_mul_i32 s46, s46, 40960
    s_add_u32 s46, s46, s63
    buffer_load_dwordx4 v[88:91], v235, s[64:67], s46 offen
    s_xor_b32 s46, s7, 24
    s_mul_i32 s46, s46, 40960
    s_add_u32 s46, s46, s63
    buffer_load_dwordx4 v[92:95], v236, s[64:67], s46 offen
    s_xor_b32 s46, s7, 24
    s_mul_i32 s46, s46, 40960
    s_add_u32 s46, s46, s63
    buffer_load_dwordx4 v[96:99], v237, s[64:67], s46 offen
    s_xor_b32 s46, s7, 24
    s_mul_i32 s46, s46, 40960
    s_add_u32 s46, s46, s63
    buffer_load_dwordx4 v[100:103], v238, s[64:67], s46 offen
    s_mov_b32 s46, 15
    s_call_b64 s[90:91], K1_FC
    s_xor_b32 s46, s7, 11
    s_mul_i32 s46, s46, 40960
    s_add_u32 s46, s46, s63
    s_mov_b32 m0, 57344
    s_nop 0
    buffer_load_dwordx4 v236, s[64:67], s46 offen lds
    s_xor_b32 s46, s7, 11
    s_mul_i32 s46, s46, 40960
    s_add_u32 s46, s46, s63
    s_mov_b32 m0, 58368
    s_nop 0
    buffer_load_dwordx4 v237, s[64:67], s46 offen lds
    s_xor_b32 s46, s7, 11
    s_mul_i32 s46, s46, 40960
    s_add_u32 s46, s46, s63
    s_mov_b32 m0, 59392
    s_nop 0
    buffer_load_dwordx4 v238, s[64:67], s46 offen lds
    s_xor_b32 s46, s7, 11
    s_mul_i32 s46, s46, 40960
    s_add_u32 s46, s46, s63
    s_mov_b32 m0, 60416
    s_nop 0
    buffer_load_dwordx4 v239, s[64:67], s46 offen lds
    s_xor_b32 s46, s7, 20
    s_mul_i32 s46, s46, 40960
    s_add_u32 s46, s46, s63
    s_mov_b32 m0, 106496
    s_nop 0
    buffer_load_dwordx4 v239, s[64:67], s46 offen lds
    s_xor_b32 s46, s7, 21
    s_mul_i32 s46, s46, 40960
    s_add_u32 s46, s46, s63
    s_mov_b32 m0, 107520
    s_nop 0
    buffer_load_dwordx4 v235, s[64:67], s46 offen lds
    s_xor_b32 s46, s7, 21
    s_mul_i32 s46, s46, 40960
    s_add_u32 s46, s46, s63
    s_mov_b32 m0, 108544
    s_nop 0
    buffer_load_dwordx4 v236, s[64:67], s46 offen lds
    s_xor_b32 s46, s7, 21
    s_mul_i32 s46, s46, 40960
    s_add_u32 s46, s46, s63
    s_mov_b32 m0, 109568
    s_nop 0
    buffer_load_dwordx4 v237, s[64:67], s46 offen lds
    v_lshlrev_b32 v229, 4, v255
    s_lshl_b32 s46, s77, 17
    v_add_u32 v230, s46, v229
    v_xor_b32 v229, 0x20000, v230
    s_lshl_b32 s47, s42, 20
    s_lshl_b32 s46, s76, 18
    s_add_u32 s47, s47, s46
    s_lshl_b32 s46, s56, 15
    s_add_u32 s47, s47, s46
    s_lshl_b32 s46, s10, 14
    s_add_u32 s47, s47, s46
    s_mov_b32 s83, 0
    s_mov_b32 s85, 0
    s_mov_b32 s86, -1
    s_mov_b32 s8, 1
    v_lshrrev_b32 v231, 2, v255
    v_mul_u32_u24 v231, 160, v231
    v_and_b32 v232, 3, v255
    v_lshl_add_u32 v231, v232, 3, v231
    v_lshlrev_b32 v234, 13, v255
    v_and_b32 v228, 31, v255
    v_lshlrev_b32 v228, 7, v228
    v_lshrrev_b32 v227, 5, v255
    v_lshl_add_u32 v228, v227, 17, v228
    s_mov_b32 s4, 0
    s_mul_i32 s46, s10, 81920
    v_add_u32 v231, s46, v231
    s_mov_b32 s80, 0
    s_mov_b32 s81, 0
    s_mov_b32 s82, 0
    s_mov_b32 s84, 0
    s_mov_b32 s11, 0
    s_mov_b32 s49, 0
    s_mov_b32 s6, 0
    s_buffer_load_dword s12, s[36:39], s78 glc
    s_waitcnt vmcnt(8)
    s_mov_b32 s46, 16
    s_call_b64 s[90:91], K1_FC
    ds_write_b128 v17, v[20:23]
    ds_write_b128 v248, v[88:91] offset:49152
    ds_write_b128 v248, v[92:95] offset:50176
    ds_write_b128 v248, v[96:99] offset:51200
    ds_write_b128 v248, v[100:103] offset:52224
    s_mov_b32 s5, 2
    s_waitcnt lgkmcnt(0)
    s_call_b64 s[90:91], K1_SVC
    s_mov_b32 s46, s85
    s_call_b64 s[90:91], K1_WV
    s_barrier
    s_setprio 1
    s_branch K1_B0
K1_LL3:
    v_and_b32 v246, 3, v255
    v_lshlrev_b32 v246, 3, v246
    v_add_u32 v246, 134240, v246
    v_mov_b32 v250, 2
    v_mov_b32 v251, 0
    ds_write_b64 v246, v[250:251]
    s_waitcnt lgkmcnt(0)
    s_barrier
    s_waitcnt vmcnt(16)
    ds_write_b128 v247, v[88:91] offset:0
    ds_write_b128 v247, v[92:95] offset:1024
    ds_write_b128 v247, v[96:99] offset:2048
    ds_write_b128 v247, v[100:103] offset:3072
    v_mov_b32 v250, 3
    ds_write_b32 v246, v250
    s_mov_b32 s46, 98304
    buffer_load_dwordx4 v[168:171], v14, s[32:35], s46 offen offset:0 nt
    buffer_load_dwordx4 v[172:175], v9, s[32:35], s46 offen offset:1024 nt
    buffer_load_dwordx4 v[176:179], v14, s[32:35], s46 offen offset:2048 nt
    buffer_load_dwordx4 v[180:183], v9, s[32:35], s46 offen offset:3072 nt
    v_mov_b32 v2, 0
    v_lshlrev_b32 v3, 9, v255
    s_mov_b64 exec, 1023
    buffer_store_dword v2, v3, s[36:39], s54 offen sc0 sc1
    s_mov_b64 exec, -1
    s_mov_b32 s46, 1
    s_call_b64 s[90:91], K1_FC
    s_waitcnt vmcnt(17)
    ds_write_b128 v248, v[104:107] offset:0
    ds_write_b128 v248, v[108:111] offset:1024
    ds_write_b128 v248, v[112:115] offset:2048
    ds_write_b128 v248, v[116:119] offset:3072
    s_waitcnt vmcnt(13)
    ds_write_b128 v247, v[120:123] offset:16384
    ds_write_b128 v247, v[124:127] offset:17408
    ds_write_b128 v247, v[128:131] offset:18432
    ds_write_b128 v247, v[132:135] offset:19456
    v_mov_b32 v250, 4
    ds_write_b32 v246, v250
    s_mov_b32 s46, 114688
    buffer_load_dwordx4 v[184:187], v10, s[28:31], s46 offen offset:0 nt
    buffer_load_dwordx4 v[188:191], v11, s[28:31], s46 offen offset:1024 nt
    buffer_load_dwordx4 v[192:195], v12, s[28:31], s46 offen offset:2048 nt
    buffer_load_dwordx4 v[196:199], v13, s[28:31], s46 offen offset:3072 nt
    s_mov_b32 s46, 2
    s_call_b64 s[90:91], K1_FC
    s_waitcnt vmcnt(13)
    ds_write_b128 v248, v[136:139] offset:16384
    ds_write_b128 v248, v[140:143] offset:17408
    ds_write_b128 v248, v[144:147] offset:18432
    ds_write_b128 v248, v[148:151] offset:19456
    s_mov_b32 s46, 114688
    buffer_load_dwordx4 v[200:203], v14, s[32:35], s46 offen offset:0 nt
    buffer_load_dwordx4 v[204:207], v9, s[32:35], s46 offen offset:1024 nt
    buffer_load_dwordx4 v[208:211], v14, s[32:35], s46 offen offset:2048 nt
    buffer_load_dwordx4 v[212:215], v9, s[32:35], s46 offen offset:3072 nt
    s_mov_b32 s46, 3
    s_call_b64 s[90:91], K1_FC
    s_waitcnt vmcnt(13)
    ds_write_b128 v247, v[152:155] offset:32768
    ds_write_b128 v247, v[156:159] offset:33792
    ds_write_b128 v247, v[160:163] offset:34816
    ds_write_b128 v247, v[164:167] offset:35840
    v_mov_b32 v250, 5
    ds_write_b32 v246, v250
    s_mov_b32 s46, 131072
    buffer_load_dwordx4 v[24:27], v10, s[28:31], s46 offen offset:0 nt
    buffer_load_dwordx4 v[28:31], v11, s[28:31], s46 offen offset:1024 nt
    buffer_load_dwordx4 v[32:35], v12, s[28:31], s46 offen offset:2048 nt
    buffer_load_dwordx4 v[36:39], v13, s[28:31], s46 offen offset:3072 nt
    s_waitcnt vmcnt(12)
    v_mov_b32 v2, 1
    v_mov_b32 v5, 4
    s_lshl_b32 s46, s42, 4
    s_mov_b64 exec, 1
    buffer_atomic_add v2, v5, s[68:71], s46 offen sc1
    s_mov_b64 exec, -1
    s_mov_b32 s46, 4
    s_call_b64 s[90:91], K1_FC
    ds_write_b128 v248, v[168:171] offset:32768
    ds_write_b128 v248, v[172:175] offset:33792
    ds_write_b128 v248, v[176:179] offset:34816
    ds_write_b128 v248, v[180:183] offset:35840
    s_mov_b32 s46, 131072
    buffer_load_dwordx4 v[40:43], v14, s[32:35], s46 offen offset:0 nt
    buffer_load_dwordx4 v[44:47], v9, s[32:35], s46 offen offset:1024 nt
    buffer_load_dwordx4 v[48:51], v14, s[32:35], s46 offen offset:2048 nt
    buffer_load_dwordx4 v[52:55], v9, s[32:35], s46 offen offset:3072 nt
    s_mov_b32 s46, 147456
    buffer_load_dwordx4 v[56:59], v10, s[28:31], s46 offen offset:0 nt
    buffer_load_dwordx4 v[60:63], v11, s[28:31], s46 offen offset:1024 nt
    buffer_load_dwordx4 v[64:67], v12, s[28:31], s46 offen offset:2048 nt
    buffer_load_dwordx4 v[68:71], v13, s[28:31], s46 offen offset:3072 nt
    s_and_b32 s46, s42, 3
    s_lshl_b32 s46, s46, 3
    s_add_u32 s46, s46, s57
    s_lshl_b32 s62, s56, 5
    s_add_u32 s46, s46, s62
    s_mul_i32 s46, s46, 40960
    s_add_u32 s46, s46, 24576
    v_lshlrev_b32 v19, 7, v255
    buffer_load_dword v18, v19, s[64:67], s46 offen
    s_mov_b32 s46, 5
    s_call_b64 s[90:91], K1_FC
    s_waitcnt vmcnt(18)
    ds_write_b128 v247, v[184:187] offset:49152
    ds_write_b128 v247, v[188:191] offset:50176
    ds_write_b128 v247, v[192:195] offset:51200
    ds_write_b128 v247, v[196:199] offset:52224
    v_mov_b32 v250, 6
    ds_write_b32 v246, v250
    s_mov_b32 s46, 147456
    buffer_load_dwordx4 v[72:75], v14, s[32:35], s46 offen offset:0 nt
    buffer_load_dwordx4 v[76:79], v9, s[32:35], s46 offen offset:1024 nt
    buffer_load_dwordx4 v[80:83], v14, s[32:35], s46 offen offset:2048 nt
    buffer_load_dwordx4 v[84:87], v9, s[32:35], s46 offen offset:3072 nt
    s_mov_b32 s46, 6
    s_call_b64 s[90:91], K1_FC
    s_waitcnt vmcnt(18)
    ds_write_b128 v248, v[200:203] offset:49152
    ds_write_b128 v248, v[204:207] offset:50176
    ds_write_b128 v248, v[208:211] offset:51200
    ds_write_b128 v248, v[212:215] offset:52224
    s_waitcnt vmcnt(14)
    ds_write_b128 v247, v[24:27] offset:0
    ds_write_b128 v247, v[28:31] offset:1024
    ds_write_b128 v247, v[32:35] offset:2048
    ds_write_b128 v247, v[36:39] offset:3072
    v_mov_b32 v250, 7
    ds_write_b32 v246, v250
    s_mov_b32 s46, 163840
    s_add_u32 m0, s45, 32768
    s_nop 0
    buffer_load_dwordx4 v10, s[28:31], s46 offen offset:0 nt lds
    buffer_load_dwordx4 v11, s[28:31], s46 offen offset:1024 nt lds
    buffer_load_dwordx4 v12, s[28:31], s46 offen offset:2048 nt lds
    buffer_load_dwordx4 v13, s[28:31], s46 offen offset:3072 nt lds
    s_lshl_b32 s46, s42, 4
    buffer_load_dword v4, v5, s[68:71], s46 offen sc0 sc1
    s_mov_b32 s46, 7
    s_call_b64 s[90:91], K1_FC
    s_waitcnt vmcnt(14)
    ds_write_b128 v248, v[40:43] offset:0
    ds_write_b128 v248, v[44:47] offset:1024
    ds_write_b128 v248, v[48:51] offset:2048
    ds_write_b128 v248, v[52:55] offset:3072
    s_waitcnt vmcnt(10)
    ds_write_b128 v247, v[56:59] offset:16384
    ds_write_b128 v247, v[60:63] offset:17408
    ds_write_b128 v247, v[64:67] offset:18432
    ds_write_b128 v247, v[68:71] offset:19456
    v_mov_b32 v250, 8
    ds_write_b32 v246, v250
    s_mov_b32 s46, 163840
    s_add_u32 m0, s45, 98304
    s_nop 0
    buffer_load_dwordx4 v14, s[32:35], s46 offen offset:0 nt lds
    buffer_load_dwordx4 v9, s[32:35], s46 offen offset:1024 nt lds
    buffer_load_dwordx4 v14, s[32:35], s46 offen offset:2048 nt lds
    buffer_load_dwordx4 v9, s[32:35], s46 offen offset:3072 nt lds
    s_mov_b32 s46, 180224
    s_add_u32 m0, s45, 49152
    s_nop 0
    buffer_load_dwordx4 v10, s[28:31], s46 offen offset:0 nt lds
    buffer_load_dwordx4 v11, s[28:31], s46 offen offset:1024 nt lds
    buffer_load_dwordx4 v12, s[28:31], s46 offen offset:2048 nt lds
    buffer_load_dwordx4 v13, s[28:31], s46 offen offset:3072 nt lds
    s_mov_b32 s46, 8
    s_call_b64 s[90:91], K1_FC
    s_waitcnt vmcnt(13)
    ds_write_b128 v248, v[72:75] offset:16384
    ds_write_b128 v248, v[76:79] offset:17408
    ds_write_b128 v248, v[80:83] offset:18432
    ds_write_b128 v248, v[84:87] offset:19456
    s_mov_b32 s46, 180224
    s_add_u32 m0, s45, 114688
    s_nop 0
    buffer_load_dwordx4 v14, s[32:35], s46 offen offset:0 nt lds
    buffer_load_dwordx4 v9, s[32:35], s46 offen offset:1024 nt lds
    buffer_load_dwordx4 v14, s[32:35], s46 offen offset:2048 nt lds
    buffer_load_dwordx4 v9, s[32:35], s46 offen offset:3072 nt lds
    s_waitcnt vmcnt(13)
    v_mov_b32 v250, 9
    ds_write_b32 v246, v250
    s_mov_b32 s46, 196608
    s_add_u32 m0, s45, 0
    s_nop 0
    buffer_load_dwordx4 v10, s[28:31], s46 offen offset:0 nt lds
    buffer_load_dwordx4 v11, s[28:31], s46 offen offset:1024 nt lds
    buffer_load_dwordx4 v12, s[28:31], s46 offen offset:2048 nt lds
    buffer_load_dwordx4 v13, s[28:31], s46 offen offset:3072 nt lds
    s_waitcnt vmcnt(8)
    v_mov_b32 v250, 10
    ds_write_b32 v246, v250
    s_xor_b32 s46, s7, 27
    s_mul_i32 s46, s46, 40960
    s_add_u32 s46, s46, s63
    s_mov_b32 m0, 138240
    s_nop 0
    buffer_load_dwordx4 v235, s[64:67], s46 offen lds
    s_xor_b32 s46, s7, 27
    s_mul_i32 s46, s46, 40960
    s_add_u32 s46, s46, s63
    s_mov_b32 m0, 142336
    s_nop 0
    buffer_load_dwordx4 v239, s[64:67], s46 offen lds
    s_xor_b32 s46, s7, 28
    s_mul_i32 s46, s46, 40960
    s_add_u32 s46, s46, s63
    s_mov_b32 m0, 146432
    s_nop 0
    buffer_load_dwordx4 v238, s[64:67], s46 offen lds
    s_mov_b32 s46, 9
    s_call_b64 s[90:91], K1_FC
    s_mov_b32 s46, 196608
    s_add_u32 m0, s45, 65536
    s_nop 0
    buffer_load_dwordx4 v14, s[32:35], s46 offen offset:0 nt lds
    buffer_load_dwordx4 v9, s[32:35], s46 offen offset:1024 nt lds
    buffer_load_dwordx4 v14, s[32:35], s46 offen offset:2048 nt lds
    buffer_load_dwordx4 v9, s[32:35], s46 offen offset:3072 nt lds
    s_mov_b32 s46, 212992
    s_add_u32 m0, s45, 16384
    s_nop 0
    buffer_load_dwordx4 v10, s[28:31], s46 offen offset:0 nt lds
    buffer_load_dwordx4 v11, s[28:31], s46 offen offset:1024 nt lds
    buffer_load_dwordx4 v12, s[28:31], s46 offen offset:2048 nt lds
    buffer_load_dwordx4 v13, s[28:31], s46 offen offset:3072 nt lds
    s_waitcnt vmcnt(11)
    v_mov_b32 v250, 11
    ds_write_b32 v246, v250
    s_mov_b32 s46, 10
    s_call_b64 s[90:91], K1_FC
    s_mov_b32 s46, 212992
    s_add_u32 m0, s45, 81920
    s_nop 0
    buffer_load_dwordx4 v14, s[32:35], s46 offen offset:0 nt lds
    buffer_load_dwordx4 v9, s[32:35], s46 offen offset:1024 nt lds
    buffer_load_dwordx4 v14, s[32:35], s46 offen offset:2048 nt lds
    buffer_load_dwordx4 v9, s[32:35], s46 offen offset:3072 nt lds
    s_mov_b32 s46, 229376
    s_add_u32 m0, s45, 32768
    s_nop 0
    buffer_load_dwordx4 v10, s[28:31], s46 offen offset:0 nt lds
    buffer_load_dwordx4 v11, s[28:31], s46 offen offset:1024 nt lds
    buffer_load_dwordx4 v12, s[28:31], s46 offen offset:2048 nt lds
    buffer_load_dwordx4 v13, s[28:31], s46 offen offset:3072 nt lds
    s_waitcnt vmcnt(8)
    v_mov_b32 v250, 12
    ds_write_b32 v246, v250
    s_xor_b32 s46, s7, 31
    s_mul_i32 s46, s46, 40960
    s_add_u32 s46, s46, s63
    s_mov_b32 m0, 159744
    s_nop 0
    buffer_load_dwordx4 v236, s[64:67], s46 offen lds
    s_xor_b32 s46, s7, 31
    s_mul_i32 s46, s46, 40960
    s_add_u32 s46, s46, s63
    s_mov_b32 m0, 160768
    s_nop 0
    buffer_load_dwordx4 v237, s[64:67], s46 offen lds
    s_xor_b32 s46, s7, 31
    s_mul_i32 s46, s46, 40960
    s_add_u32 s46, s46, s63
    s_mov_b32 m0, 161792
    s_nop 0
    buffer_load_dwordx4 v238, s[64:67], s46 offen lds
    s_xor_b32 s46, s7, 31
    s_mul_i32 s46, s46, 40960
    s_add_u32 s46, s46, s63
    s_mov_b32 m0, 162816
    s_nop 0
    buffer_load_dwordx4 v239, s[64:67], s46 offen lds
    s_xor_b32 s46, s7, 26
    s_mul_i32 s46, s46, 40960
    s_add_u32 s46, s46, s63
    buffer_load_dwordx4 v[20:23], v236, s[64:67], s46 offen
    v_lshlrev_b32 v17, 4, v255
    v_add_u32 v17, 134144, v17
    s_lshl_b32 s46, s42, 4
    s_mov_b32 s62, 0
K1_POLL0L:
    v_cmp_le_u32 vcc, 32, v4
    s_add_u32 s62, s62, 1
    s_cmp_gt_u32 s62, 400000
    s_cbranch_scc1 K1_POLL0L_DONE
    s_cmp_eq_u64 vcc, -1
    s_cbranch_scc1 K1_POLL0L_DONE
    buffer_load_dword v4, v5, s[68:71], s46 offen sc0 sc1
    s_waitcnt vmcnt(0)
    s_branch K1_POLL0L
K1_POLL0L_DONE:
    s_mov_b32 s46, 11
    s_call_b64 s[90:91], K1_FC
    s_mov_b32 s46, 229376
    s_add_u32 m0, s45, 98304
    s_nop 0
    buffer_load_dwordx4 v14, s[32:35], s46 offen offset:0 nt lds
    buffer_load_dwordx4 v9, s[32:35], s46 offen offset:1024 nt lds
    buffer_load_dwordx4 v14, s[32:35], s46 offen offset:2048 nt lds
    buffer_load_dwordx4 v9, s[32:35], s46 offen offset:3072 nt lds
    s_waitcnt vmcnt(9)
    v_mov_b32 v250, 13
    ds_write_b32 v246, v250
    s_mov_b32 s46, 245760
    s_add_u32 m0, s45, 49152
    s_nop 0
    buffer_load_dwordx4 v10, s[28:31], s46 offen offset:0 nt lds
    buffer_load_dwordx4 v11, s[28:31], s46 offen offset:1024 nt lds
    buffer_load_dwordx4 v12, s[28:31], s46 offen offset:2048 nt lds
    buffer_load_dwordx4 v13, s[28:31], s46 offen offset:3072 nt lds
    s_mov_b32 s46, 12
    s_call_b64 s[90:91], K1_FC
    s_mov_b32 s46, 245760
    s_add_u32 m0, s45, 114688
    s_nop 0
    buffer_load_dwordx4 v14, s[32:35], s46 offen offset:0 nt lds
    buffer_load_dwordx4 v9, s[32:35], s46 offen offset:1024 nt lds
    buffer_load_dwordx4 v14, s[32:35], s46 offen offset:2048 nt lds
    buffer_load_dwordx4 v9, s[32:35], s46 offen offset:3072 nt lds
    s_waitcnt vmcnt(4)
    v_mov_b32 v250, 14
    ds_write_b32 v246, v250
    s_mov_b32 s46, 13
    s_call_b64 s[90:91], K1_FC
    s_xor_b32 s46, s7, 2
    s_mul_i32 s46, s46, 40960
    s_add_u32 s46, s46, s63
    s_mov_b32 m0, 12288
    s_nop 0
    buffer_load_dwordx4 v237, s[64:67], s46 offen lds
    s_xor_b32 s46, s7, 2
    s_mul_i32 s46, s46, 40960
    s_add_u32 s46, s46, s63
    s_mov_b32 m0, 13312
    s_nop 0
    buffer_load_dwordx4 v238, s[64:67], s46 offen lds
    s_xor_b32 s46, s7, 2
    s_mul_i32 s46, s46, 40960
    s_add_u32 s46, s46, s63
    s_mov_b32 m0, 14336
    s_nop 0
    buffer_load_dwordx4 v239, s[64:67], s46 offen lds
    s_xor_b32 s46, s7, 3
    s_mul_i32 s46, s46, 40960
    s_add_u32 s46, s46, s63
    s_mov_b32 m0, 15360
    s_nop 0
    buffer_load_dwordx4 v235, s[64:67], s46 offen lds
    s_xor_b32 s46, s7, 5
    s_mul_i32 s46, s46, 40960
    s_add_u32 s46, s46, s63
    s_mov_b32 m0, 28672
    s_nop 0
    buffer_load_dwordx4 v238, s[64:67], s46 offen lds
    s_xor_b32 s46, s7, 5
    s_mul_i32 s46, s46, 40960
    s_add_u32 s46, s46, s63
    s_mov_b32 m0, 29696
    s_nop 0
    buffer_load_dwordx4 v239, s[64:67], s46 offen lds
    s_xor_b32 s46, s7, 6
    s_mul_i32 s46, s46, 40960
    s_add_u32 s46, s46, s63
    s_mov_b32 m0, 30720
    s_nop 0
    buffer_load_dwordx4 v235, s[64:67], s46 offen lds
    s_xor_b32 s46, s7, 6
    s_mul_i32 s46, s46, 40960
    s_add_u32 s46, s46, s63
    s_mov_b32 m0, 31744
    s_nop 0
    buffer_load_dwordx4 v236, s[64:67], s46 offen lds
    s_waitcnt vmcnt(8)
    v_mov_b32 v250, 15
    ds_write_b32 v246, v250
    s_xor_b32 s46, s7, 15
    s_mul_i32 s46, s46, 40960
    s_add_u32 s46, s46, s63
    s_mov_b32 m0, 77824
    s_nop 0
    buffer_load_dwordx4 v236, s[64:67], s46 offen lds
    s_xor_b32 s46, s7, 15
    s_mul_i32 s46, s46, 40960
    s_add_u32 s46, s46, s63
    s_mov_b32 m0, 78848
    s_nop 0
    buffer_load_dwordx4 v237, s[64:67], s46 offen lds
    s_xor_b32 s46, s7, 15
    s_mul_i32 s46, s46, 40960
    s_add_u32 s46, s46, s63
    s_mov_b32 m0, 79872
    s_nop 0
    buffer_load_dwordx4 v238, s[64:67], s46 offen lds
    s_xor_b32 s46, s7, 15
    s_mul_i32 s46, s46, 40960
    s_add_u32 s46, s46, s63
    s_mov_b32 m0, 80896
    s_nop 0
    buffer_load_dwordx4 v239, s[64:67], s46 offen lds
    s_mov_b32 s46, 14
    s_call_b64 s[90:91], K1_FC
    s_xor_b32 s46, s7, 8
    s_mul_i32 s46, s46, 40960
    s_add_u32 s46, s46, s63
    s_mov_b32 m0, 45056
    s_nop 0
    buffer_load_dwordx4 v239, s[64:67], s46 offen lds
    s_xor_b32 s46, s7, 9
    s_mul_i32 s46, s46, 40960
    s_add_u32 s46, s46, s63
    s_mov_b32 m0, 46080
    s_nop 0
    buffer_load_dwordx4 v235, s[64:67], s46 offen lds
    s_xor_b32 s46, s7, 9
    s_mul_i32 s46, s46, 40960
    s_add_u32 s46, s46, s63
    s_mov_b32 m0, 47104
    s_nop 0
    buffer_load_dwordx4 v236, s[64:67], s46 offen lds
    s_xor_b32 s46, s7, 9
    s_mul_i32 s46, s46, 40960
    s_add_u32 s46, s46, s63
    s_mov_b32 m0, 48128
    s_nop 0
    buffer_load_dwordx4 v237, s[64:67], s46 offen lds
    s_xor_b32 s46, s7, 18
    s_mul_i32 s46, s46, 40960
    s_add_u32 s46, s46, s63
    s_mov_b32 m0, 94208
    s_nop 0
    buffer_load_dwordx4 v237, s[64:67], s46 offen lds
    s_xor_b32 s46, s7, 18
    s_mul_i32 s46, s46, 40960
    s_add_u32 s46, s46, s63
    s_mov_b32 m0, 95232
    s_nop 0
    buffer_load_dwordx4 v238, s[64:67], s46 offen lds
    s_xor_b32 s46, s7, 18
    s_mul_i32 s46, s46, 40960
    s_add_u32 s46, s46, s63
    s_mov_b32 m0, 96256
    s_nop 0
    buffer_load_dwordx4 v239, s[64:67], s46 offen lds
    s_xor_b32 s46, s7, 19
    s_mul_i32 s46, s46, 40960
    s_add_u32 s46, s46, s63
    s_mov_b32 m0, 97280
    s_nop 0
    buffer_load_dwordx4 v235, s[64:67], s46 offen lds
    s_xor_b32 s46, s7, 24
    s_mul_i32 s46, s46, 40960
    s_add_u32 s46, s46, s63
    buffer_load_dwordx4 v[88:91], v239, s[64:67], s46 offen
    s_xor_b32 s46, s7, 25
    s_mul_i32 s46, s46, 40960
    s_add_u32 s46, s46, s63
    buffer_load_dwordx4 v[92:95], v235, s[64:67], s46 offen
    s_xor_b32 s46, s7, 25
    s_mul_i32 s46, s46, 40960
    s_add_u32 s46, s46, s63
    buffer_load_dwordx4 v[96:99], v236, s[64:67], s46 offen
    s_xor_b32 s46, s7, 25
    s_mul_i32 s46, s46, 40960
    s_add_u32 s46, s46, s63
    buffer_load_dwordx4 v[100:103], v237, s[64:67], s46 offen
    s_mov_b32 s46, 15
    s_call_b64 s[90:91], K1_FC
    s_xor_b32 s46, s7, 12
    s_mul_i32 s46, s46, 40960
    s_add_u32 s46, s46, s63
    s_mov_b32 m0, 61440
    s_nop 0
    buffer_load_dwordx4 v235, s[64:67], s46 offen lds
    s_xor_b32 s46, s7, 12
    s_mul_i32 s46, s46, 40960
    s_add_u32 s46, s46, s63
    s_mov_b32 m0, 62464
    s_nop 0
    buffer_load_dwordx4 v236, s[64:67], s46 offen lds
    s_xor_b32 s46, s7, 12
    s_mul_i32 s46, s46, 40960
    s_add_u32 s46, s46, s63
    s_mov_b32 m0, 63488
    s_nop 0
    buffer_load_dwordx4 v237, s[64:67], s46 offen lds
    s_xor_b32 s46, s7, 12
    s_mul_i32 s46, s46, 40960
    s_add_u32 s46, s46, s63
    s_mov_b32 m0, 64512
    s_nop 0
    buffer_load_dwordx4 v238, s[64:67], s46 offen lds
    s_xor_b32 s46, s7, 21
    s_mul_i32 s46, s46, 40960
    s_add_u32 s46, s46, s63
    s_mov_b32 m0, 110592
    s_nop 0
    buffer_load_dwordx4 v238, s[64:67], s46 offen lds
    s_xor_b32 s46, s7, 21
    s_mul_i32 s46, s46, 40960
    s_add_u32 s46, s46, s63
    s_mov_b32 m0, 111616
    s_nop 0
    buffer_load_dwordx4 v239, s[64:67], s46 offen lds
    s_xor_b32 s46, s7, 22
    s_mul_i32 s46, s46, 40960
    s_add_u32 s46, s46, s63
    s_mov_b32 m0, 112640
    s_nop 0
    buffer_load_dwordx4 v235, s[64:67], s46 offen lds
    s_xor_b32 s46, s7, 22
    s_mul_i32 s46, s46, 40960
    s_add_u32 s46, s46, s63
    s_mov_b32 m0, 113664
    s_nop 0
    buffer_load_dwordx4 v236, s[64:67], s46 offen lds
    v_lshlrev_b32 v229, 4, v255
    s_lshl_b32 s46, s77, 17
    v_add_u32 v230, s46, v229
    v_xor_b32 v229, 0x20000, v230
    s_lshl_b32 s47, s42, 20
    s_lshl_b32 s46, s76, 18
    s_add_u32 s47, s47, s46
    s_lshl_b32 s46, s56, 15
    s_add_u32 s47, s47, s46
    s_lshl_b32 s46, s10, 14
    s_add_u32 s47, s47, s46
    s_mov_b32 s83, 0
    s_mov_b32 s85, 0
    s_mov_b32 s86, -1
    s_mov_b32 s8, 1
    v_lshrrev_b32 v231, 2, v255
    v_mul_u32_u24 v231, 160, v231
    v_and_b32 v232, 3, v255
    v_lshl_add_u32 v231, v232, 3, v231
    v_lshlrev_b32 v234, 13, v255
    v_and_b32 v228, 31, v255
    v_lshlrev_b32 v228, 7, v228
    v_lshrrev_b32 v227, 5, v255
    v_lshl_add_u32 v228, v227, 17, v228
    s_mov_b32 s4, 0
    s_mul_i32 s46, s10, 81920
    v_add_u32 v231, s46, v231
    s_mov_b32 s80, 0
    s_mov_b32 s81, 0
    s_mov_b32 s82, 0
    s_mov_b32 s84, 0
    s_mov_b32 s11, 0
    s_mov_b32 s49, 0
    s_mov_b32 s6, 0
    s_buffer_load_dword s12, s[36:39], s78 glc
    s_waitcnt vmcnt(8)
    s_mov_b32 s46, 16
    s_call_b64 s[90:91], K1_FC
    ds_write_b128 v17, v[20:23]
    ds_write_b128 v248, v[88:91] offset:49152
    ds_write_b128 v248, v[92:95] offset:50176
    ds_write_b128 v248, v[96:99] offset:51200
    ds_write_b128 v248, v[100:103] offset:52224
    s_mov_b32 s5, 2
    s_waitcnt lgkmcnt(0)
    s_call_b64 s[90:91], K1_SVC
    s_mov_b32 s46, s85
    s_call_b64 s[90:91], K1_WV
    s_barrier
    s_setprio 1
K1_B0:
    s_cmp_eq_u32 s8, 0
    s_cbranch_scc1 K1_G0
    s_waitcnt lgkmcnt(0)
    s_call_b64 s[90:91], K1_SVF
K1_G0:
    s_min_u32 s5, s81, 2
    s_cmp_le_u32 s81, 0
    s_cbranch_scc1 K1_T0
    s_call_b64 s[90:91], K1_V5
K1_R0:
    s_cmp_lg_u32 s6, 0
    s_cbranch_scc1 K1_D0
    s_bfe_u32 s46, s80, 0x40000
    s_xor_b32 s46, s46, s4
    s_mul_i32 s46, s46, 20480
    v_add_u32 v232, s46, v231
    ds_read_b64_tr_b16 v[64:65], v232 offset:0
    ds_read_b64_tr_b16 v[66:67], v232 offset:2560
    ds_read_b64_tr_b16 v[68:69], v232 offset:32
    ds_read_b64_tr_b16 v[70:71], v232 offset:2592
    ds_read_b64_tr_b16 v[72:73], v232 offset:64
    ds_read_b64_tr_b16 v[74:75], v232 offset:2624
    ds_read_b64_tr_b16 v[76:77], v232 offset:96
    ds_read_b64_tr_b16 v[78:79], v232 offset:2656
    ds_read_b64_tr_b16 v[80:81], v232 offset:128
    ds_read_b64_tr_b16 v[82:83], v232 offset:2688
K1_D0:
    s_cmp_le_u32 s82, 1
    s_cbranch_scc1 K1_Z0
    s_waitcnt vmcnt(8)
K1_C0:
    s_bfe_u32 s46, s80, 0x40004
    s_xor_b32 s46, s46, s4
    s_mul_i32 s46, s46, 20480
    s_cmp_gt_u32 s81, 1
    s_cselect_b32 s6, 1, 0
    ds_read_b64_tr_b16 v[40:41], v232 offset:5120
    ds_read_b64_tr_b16 v[42:43], v232 offset:7680
    ds_read_b64_tr_b16 v[44:45], v232 offset:5152
    ds_read_b64_tr_b16 v[46:47], v232 offset:7712
    s_waitcnt lgkmcnt(12)
    v_mfma_f32_16x16x32_bf16 v[0:3], v[64:67], v[96:99], 0
    v_mfma_f32_16x16x32_bf16 v[20:23], v[64:67], v[100:103], 0
    ds_read_b64_tr_b16 v[48:49], v232 offset:5184
    ds_read_b64_tr_b16 v[50:51], v232 offset:7744
    s_waitcnt lgkmcnt(12)
    v_mfma_f32_16x16x32_bf16 v[4:7], v[68:71], v[96:99], 0
    v_mfma_f32_16x16x32_bf16 v[24:27], v[68:71], v[100:103], 0
    ds_read_b64_tr_b16 v[52:53], v232 offset:5216
    ds_read_b64_tr_b16 v[54:55], v232 offset:7776
    s_waitcnt lgkmcnt(12)
    v_mfma_f32_16x16x32_bf16 v[8:11], v[72:75], v[96:99], 0
    v_mfma_f32_16x16x32_bf16 v[28:31], v[72:75], v[100:103], 0
    ds_read_b64_tr_b16 v[56:57], v232 offset:5248
    ds_read_b64_tr_b16 v[58:59], v232 offset:7808
    s_waitcnt lgkmcnt(12)
    v_mfma_f32_16x16x32_bf16 v[12:15], v[76:79], v[96:99], 0
    v_mfma_f32_16x16x32_bf16 v[32:35], v[76:79], v[100:103], 0
    s_waitcnt lgkmcnt(10)
    v_mfma_f32_16x16x32_bf16 v[16:19], v[80:83], v[96:99], 0
    v_mfma_f32_16x16x32_bf16 v[36:39], v[80:83], v[100:103], 0
    s_cmp_eq_u32 s11, 0
    s_cbranch_scc1 K1_PUBD
    s_mov_b32 s89, s46
    s_mov_b32 s46, s85
    s_call_b64 s[90:91], K1_WV
    s_mov_b64 exec, 0xff
    buffer_store_byte v233, v234, s[36:39], s13 offen sc0 sc1
    s_mov_b64 exec, -1
    s_add_u32 s85, s85, 1
    s_mov_b32 s46, s89
    s_mov_b32 s11, 0
    s_setprio 0
K1_PUBD:
    ds_read_b64_tr_b16 v[64:65], v232 offset:10240
    ds_read_b64_tr_b16 v[66:67], v232 offset:12800
    ds_read_b64_tr_b16 v[68:69], v232 offset:10272
    ds_read_b64_tr_b16 v[70:71], v232 offset:12832
    s_waitcnt lgkmcnt(12)
    v_mfma_f32_16x16x32_bf16 v[0:3], v[40:43], v[104:107], v[0:3]
    v_mfma_f32_16x16x32_bf16 v[20:23], v[40:43], v[108:111], v[20:23]
    ds_read_b64_tr_b16 v[72:73], v232 offset:10304
    ds_read_b64_tr_b16 v[74:75], v232 offset:12864
    s_waitcnt lgkmcnt(12)
    v_mfma_f32_16x16x32_bf16 v[4:7], v[44:47], v[104:107], v[4:7]
    v_mfma_f32_16x16x32_bf16 v[24:27], v[44:47], v[108:111], v[24:27]
    ds_read_b64_tr_b16 v[76:77], v232 offset:10336
    ds_read_b64_tr_b16 v[78:79], v232 offset:12896
    s_waitcnt lgkmcnt(12)
    v_mfma_f32_16x16x32_bf16 v[8:11], v[48:51], v[104:107], v[8:11]
    v_mfma_f32_16x16x32_bf16 v[28:31], v[48:51], v[108:111], v[28:31]
    ds_read_b64_tr_b16 v[80:81], v232 offset:10368
    ds_read_b64_tr_b16 v[82:83], v232 offset:12928
    s_waitcnt lgkmcnt(12)
    v_mfma_f32_16x16x32_bf16 v[12:15], v[52:55], v[104:107], v[12:15]
    v_mfma_f32_16x16x32_bf16 v[32:35], v[52:55], v[108:111], v[32:35]
    s_waitcnt lgkmcnt(10)
    v_mfma_f32_16x16x32_bf16 v[16:19], v[56:59], v[104:107], v[16:19]
    v_mfma_f32_16x16x32_bf16 v[36:39], v[56:59], v[108:111], v[36:39]
    ds_read_b64_tr_b16 v[40:41], v232 offset:15360
    ds_read_b64_tr_b16 v[42:43], v232 offset:17920
    ds_read_b64_tr_b16 v[44:45], v232 offset:15392
    ds_read_b64_tr_b16 v[46:47], v232 offset:17952
    s_waitcnt lgkmcnt(12)
    v_mfma_f32_16x16x32_bf16 v[0:3], v[64:67], v[112:115], v[0:3]
    v_mfma_f32_16x16x32_bf16 v[20:23], v[64:67], v[116:119], v[20:23]
    ds_read_b64_tr_b16 v[48:49], v232 offset:15424
    ds_read_b64_tr_b16 v[50:51], v232 offset:17984
    s_waitcnt lgkmcnt(12)
    v_mfma_f32_16x16x32_bf16 v[4:7], v[68:71], v[112:115], v[4:7]
    v_mfma_f32_16x16x32_bf16 v[24:27], v[68:71], v[116:119], v[24:27]
    ds_read_b64_tr_b16 v[52:53], v232 offset:15456
    ds_read_b64_tr_b16 v[54:55], v232 offset:18016
    s_waitcnt lgkmcnt(12)
    v_mfma_f32_16x16x32_bf16 v[8:11], v[72:75], v[112:115], v[8:11]
    v_mfma_f32_16x16x32_bf16 v[28:31], v[72:75], v[116:119], v[28:31]
    ds_read_b64_tr_b16 v[56:57], v232 offset:15488
    ds_read_b64_tr_b16 v[58:59], v232 offset:18048
    s_waitcnt lgkmcnt(12)
    v_mfma_f32_16x16x32_bf16 v[12:15], v[76:79], v[112:115], v[12:15]
    v_mfma_f32_16x16x32_bf16 v[32:35], v[76:79], v[116:119], v[32:35]
    s_waitcnt lgkmcnt(10)
    v_mfma_f32_16x16x32_bf16 v[16:19], v[80:83], v[112:115], v[16:19]
    v_mfma_f32_16x16x32_bf16 v[36:39], v[80:83], v[116:119], v[36:39]
    v_add_u32 v232, s46, v231
    ds_read_b64_tr_b16 v[64:65], v232 offset:0
    ds_read_b64_tr_b16 v[66:67], v232 offset:2560
    ds_read_b64_tr_b16 v[68:69], v232 offset:32
    ds_read_b64_tr_b16 v[70:71], v232 offset:2592
    s_waitcnt lgkmcnt(12)
    v_mfma_f32_16x16x32_bf16 v[0:3], v[40:43], v[120:123], v[0:3]
    v_mfma_f32_16x16x32_bf16 v[20:23], v[40:43], v[124:127], v[20:23]
    ds_read_b64_tr_b16 v[72:73], v232 offset:64
    ds_read_b64_tr_b16 v[74:75], v232 offset:2624
    s_waitcnt lgkmcnt(12)
    v_mfma_f32_16x16x32_bf16 v[4:7], v[44:47], v[120:123], v[4:7]
    v_mfma_f32_16x16x32_bf16 v[24:27], v[44:47], v[124:127], v[24:27]
    ds_read_b64_tr_b16 v[76:77], v232 offset:96
    ds_read_b64_tr_b16 v[78:79], v232 offset:2656
    s_waitcnt lgkmcnt(12)
    v_mfma_f32_16x16x32_bf16 v[8:11], v[48:51], v[120:123], v[8:11]
    v_mfma_f32_16x16x32_bf16 v[28:31], v[48:51], v[124:127], v[28:31]
    ds_read_b64_tr_b16 v[80:81], v232 offset:128
    ds_read_b64_tr_b16 v[82:83], v232 offset:2688
    s_waitcnt lgkmcnt(12)
    v_mfma_f32_16x16x32_bf16 v[12:15], v[52:55], v[120:123], v[12:15]
    v_mfma_f32_16x16x32_bf16 v[32:35], v[52:55], v[124:127], v[32:35]
    s_waitcnt lgkmcnt(10)
    v_mfma_f32_16x16x32_bf16 v[16:19], v[56:59], v[120:123], v[16:19]
    v_mfma_f32_16x16x32_bf16 v[36:39], v[56:59], v[124:127], v[36:39]
    s_cmp_eq_u32 s8, 0
    s_cbranch_scc1 K1_I1
    s_waitcnt lgkmcnt(0)
    s_call_b64 s[90:91], K1_SVF
K1_I1:
    s_cmp_lg_u32 s82, 2
    s_cbranch_scc1 K1_G1
    s_cmp_le_u32 s81, 2
    s_cbranch_scc1 K1_R1
    s_bfe_u32 s46, s80, 0x40008
    s_lshl_b32 s46, s46, 12
    s_add_u32 s46, s46, s47
    buffer_load_dwordx4 v[160:163], v230, s[36:39], s46 offen offset:0
    buffer_load_dwordx4 v[164:167], v229, s[36:39], s46 offen offset:0
    buffer_load_dwordx4 v[168:171], v230, s[36:39], s46 offen offset:1024
    buffer_load_dwordx4 v[172:175], v229, s[36:39], s46 offen offset:1024
    buffer_load_dwordx4 v[176:179], v230, s[36:39], s46 offen offset:2048
    buffer_load_dwordx4 v[180:183], v229, s[36:39], s46 offen offset:2048
    buffer_load_dwordx4 v[184:187], v230, s[36:39], s46 offen offset:3072
    buffer_load_dwordx4 v[188:191], v229, s[36:39], s46 offen offset:3072
    s_mov_b32 s82, 3
K1_R1:
    s_cmp_eq_u32 s6, 0
    s_cbranch_scc1 K1_N1
K1_D1:
    s_cmp_le_u32 s82, 2
    s_cbranch_scc1 K1_Z1
    s_waitcnt vmcnt(8)
K1_C1:
    s_bfe_u32 s46, s80, 0x40008
    s_xor_b32 s46, s46, s4
    s_mul_i32 s46, s46, 20480
    s_cmp_gt_u32 s81, 2
    s_cselect_b32 s6, 1, 0
    ds_read_b64_tr_b16 v[40:41], v232 offset:5120
    ds_read_b64_tr_b16 v[42:43], v232 offset:7680
    ds_read_b64_tr_b16 v[44:45], v232 offset:5152
    ds_read_b64_tr_b16 v[46:47], v232 offset:7712
    s_waitcnt lgkmcnt(12)
    v_mfma_f32_16x16x32_bf16 v[0:3], v[64:67], v[128:131], v[0:3]
    v_mfma_f32_16x16x32_bf16 v[20:23], v[64:67], v[132:135], v[20:23]
    ds_read_b64_tr_b16 v[48:49], v232 offset:5184
    ds_read_b64_tr_b16 v[50:51], v232 offset:7744
    s_waitcnt lgkmcnt(12)
    v_mfma_f32_16x16x32_bf16 v[4:7], v[68:71], v[128:131], v[4:7]
    v_mfma_f32_16x16x32_bf16 v[24:27], v[68:71], v[132:135], v[24:27]
    ds_read_b64_tr_b16 v[52:53], v232 offset:5216
    ds_read_b64_tr_b16 v[54:55], v232 offset:7776
    s_waitcnt lgkmcnt(12)
    v_mfma_f32_16x16x32_bf16 v[8:11], v[72:75], v[128:131], v[8:11]
    v_mfma_f32_16x16x32_bf16 v[28:31], v[72:75], v[132:135], v[28:31]
    ds_read_b64_tr_b16 v[56:57], v232 offset:5248
    ds_read_b64_tr_b16 v[58:59], v232 offset:7808
    s_waitcnt lgkmcnt(12)
    v_mfma_f32_16x16x32_bf16 v[12:15], v[76:79], v[128:131], v[12:15]
    v_mfma_f32_16x16x32_bf16 v[32:35], v[76:79], v[132:135], v[32:35]
    s_waitcnt lgkmcnt(10)
    v_mfma_f32_16x16x32_bf16 v[16:19], v[80:83], v[128:131], v[16:19]
    v_mfma_f32_16x16x32_bf16 v[36:39], v[80:83], v[132:135], v[36:39]
    ds_read_b64_tr_b16 v[64:65], v232 offset:10240
    ds_read_b64_tr_b16 v[66:67], v232 offset:12800
    ds_read_b64_tr_b16 v[68:69], v232 offset:10272
    ds_read_b64_tr_b16 v[70:71], v232 offset:12832
    s_waitcnt lgkmcnt(12)
    v_mfma_f32_16x16x32_bf16 v[0:3], v[40:43], v[136:139], v[0:3]
    v_mfma_f32_16x16x32_bf16 v[20:23], v[40:43], v[140:143], v[20:23]
    ds_read_b64_tr_b16 v[72:73], v232 offset:10304
    ds_read_b64_tr_b16 v[74:75], v232 offset:12864
    s_waitcnt lgkmcnt(12)
    v_mfma_f32_16x16x32_bf16 v[4:7], v[44:47], v[136:139], v[4:7]
    v_mfma_f32_16x16x32_bf16 v[24:27], v[44:47], v[140:143], v[24:27]
    ds_read_b64_tr_b16 v[76:77], v232 offset:10336
    ds_read_b64_tr_b16 v[78:79], v232 offset:12896
    s_waitcnt lgkmcnt(12)
    v_mfma_f32_16x16x32_bf16 v[8:11], v[48:51], v[136:139], v[8:11]
    v_mfma_f32_16x16x32_bf16 v[28:31], v[48:51], v[140:143], v[28:31]
    ds_read_b64_tr_b16 v[80:81], v232 offset:10368
    ds_read_b64_tr_b16 v[82:83], v232 offset:12928
    s_waitcnt lgkmcnt(12)
    v_mfma_f32_16x16x32_bf16 v[12:15], v[52:55], v[136:139], v[12:15]
    v_mfma_f32_16x16x32_bf16 v[32:35], v[52:55], v[140:143], v[32:35]
    s_waitcnt lgkmcnt(10)
    v_mfma_f32_16x16x32_bf16 v[16:19], v[56:59], v[136:139], v[16:19]
    v_mfma_f32_16x16x32_bf16 v[36:39], v[56:59], v[140:143], v[36:39]
    ds_read_b64_tr_b16 v[40:41], v232 offset:15360
    ds_read_b64_tr_b16 v[42:43], v232 offset:17920
    ds_read_b64_tr_b16 v[44:45], v232 offset:15392
    ds_read_b64_tr_b16 v[46:47], v232 offset:17952
    s_waitcnt lgkmcnt(12)
    v_mfma_f32_16x16x32_bf16 v[0:3], v[64:67], v[144:147], v[0:3]
    v_mfma_f32_16x16x32_bf16 v[20:23], v[64:67], v[148:151], v[20:23]
    ds_read_b64_tr_b16 v[48:49], v232 offset:15424
    ds_read_b64_tr_b16 v[50:51], v232 offset:17984
    s_waitcnt lgkmcnt(12)
    v_mfma_f32_16x16x32_bf16 v[4:7], v[68:71], v[144:147], v[4:7]
    v_mfma_f32_16x16x32_bf16 v[24:27], v[68:71], v[148:151], v[24:27]
    ds_read_b64_tr_b16 v[52:53], v232 offset:15456
    ds_read_b64_tr_b16 v[54:55], v232 offset:18016
    s_waitcnt lgkmcnt(12)
    v_mfma_f32_16x16x32_bf16 v[8:11], v[72:75], v[144:147], v[8:11]
    v_mfma_f32_16x16x32_bf16 v[28:31], v[72:75], v[148:151], v[28:31]
    ds_read_b64_tr_b16 v[56:57], v232 offset:15488
    ds_read_b64_tr_b16 v[58:59], v232 offset:18048
    s_waitcnt lgkmcnt(12)
    v_mfma_f32_16x16x32_bf16 v[12:15], v[76:79], v[144:147], v[12:15]
    v_mfma_f32_16x16x32_bf16 v[32:35], v[76:79], v[148:151], v[32:35]
    s_waitcnt lgkmcnt(10)
    v_mfma_f32_16x16x32_bf16 v[16:19], v[80:83], v[144:147], v[16:19]
    v_mfma_f32_16x16x32_bf16 v[36:39], v[80:83], v[148:151], v[36:39]
    v_add_u32 v232, s46, v231
    ds_read_b64_tr_b16 v[64:65], v232 offset:0
    ds_read_b64_tr_b16 v[66:67], v232 offset:2560
    ds_read_b64_tr_b16 v[68:69], v232 offset:32
    ds_read_b64_tr_b16 v[70:71], v232 offset:2592
    s_waitcnt lgkmcnt(12)
    v_mfma_f32_16x16x32_bf16 v[0:3], v[40:43], v[152:155], v[0:3]
    v_mfma_f32_16x16x32_bf16 v[20:23], v[40:43], v[156:159], v[20:23]
    ds_read_b64_tr_b16 v[72:73], v232 offset:64
    ds_read_b64_tr_b16 v[74:75], v232 offset:2624
    s_waitcnt lgkmcnt(12)
    v_mfma_f32_16x16x32_bf16 v[4:7], v[44:47], v[152:155], v[4:7]
    v_mfma_f32_16x16x32_bf16 v[24:27], v[44:47], v[156:159], v[24:27]
    ds_read_b64_tr_b16 v[76:77], v232 offset:96
    ds_read_b64_tr_b16 v[78:79], v232 offset:2656
    s_waitcnt lgkmcnt(12)
    v_mfma_f32_16x16x32_bf16 v[8:11], v[48:51], v[152:155], v[8:11]
    v_mfma_f32_16x16x32_bf16 v[28:31], v[48:51], v[156:159], v[28:31]
    ds_read_b64_tr_b16 v[80:81], v232 offset:128
    ds_read_b64_tr_b16 v[82:83], v232 offset:2688
    s_waitcnt lgkmcnt(12)
    v_mfma_f32_16x16x32_bf16 v[12:15], v[52:55], v[152:155], v[12:15]
    v_mfma_f32_16x16x32_bf16 v[32:35], v[52:55], v[156:159], v[32:35]
    s_waitcnt lgkmcnt(10)
    v_mfma_f32_16x16x32_bf16 v[16:19], v[56:59], v[152:155], v[16:19]
    v_mfma_f32_16x16x32_bf16 v[36:39], v[56:59], v[156:159], v[36:39]
    s_cmp_eq_u32 s8, 0
    s_cbranch_scc1 K1_I2
    s_waitcnt lgkmcnt(0)
    s_call_b64 s[90:91], K1_SVF
K1_I2:
    s_cmp_lg_u32 s82, 3
    s_cbranch_scc1 K1_G2
    s_cmp_le_u32 s81, 3
    s_cbranch_scc1 K1_R2
    s_bfe_u32 s46, s80, 0x4000c
    s_lshl_b32 s46, s46, 12
    s_add_u32 s46, s46, s47
    buffer_load_dwordx4 v[192:195], v230, s[36:39], s46 offen offset:0
    buffer_load_dwordx4 v[196:199], v229, s[36:39], s46 offen offset:0
    buffer_load_dwordx4 v[200:203], v230, s[36:39], s46 offen offset:1024
    buffer_load_dwordx4 v[204:207], v229, s[36:39], s46 offen offset:1024
    buffer_load_dwordx4 v[208:211], v230, s[36:39], s46 offen offset:2048
    buffer_load_dwordx4 v[212:215], v229, s[36:39], s46 offen offset:2048
    buffer_load_dwordx4 v[216:219], v230, s[36:39], s46 offen offset:3072
    buffer_load_dwordx4 v[220:223], v229, s[36:39], s46 offen offset:3072
    s_mov_b32 s82, 4
K1_R2:
    s_cmp_eq_u32 s6, 0
    s_cbranch_scc1 K1_N2
K1_D2:
    s_cmp_le_u32 s82, 3
    s_cbranch_scc1 K1_Z2
    s_waitcnt vmcnt(8)
K1_C2:
    s_bfe_u32 s46, s80, 0x4000c
    s_xor_b32 s46, s46, s4
    s_mul_i32 s46, s46, 20480
    s_cmp_gt_u32 s81, 3
    s_cselect_b32 s6, 1, 0
    ds_read_b64_tr_b16 v[40:41], v232 offset:5120
    ds_read_b64_tr_b16 v[42:43], v232 offset:7680
    ds_read_b64_tr_b16 v[44:45], v232 offset:5152
    ds_read_b64_tr_b16 v[46:47], v232 offset:7712
    s_waitcnt lgkmcnt(12)
    v_mfma_f32_16x16x32_bf16 v[0:3], v[64:67], v[160:163], v[0:3]
    v_mfma_f32_16x16x32_bf16 v[20:23], v[64:67], v[164:167], v[20:23]
    ds_read_b64_tr_b16 v[48:49], v232 offset:5184
    ds_read_b64_tr_b16 v[50:51], v232 offset:7744
    s_lshl_b32 s44, s42, 3
    s_add_u32 s44, s44, s57
    s_mul_i32 s16, s44, 163840
    s_waitcnt lgkmcnt(12)
    v_mfma_f32_16x16x32_bf16 v[4:7], v[68:71], v[160:163], v[4:7]
    v_mfma_f32_16x16x32_bf16 v[24:27], v[68:71], v[164:167], v[24:27]
    ds_read_b64_tr_b16 v[52:53], v232 offset:5216
    ds_read_b64_tr_b16 v[54:55], v232 offset:7776
    s_add_u32 s16, s16, 33554432
    s_lshl_b32 s44, s76, 1
    s_add_u32 s44, s44, s77
    s_waitcnt lgkmcnt(12)
    v_mfma_f32_16x16x32_bf16 v[8:11], v[72:75], v[160:163], v[8:11]
    v_mfma_f32_16x16x32_bf16 v[28:31], v[72:75], v[164:167], v[28:31]
    ds_read_b64_tr_b16 v[56:57], v232 offset:5248
    ds_read_b64_tr_b16 v[58:59], v232 offset:7808
    s_mul_i32 s45, s44, 5120
    s_add_u32 s16, s16, s45
    s_lshl_b32 s45, s42, 3
    s_waitcnt lgkmcnt(12)
    v_mfma_f32_16x16x32_bf16 v[12:15], v[76:79], v[160:163], v[12:15]
    v_mfma_f32_16x16x32_bf16 v[32:35], v[76:79], v[164:167], v[32:35]
    s_add_u32 s44, s44, s45
    s_mul_i32 s53, s44, 20480
    s_mul_i32 s44, s57, 160
    s_waitcnt lgkmcnt(10)
    v_mfma_f32_16x16x32_bf16 v[16:19], v[80:83], v[160:163], v[16:19]
    v_mfma_f32_16x16x32_bf16 v[36:39], v[80:83], v[164:167], v[36:39]
    s_add_u32 s53, s53, s44
    s_mul_i32 s44, s56, 40960
    s_add_u32 s52, s16, s44
    ds_read_b64_tr_b16 v[64:65], v232 offset:10240
    ds_read_b64_tr_b16 v[66:67], v232 offset:12800
    ds_read_b64_tr_b16 v[68:69], v232 offset:10272
    ds_read_b64_tr_b16 v[70:71], v232 offset:12832
    s_waitcnt lgkmcnt(12)
    v_mfma_f32_16x16x32_bf16 v[0:3], v[40:43], v[168:171], v[0:3]
    v_mfma_f32_16x16x32_bf16 v[20:23], v[40:43], v[172:175], v[20:23]
    ds_read_b64_tr_b16 v[72:73], v232 offset:10304
    ds_read_b64_tr_b16 v[74:75], v232 offset:12864
    s_lshl_b32 s14, s42, 5
    s_lshl_b32 s44, s76, 3
    s_add_u32 s14, s14, s44
    s_waitcnt lgkmcnt(12)
    v_mfma_f32_16x16x32_bf16 v[4:7], v[44:47], v[168:171], v[4:7]
    v_mfma_f32_16x16x32_bf16 v[24:27], v[44:47], v[172:175], v[24:27]
    ds_read_b64_tr_b16 v[76:77], v232 offset:10336
    ds_read_b64_tr_b16 v[78:79], v232 offset:12896
    s_add_u32 s14, s14, s57
    s_lshl_b32 s14, s14, 13
    s_lshl_b32 s44, s77, 9
    s_waitcnt lgkmcnt(12)
    v_mfma_f32_16x16x32_bf16 v[8:11], v[48:51], v[168:171], v[8:11]
    v_mfma_f32_16x16x32_bf16 v[28:31], v[48:51], v[172:175], v[28:31]
    ds_read_b64_tr_b16 v[80:81], v232 offset:10368
    ds_read_b64_tr_b16 v[82:83], v232 offset:12928
    s_add_u32 s14, s14, s44
    s_add_u32 s14, s14, 25169920
    s_add_u32 s55, s14, s56
    s_waitcnt lgkmcnt(12)
    v_mfma_f32_16x16x32_bf16 v[12:15], v[52:55], v[168:171], v[12:15]
    v_mfma_f32_16x16x32_bf16 v[32:35], v[52:55], v[172:175], v[32:35]
    s_lshl_b32 s44, s56, 3
    s_lshl_b32 s15, 1, s44
    s_add_u32 s44, s56, 1
    s_waitcnt lgkmcnt(10)
    v_mfma_f32_16x16x32_bf16 v[16:19], v[56:59], v[168:171], v[16:19]
    v_mfma_f32_16x16x32_bf16 v[36:39], v[56:59], v[172:175], v[36:39]
    s_and_b32 s44, s44, 3
    s_mul_i32 s44, s44, 40960
    s_add_u32 s17, s16, s44
    ds_read_b64_tr_b16 v[40:41], v232 offset:15360
    ds_read_b64_tr_b16 v[42:43], v232 offset:17920
    ds_read_b64_tr_b16 v[44:45], v232 offset:15392
    ds_read_b64_tr_b16 v[46:47], v232 offset:17952
    s_waitcnt lgkmcnt(12)
    v_mfma_f32_16x16x32_bf16 v[0:3], v[64:67], v[176:179], v[0:3]
    v_mfma_f32_16x16x32_bf16 v[20:23], v[64:67], v[180:183], v[20:23]
    ds_read_b64_tr_b16 v[48:49], v232 offset:15424
    ds_read_b64_tr_b16 v[50:51], v232 offset:17984
    s_add_u32 s44, s56, 2
    s_and_b32 s44, s44, 3
    s_mul_i32 s44, s44, 40960
    s_waitcnt lgkmcnt(12)
    v_mfma_f32_16x16x32_bf16 v[4:7], v[68:71], v[176:179], v[4:7]
    v_mfma_f32_16x16x32_bf16 v[24:27], v[68:71], v[180:183], v[24:27]
    ds_read_b64_tr_b16 v[52:53], v232 offset:15456
    ds_read_b64_tr_b16 v[54:55], v232 offset:18016
    s_add_u32 s18, s16, s44
    s_add_u32 s44, s56, 3
    s_and_b32 s44, s44, 3
    s_waitcnt lgkmcnt(12)
    v_mfma_f32_16x16x32_bf16 v[8:11], v[72:75], v[176:179], v[8:11]
    v_mfma_f32_16x16x32_bf16 v[28:31], v[72:75], v[180:183], v[28:31]
    ds_read_b64_tr_b16 v[56:57], v232 offset:15488
    ds_read_b64_tr_b16 v[58:59], v232 offset:18048
    s_mul_i32 s44, s44, 40960
    s_add_u32 s19, s16, s44
    v_lshlrev_b32 v224, 4, v255
    s_waitcnt lgkmcnt(12)
    v_mfma_f32_16x16x32_bf16 v[12:15], v[76:79], v[176:179], v[12:15]
    v_mfma_f32_16x16x32_bf16 v[32:35], v[76:79], v[180:183], v[32:35]
    v_add_u32 v228, 4096, v224
    v_and_b32 v225, 15, v255
    v_mul_u32_u24 v225, 1280, v225
    s_waitcnt lgkmcnt(10)
    v_mfma_f32_16x16x32_bf16 v[16:19], v[80:83], v[176:179], v[16:19]
    v_mfma_f32_16x16x32_bf16 v[36:39], v[80:83], v[180:183], v[36:39]
    v_lshrrev_b32 v226, 4, v255
    v_lshl_add_u32 v225, v226, 3, v225
    s_mul_i32 s44, s40, 5120
    v_add_u32 v232, s46, v231
    ds_read_b64_tr_b16 v[64:65], v232 offset:0
    ds_read_b64_tr_b16 v[66:67], v232 offset:2560
    ds_read_b64_tr_b16 v[68:69], v232 offset:32
    ds_read_b64_tr_b16 v[70:71], v232 offset:2592
    s_waitcnt lgkmcnt(12)
    v_mfma_f32_16x16x32_bf16 v[0:3], v[40:43], v[184:187], v[0:3]
    v_mfma_f32_16x16x32_bf16 v[20:23], v[40:43], v[188:191], v[20:23]
    ds_read_b64_tr_b16 v[72:73], v232 offset:64
    ds_read_b64_tr_b16 v[74:75], v232 offset:2624
    v_add_u32 v226, s44, v224
    s_xor_b32 s44, s40, 4
    s_mul_i32 s44, s44, 5120
    s_waitcnt lgkmcnt(12)
    v_mfma_f32_16x16x32_bf16 v[4:7], v[44:47], v[184:187], v[4:7]
    v_mfma_f32_16x16x32_bf16 v[24:27], v[44:47], v[188:191], v[24:27]
    ds_read_b64_tr_b16 v[76:77], v232 offset:96
    ds_read_b64_tr_b16 v[78:79], v232 offset:2656
    v_add_u32 v227, s44, v224
    v_mov_b32 v233, 1
    v_mov_b32 v234, 0
    s_waitcnt lgkmcnt(12)
    v_mfma_f32_16x16x32_bf16 v[8:11], v[48:51], v[184:187], v[8:11]
    v_mfma_f32_16x16x32_bf16 v[28:31], v[48:51], v[188:191], v[28:31]
    ds_read_b64_tr_b16 v[80:81], v232 offset:128
    ds_read_b64_tr_b16 v[82:83], v232 offset:2688
    s_waitcnt lgkmcnt(12)
    v_mfma_f32_16x16x32_bf16 v[12:15], v[52:55], v[184:187], v[12:15]
    v_mfma_f32_16x16x32_bf16 v[32:35], v[52:55], v[188:191], v[32:35]
    s_waitcnt lgkmcnt(10)
    v_mfma_f32_16x16x32_bf16 v[16:19], v[56:59], v[184:187], v[16:19]
    v_mfma_f32_16x16x32_bf16 v[36:39], v[56:59], v[188:191], v[36:39]
    s_cmp_lg_u32 s82, 4
    s_cbranch_scc1 K1_B3
K1_R3:
    s_cmp_eq_u32 s6, 0
    s_cbranch_scc1 K1_N3
K1_D3:
    s_waitcnt vmcnt(0)
K1_C3:
    ds_read_b64_tr_b16 v[40:41], v232 offset:5120
    ds_read_b64_tr_b16 v[42:43], v232 offset:7680
    ds_read_b64_tr_b16 v[44:45], v232 offset:5152
    ds_read_b64_tr_b16 v[46:47], v232 offset:7712
    s_waitcnt lgkmcnt(12)
    v_mfma_f32_16x16x32_bf16 v[0:3], v[64:67], v[192:195], v[0:3]
    v_mfma_f32_16x16x32_bf16 v[20:23], v[64:67], v[196:199], v[20:23]
    ds_read_b64_tr_b16 v[48:49], v232 offset:5184
    ds_read_b64_tr_b16 v[50:51], v232 offset:7744
    s_waitcnt lgkmcnt(12)
    v_mfma_f32_16x16x32_bf16 v[4:7], v[68:71], v[192:195], v[4:7]
    v_mfma_f32_16x16x32_bf16 v[24:27], v[68:71], v[196:199], v[24:27]
    ds_read_b64_tr_b16 v[52:53], v232 offset:5216
    ds_read_b64_tr_b16 v[54:55], v232 offset:7776
    s_waitcnt lgkmcnt(12)
    v_mfma_f32_16x16x32_bf16 v[8:11], v[72:75], v[192:195], v[8:11]
    v_mfma_f32_16x16x32_bf16 v[28:31], v[72:75], v[196:199], v[28:31]
    ds_read_b64_tr_b16 v[56:57], v232 offset:5248
    ds_read_b64_tr_b16 v[58:59], v232 offset:7808
    s_waitcnt lgkmcnt(12)
    v_mfma_f32_16x16x32_bf16 v[12:15], v[76:79], v[192:195], v[12:15]
    v_mfma_f32_16x16x32_bf16 v[32:35], v[76:79], v[196:199], v[32:35]
    s_waitcnt lgkmcnt(10)
    v_mfma_f32_16x16x32_bf16 v[16:19], v[80:83], v[192:195], v[16:19]
    v_mfma_f32_16x16x32_bf16 v[36:39], v[80:83], v[196:199], v[36:39]
    ds_read_b64_tr_b16 v[64:65], v232 offset:10240
    ds_read_b64_tr_b16 v[66:67], v232 offset:12800
    ds_read_b64_tr_b16 v[68:69], v232 offset:10272
    ds_read_b64_tr_b16 v[70:71], v232 offset:12832
    s_waitcnt lgkmcnt(12)
    v_mfma_f32_16x16x32_bf16 v[0:3], v[40:43], v[200:203], v[0:3]
    v_mfma_f32_16x16x32_bf16 v[20:23], v[40:43], v[204:207], v[20:23]
    ds_read_b64_tr_b16 v[72:73], v232 offset:10304
    ds_read_b64_tr_b16 v[74:75], v232 offset:12864
    s_waitcnt lgkmcnt(12)
    v_mfma_f32_16x16x32_bf16 v[4:7], v[44:47], v[200:203], v[4:7]
    v_mfma_f32_16x16x32_bf16 v[24:27], v[44:47], v[204:207], v[24:27]
    ds_read_b64_tr_b16 v[76:77], v232 offset:10336
    ds_read_b64_tr_b16 v[78:79], v232 offset:12896
    s_waitcnt lgkmcnt(12)
    v_mfma_f32_16x16x32_bf16 v[8:11], v[48:51], v[200:203], v[8:11]
    v_mfma_f32_16x16x32_bf16 v[28:31], v[48:51], v[204:207], v[28:31]
    ds_read_b64_tr_b16 v[80:81], v232 offset:10368
    ds_read_b64_tr_b16 v[82:83], v232 offset:12928
    s_waitcnt lgkmcnt(12)
    v_mfma_f32_16x16x32_bf16 v[12:15], v[52:55], v[200:203], v[12:15]
    v_mfma_f32_16x16x32_bf16 v[32:35], v[52:55], v[204:207], v[32:35]
    s_waitcnt lgkmcnt(10)
    v_mfma_f32_16x16x32_bf16 v[16:19], v[56:59], v[200:203], v[16:19]
    v_mfma_f32_16x16x32_bf16 v[36:39], v[56:59], v[204:207], v[36:39]
    ds_read_b64_tr_b16 v[40:41], v232 offset:15360
    ds_read_b64_tr_b16 v[42:43], v232 offset:17920
    ds_read_b64_tr_b16 v[44:45], v232 offset:15392
    ds_read_b64_tr_b16 v[46:47], v232 offset:17952
    s_waitcnt lgkmcnt(12)
    v_mfma_f32_16x16x32_bf16 v[0:3], v[64:67], v[208:211], v[0:3]
    v_mfma_f32_16x16x32_bf16 v[20:23], v[64:67], v[212:215], v[20:23]
    ds_read_b64_tr_b16 v[48:49], v232 offset:15424
    ds_read_b64_tr_b16 v[50:51], v232 offset:17984
    s_waitcnt lgkmcnt(12)
    v_mfma_f32_16x16x32_bf16 v[4:7], v[68:71], v[208:211], v[4:7]
    v_mfma_f32_16x16x32_bf16 v[24:27], v[68:71], v[212:215], v[24:27]
    ds_read_b64_tr_b16 v[52:53], v232 offset:15456
    ds_read_b64_tr_b16 v[54:55], v232 offset:18016
    s_waitcnt lgkmcnt(12)
    v_mfma_f32_16x16x32_bf16 v[8:11], v[72:75], v[208:211], v[8:11]
    v_mfma_f32_16x16x32_bf16 v[28:31], v[72:75], v[212:215], v[28:31]
    ds_read_b64_tr_b16 v[56:57], v232 offset:15488
    ds_read_b64_tr_b16 v[58:59], v232 offset:18048
    s_waitcnt lgkmcnt(12)
    v_mfma_f32_16x16x32_bf16 v[12:15], v[76:79], v[208:211], v[12:15]
    v_mfma_f32_16x16x32_bf16 v[32:35], v[76:79], v[212:215], v[32:35]
    s_waitcnt lgkmcnt(10)
    v_mfma_f32_16x16x32_bf16 v[16:19], v[80:83], v[208:211], v[16:19]
    v_mfma_f32_16x16x32_bf16 v[36:39], v[80:83], v[212:215], v[36:39]
    s_waitcnt lgkmcnt(8)
    v_mfma_f32_16x16x32_bf16 v[0:3], v[40:43], v[216:219], v[0:3]
    v_mfma_f32_16x16x32_bf16 v[20:23], v[40:43], v[220:223], v[20:23]
    s_waitcnt lgkmcnt(6)
    v_mfma_f32_16x16x32_bf16 v[4:7], v[44:47], v[216:219], v[4:7]
    v_mfma_f32_16x16x32_bf16 v[24:27], v[44:47], v[220:223], v[24:27]
    s_waitcnt lgkmcnt(4)
    v_mfma_f32_16x16x32_bf16 v[8:11], v[48:51], v[216:219], v[8:11]
    v_mfma_f32_16x16x32_bf16 v[28:31], v[48:51], v[220:223], v[28:31]
    s_waitcnt lgkmcnt(2)
    v_mfma_f32_16x16x32_bf16 v[12:15], v[52:55], v[216:219], v[12:15]
    v_mfma_f32_16x16x32_bf16 v[32:35], v[52:55], v[220:223], v[32:35]
    s_waitcnt lgkmcnt(0)
    v_mfma_f32_16x16x32_bf16 v[16:19], v[56:59], v[216:219], v[16:19]
    v_mfma_f32_16x16x32_bf16 v[36:39], v[56:59], v[220:223], v[36:39]
K1_GDONE:
    s_barrier
    ds_write_b128 v226, v[20:23] offset:0
    ds_write_b128 v226, v[24:27] offset:1024
    ds_write_b128 v226, v[28:31] offset:2048
    s_nop 0
    ds_write_b128 v226, v[32:35] offset:3072
    s_nop 1
    ds_write_b128 v226, v[36:39] offset:4096
    s_cmp_eq_u32 s76, s56
    s_waitcnt lgkmcnt(0)
    s_barrier
    ds_read_b128 v[40:43], v227 offset:0
    ds_read_b128 v[44:47], v227 offset:1024
    ds_read_b128 v[48:51], v227 offset:2048
    ds_read_b128 v[52:55], v227 offset:3072
    ds_read_b128 v[56:59], v227 offset:4096
    s_cbranch_scc1 K1_FINAL
    s_waitcnt lgkmcnt(4)
    v_pk_add_f32 v[0:1], v[0:1], v[40:41]
    v_pk_add_f32 v[2:3], v[2:3], v[42:43]
    buffer_store_dwordx4 v[0:3], v224, s[36:39], s52 offen offset:0 sc1
    s_waitcnt lgkmcnt(3)
    v_pk_add_f32 v[4:5], v[4:5], v[44:45]
    v_pk_add_f32 v[6:7], v[6:7], v[46:47]
    buffer_store_dwordx4 v[4:7], v224, s[36:39], s52 offen offset:1024 sc1
    s_waitcnt lgkmcnt(2)
    v_pk_add_f32 v[8:9], v[8:9], v[48:49]
    v_pk_add_f32 v[10:11], v[10:11], v[50:51]
    buffer_store_dwordx4 v[8:11], v224, s[36:39], s52 offen offset:2048 sc1
    s_waitcnt lgkmcnt(1)
    v_pk_add_f32 v[12:13], v[12:13], v[52:53]
    v_pk_add_f32 v[14:15], v[14:15], v[54:55]
    buffer_store_dwordx4 v[12:15], v224, s[36:39], s52 offen offset:3072 sc1
    s_waitcnt lgkmcnt(0)
    v_pk_add_f32 v[16:17], v[16:17], v[56:57]
    v_pk_add_f32 v[18:19], v[18:19], v[58:59]
    buffer_store_dwordx4 v[16:19], v228, s[36:39], s52 offen offset:0 sc1
    s_mov_b64 exec, 1
    s_waitcnt vmcnt(0)
    buffer_store_byte v233, v234, s[36:39], s55 offen sc0 sc1
    s_mov_b64 exec, -1
    s_endpgm
K1_FINAL:
    s_buffer_load_dword s12, s[36:39], s14 glc
    s_mov_b32 s83, 0
    s_waitcnt lgkmcnt(0)
    s_or_b32 s12, s12, s15
    s_cmp_eq_u32 s12, 0x01010101
    s_cbranch_scc1 K1_POLL2_DONE
K1_POLL2:
    s_buffer_load_dword s12, s[36:39], s14 glc
    s_add_u32 s83, s83, 1
    s_cmp_gt_u32 s83, 400000
    s_waitcnt lgkmcnt(0)
    s_cbranch_scc1 K1_POLL2_DONE
    s_or_b32 s12, s12, s15
    s_cmp_eq_u32 s12, 0x01010101
    s_cbranch_scc0 K1_POLL2
K1_POLL2_DONE:
    buffer_load_dwordx4 v[96:99], v224, s[36:39], s17 offen offset:0
    buffer_load_dwordx4 v[100:103], v224, s[36:39], s17 offen offset:1024
    buffer_load_dwordx4 v[104:107], v224, s[36:39], s17 offen offset:2048
    buffer_load_dwordx4 v[108:111], v224, s[36:39], s17 offen offset:3072
    buffer_load_dwordx4 v[112:115], v228, s[36:39], s17 offen offset:0
    buffer_load_dwordx4 v[116:119], v224, s[36:39], s18 offen offset:0
    buffer_load_dwordx4 v[120:123], v224, s[36:39], s18 offen offset:1024
    buffer_load_dwordx4 v[124:127], v224, s[36:39], s18 offen offset:2048
    buffer_load_dwordx4 v[128:131], v224, s[36:39], s18 offen offset:3072
    buffer_load_dwordx4 v[132:135], v228, s[36:39], s18 offen offset:0
    buffer_load_dwordx4 v[136:139], v224, s[36:39], s19 offen offset:0
    buffer_load_dwordx4 v[140:143], v224, s[36:39], s19 offen offset:1024
    buffer_load_dwordx4 v[144:147], v224, s[36:39], s19 offen offset:2048
    buffer_load_dwordx4 v[148:151], v224, s[36:39], s19 offen offset:3072
    buffer_load_dwordx4 v[152:155], v228, s[36:39], s19 offen offset:0
    v_pk_add_f32 v[0:1], v[0:1], v[40:41]
    v_pk_add_f32 v[2:3], v[2:3], v[42:43]
    v_pk_add_f32 v[4:5], v[4:5], v[44:45]
    v_pk_add_f32 v[6:7], v[6:7], v[46:47]
    v_pk_add_f32 v[8:9], v[8:9], v[48:49]
    v_pk_add_f32 v[10:11], v[10:11], v[50:51]
    v_pk_add_f32 v[12:13], v[12:13], v[52:53]
    v_pk_add_f32 v[14:15], v[14:15], v[54:55]
    v_pk_add_f32 v[16:17], v[16:17], v[56:57]
    v_pk_add_f32 v[18:19], v[18:19], v[58:59]
    s_waitcnt vmcnt(10)
    v_pk_add_f32 v[0:1], v[0:1], v[96:97]
    v_pk_add_f32 v[2:3], v[2:3], v[98:99]
    v_pk_add_f32 v[4:5], v[4:5], v[100:101]
    v_pk_add_f32 v[6:7], v[6:7], v[102:103]
    v_pk_add_f32 v[8:9], v[8:9], v[104:105]
    v_pk_add_f32 v[10:11], v[10:11], v[106:107]
    v_pk_add_f32 v[12:13], v[12:13], v[108:109]
    v_pk_add_f32 v[14:15], v[14:15], v[110:111]
    v_pk_add_f32 v[16:17], v[16:17], v[112:113]
    v_pk_add_f32 v[18:19], v[18:19], v[114:115]
    s_waitcnt vmcnt(5)
    v_pk_add_f32 v[0:1], v[0:1], v[116:117]
    v_pk_add_f32 v[2:3], v[2:3], v[118:119]
    v_pk_add_f32 v[4:5], v[4:5], v[120:121]
    v_pk_add_f32 v[6:7], v[6:7], v[122:123]
    v_pk_add_f32 v[8:9], v[8:9], v[124:125]
    v_pk_add_f32 v[10:11], v[10:11], v[126:127]
    v_pk_add_f32 v[12:13], v[12:13], v[128:129]
    v_pk_add_f32 v[14:15], v[14:15], v[130:131]
    v_pk_add_f32 v[16:17], v[16:17], v[132:133]
    v_pk_add_f32 v[18:19], v[18:19], v[134:135]
    s_waitcnt vmcnt(0)
    v_pk_add_f32 v[0:1], v[0:1], v[136:137]
    v_pk_add_f32 v[2:3], v[2:3], v[138:139]
    v_cvt_pk_bf16_f32 v40, v0, v1
    v_cvt_pk_bf16_f32 v41, v2, v3
    buffer_store_dwordx2 v[40:41], v225, s[72:75], s53 offen offset:0
    v_pk_add_f32 v[4:5], v[4:5], v[140:141]
    v_pk_add_f32 v[6:7], v[6:7], v[142:143]
    v_cvt_pk_bf16_f32 v42, v4, v5
    v_cvt_pk_bf16_f32 v43, v6, v7
    buffer_store_dwordx2 v[42:43], v225, s[72:75], s53 offen offset:32
    v_pk_add_f32 v[8:9], v[8:9], v[144:145]
    v_pk_add_f32 v[10:11], v[10:11], v[146:147]
    v_cvt_pk_bf16_f32 v44, v8, v9
    v_cvt_pk_bf16_f32 v45, v10, v11
    buffer_store_dwordx2 v[44:45], v225, s[72:75], s53 offen offset:64
    v_pk_add_f32 v[12:13], v[12:13], v[148:149]
    v_pk_add_f32 v[14:15], v[14:15], v[150:151]
    v_cvt_pk_bf16_f32 v46, v12, v13
    v_cvt_pk_bf16_f32 v47, v14, v15
    buffer_store_dwordx2 v[46:47], v225, s[72:75], s53 offen offset:96
    v_pk_add_f32 v[16:17], v[16:17], v[152:153]
    v_pk_add_f32 v[18:19], v[18:19], v[154:155]
    v_cvt_pk_bf16_f32 v48, v16, v17
    v_cvt_pk_bf16_f32 v49, v18, v19
    buffer_store_dwordx2 v[48:49], v225, s[72:75], s53 offen offset:128
K1_FIN:
    s_endpgm
K1_TMO:
    s_lshl_b32 s44, s42, 3
    s_add_u32 s44, s44, s57
    s_mul_i32 s16, s44, 163840
    s_add_u32 s16, s16, 33554432
    s_lshl_b32 s44, s76, 1
    s_add_u32 s44, s44, s77
    s_mul_i32 s45, s44, 5120
    s_add_u32 s16, s16, s45
    s_lshl_b32 s45, s42, 3
    s_add_u32 s44, s44, s45
    s_mul_i32 s53, s44, 20480
    s_mul_i32 s44, s57, 160
    s_add_u32 s53, s53, s44
    s_mul_i32 s44, s56, 40960
    s_add_u32 s52, s16, s44
    s_lshl_b32 s14, s42, 5
    s_lshl_b32 s44, s76, 3
    s_add_u32 s14, s14, s44
    s_add_u32 s14, s14, s57
    s_lshl_b32 s14, s14, 13
    s_lshl_b32 s44, s77, 9
    s_add_u32 s14, s14, s44
    s_add_u32 s14, s14, 25169920
    s_add_u32 s55, s14, s56
    s_lshl_b32 s44, s56, 3
    s_lshl_b32 s15, 1, s44
    s_add_u32 s44, s56, 1
    s_and_b32 s44, s44, 3
    s_mul_i32 s44, s44, 40960
    s_add_u32 s17, s16, s44
    s_add_u32 s44, s56, 2
    s_and_b32 s44, s44, 3
    s_mul_i32 s44, s44, 40960
    s_add_u32 s18, s16, s44
    s_add_u32 s44, s56, 3
    s_and_b32 s44, s44, 3
    s_mul_i32 s44, s44, 40960
    s_add_u32 s19, s16, s44
    v_lshlrev_b32 v224, 4, v255
    v_add_u32 v228, 4096, v224
    v_and_b32 v225, 15, v255
    v_mul_u32_u24 v225, 1280, v225
    v_lshrrev_b32 v226, 4, v255
    v_lshl_add_u32 v225, v226, 3, v225
    s_mul_i32 s44, s40, 5120
    v_add_u32 v226, s44, v224
    s_xor_b32 s44, s40, 4
    s_mul_i32 s44, s44, 5120
    v_add_u32 v227, s44, v224
    v_mov_b32 v233, 1
    v_mov_b32 v234, 0
    s_waitcnt lgkmcnt(0)
    s_branch K1_GDONE
K1_T0:
    s_add_u32 s83, s83, 1
    s_cmp_gt_u32 s83, 400000
    s_cbranch_scc1 K1_TMO
    s_branch K1_B0
K1_Z0:
    s_waitcnt vmcnt(0)
    s_branch K1_C0
K1_Z1:
    s_waitcnt vmcnt(0)
    s_branch K1_C1
K1_B1:
    s_cmp_eq_u32 s8, 0
    s_cbranch_scc1 K1_G1
    s_waitcnt lgkmcnt(0)
    s_call_b64 s[90:91], K1_SVF
K1_G1:
    s_min_u32 s5, s81, 3
    s_cmp_le_u32 s81, 1
    s_cbranch_scc1 K1_T1
    s_call_b64 s[90:91], K1_X0
    s_branch K1_R1
K1_T1:
    s_add_u32 s83, s83, 1
    s_cmp_gt_u32 s83, 400000
    s_cbranch_scc1 K1_TMO
    s_branch K1_B1
K1_N1:
    s_bfe_u32 s46, s80, 0x40004
    s_xor_b32 s46, s46, s4
    s_mul_i32 s46, s46, 20480
    v_add_u32 v232, s46, v231
    ds_read_b64_tr_b16 v[64:65], v232 offset:0
    ds_read_b64_tr_b16 v[66:67], v232 offset:2560
    ds_read_b64_tr_b16 v[68:69], v232 offset:32
    ds_read_b64_tr_b16 v[70:71], v232 offset:2592
    ds_read_b64_tr_b16 v[72:73], v232 offset:64
    ds_read_b64_tr_b16 v[74:75], v232 offset:2624
    ds_read_b64_tr_b16 v[76:77], v232 offset:96
    ds_read_b64_tr_b16 v[78:79], v232 offset:2656
    ds_read_b64_tr_b16 v[80:81], v232 offset:128
    ds_read_b64_tr_b16 v[82:83], v232 offset:2688
    s_branch K1_D1
K1_Z2:
    s_waitcnt vmcnt(0)
    s_branch K1_C2
K1_B2:
    s_cmp_eq_u32 s8, 0
    s_cbranch_scc1 K1_G2
    s_waitcnt lgkmcnt(0)
    s_call_b64 s[90:91], K1_SVF
K1_G2:
    s_min_u32 s5, s81, 4
    s_cmp_le_u32 s81, 2
    s_cbranch_scc1 K1_T2
    s_call_b64 s[90:91], K1_X1
    s_branch K1_R2
K1_T2:
    s_add_u32 s83, s83, 1
    s_cmp_gt_u32 s83, 400000
    s_cbranch_scc1 K1_TMO
    s_branch K1_B2
K1_N2:
    s_bfe_u32 s46, s80, 0x40008
    s_xor_b32 s46, s46, s4
    s_mul_i32 s46, s46, 20480
    v_add_u32 v232, s46, v231
    ds_read_b64_tr_b16 v[64:65], v232 offset:0
    ds_read_b64_tr_b16 v[66:67], v232 offset:2560
    ds_read_b64_tr_b16 v[68:69], v232 offset:32
    ds_read_b64_tr_b16 v[70:71], v232 offset:2592
    ds_read_b64_tr_b16 v[72:73], v232 offset:64
    ds_read_b64_tr_b16 v[74:75], v232 offset:2624
    ds_read_b64_tr_b16 v[76:77], v232 offset:96
    ds_read_b64_tr_b16 v[78:79], v232 offset:2656
    ds_read_b64_tr_b16 v[80:81], v232 offset:128
    ds_read_b64_tr_b16 v[82:83], v232 offset:2688
    s_branch K1_D2
K1_B3:
    s_cmp_eq_u32 s8, 0
    s_cbranch_scc1 K1_G3
    s_waitcnt lgkmcnt(0)
    s_call_b64 s[90:91], K1_SVF
K1_G3:
    s_min_u32 s5, s81, 5
    s_cmp_le_u32 s81, 3
    s_cbranch_scc1 K1_T3
    s_call_b64 s[90:91], K1_X2
    s_branch K1_R3
K1_T3:
    s_add_u32 s83, s83, 1
    s_cmp_gt_u32 s83, 400000
    s_cbranch_scc1 K1_TMO
    s_branch K1_B3
K1_N3:
    s_bfe_u32 s46, s80, 0x4000c
    s_xor_b32 s46, s46, s4
    s_mul_i32 s46, s46, 20480
    v_add_u32 v232, s46, v231
    ds_read_b64_tr_b16 v[64:65], v232 offset:0
    ds_read_b64_tr_b16 v[66:67], v232 offset:2560
    ds_read_b64_tr_b16 v[68:69], v232 offset:32
    ds_read_b64_tr_b16 v[70:71], v232 offset:2592
    ds_read_b64_tr_b16 v[72:73], v232 offset:64
    ds_read_b64_tr_b16 v[74:75], v232 offset:2624
    ds_read_b64_tr_b16 v[76:77], v232 offset:96
    ds_read_b64_tr_b16 v[78:79], v232 offset:2656
    ds_read_b64_tr_b16 v[80:81], v232 offset:128
    ds_read_b64_tr_b16 v[82:83], v232 offset:2688
    s_branch K1_D3
K1_SVF:
    s_mul_i32 s79, s12, 0x01010101
    s_lshr_b32 s79, s79, 24
    s_and_b32 s79, s79, 0xf
    s_andn2_b32 s79, s79, s84
    s_cbranch_scc0 K1_F3
    s_or_b32 s84, s84, s79
K1_F2:
    s_ff1_i32_b32 s46, s79
    s_bitset0_b32 s79, s46
    s_lshl_b32 s62, s81, 2
    s_lshl_b32 s46, s46, s62
    s_or_b32 s80, s80, s46
    s_add_u32 s81, s81, 1
    s_cmp_lg_u32 s79, 0
    s_cbranch_scc1 K1_F2
    s_xor_b32 s8, s84, 0xf
    s_cbranch_scc1 K1_F3
    s_setpc_b64 s[90:91]
K1_F3:
    s_buffer_load_dword s12, s[36:39], s78 glc
    s_setpc_b64 s[90:91]
K1_SVC:
    s_cmp_eq_u32 s8, 0
    s_cbranch_scc1 K1_V4
    s_mul_i32 s79, s12, 0x01010101
    s_lshr_b32 s79, s79, 24
    s_and_b32 s79, s79, 0xf
    s_andn2_b32 s79, s79, s84
    s_cbranch_scc0 K1_V3
    s_or_b32 s84, s84, s79
K1_V2:
    s_ff1_i32_b32 s46, s79
    s_bitset0_b32 s79, s46
    s_lshl_b32 s62, s81, 2
    s_lshl_b32 s46, s46, s62
    s_or_b32 s80, s80, s46
    s_add_u32 s81, s81, 1
    s_cmp_lg_u32 s79, 0
    s_cbranch_scc1 K1_V2
    s_xor_b32 s8, s84, 0xf
    s_cbranch_scc0 K1_V4
K1_V3:
    s_buffer_load_dword s12, s[36:39], s78 glc
K1_V4:
    s_min_u32 s5, s5, s81
K1_V5:
    s_cmp_lg_u32 s82, 0
    s_cbranch_scc1 K1_X0
    s_cmp_le_u32 s5, 0
    s_cbranch_scc1 K1_X4
    s_bfe_u32 s46, s80, 0x40000
    s_lshl_b32 s46, s46, 12
    s_add_u32 s46, s46, s47
    buffer_load_dwordx4 v[96:99], v230, s[36:39], s46 offen offset:0
    buffer_load_dwordx4 v[100:103], v229, s[36:39], s46 offen offset:0
    buffer_load_dwordx4 v[104:107], v230, s[36:39], s46 offen offset:1024
    buffer_load_dwordx4 v[108:111], v229, s[36:39], s46 offen offset:1024
    buffer_load_dwordx4 v[112:115], v230, s[36:39], s46 offen offset:2048
    buffer_load_dwordx4 v[116:119], v229, s[36:39], s46 offen offset:2048
    buffer_load_dwordx4 v[120:123], v230, s[36:39], s46 offen offset:3072
    buffer_load_dwordx4 v[124:127], v229, s[36:39], s46 offen offset:3072
    s_add_u32 s85, s85, 8
    s_xor_b32 s46, s85, 0xff
    s_lshl_b32 s46, s46, 0
    s_xor_b32 s86, s86, s46
    s_mov_b32 s82, 1
K1_X0:
    s_cmp_lg_u32 s82, 1
    s_cbranch_scc1 K1_X1
    s_cmp_le_u32 s5, 1
    s_cbranch_scc1 K1_X4
    s_bfe_u32 s46, s80, 0x40004
    s_lshl_b32 s46, s46, 12
    s_add_u32 s46, s46, s47
    buffer_load_dwordx4 v[128:131], v230, s[36:39], s46 offen offset:0
    buffer_load_dwordx4 v[132:135], v229, s[36:39], s46 offen offset:0
    buffer_load_dwordx4 v[136:139], v230, s[36:39], s46 offen offset:1024
    buffer_load_dwordx4 v[140:143], v229, s[36:39], s46 offen offset:1024
    buffer_load_dwordx4 v[144:147], v230, s[36:39], s46 offen offset:2048
    buffer_load_dwordx4 v[148:151], v229, s[36:39], s46 offen offset:2048
    buffer_load_dwordx4 v[152:155], v230, s[36:39], s46 offen offset:3072
    buffer_load_dwordx4 v[156:159], v229, s[36:39], s46 offen offset:3072
    s_add_u32 s85, s85, 8
    s_xor_b32 s46, s85, 0xff
    s_lshl_b32 s46, s46, 8
    s_xor_b32 s86, s86, s46
    s_mov_b32 s82, 2
K1_X1:
    s_cmp_lg_u32 s82, 2
    s_cbranch_scc1 K1_X2
    s_cmp_le_u32 s5, 2
    s_cbranch_scc1 K1_X4
    s_bfe_u32 s46, s80, 0x40008
    s_lshl_b32 s46, s46, 12
    s_add_u32 s46, s46, s47
    buffer_load_dwordx4 v[160:163], v230, s[36:39], s46 offen offset:0
    buffer_load_dwordx4 v[164:167], v229, s[36:39], s46 offen offset:0
    buffer_load_dwordx4 v[168:171], v230, s[36:39], s46 offen offset:1024
    buffer_load_dwordx4 v[172:175], v229, s[36:39], s46 offen offset:1024
    buffer_load_dwordx4 v[176:179], v230, s[36:39], s46 offen offset:2048
    buffer_load_dwordx4 v[180:183], v229, s[36:39], s46 offen offset:2048
    buffer_load_dwordx4 v[184:187], v230, s[36:39], s46 offen offset:3072
    buffer_load_dwordx4 v[188:191], v229, s[36:39], s46 offen offset:3072
    s_add_u32 s85, s85, 8
    s_xor_b32 s46, s85, 0xff
    s_lshl_b32 s46, s46, 16
    s_xor_b32 s86, s86, s46
    s_mov_b32 s82, 3
K1_X2:
    s_cmp_lg_u32 s82, 3
    s_cbranch_scc1 K1_X3
    s_cmp_le_u32 s5, 3
    s_cbranch_scc1 K1_X4
    s_bfe_u32 s46, s80, 0x4000c
    s_lshl_b32 s46, s46, 12
    s_add_u32 s46, s46, s47
    buffer_load_dwordx4 v[192:195], v230, s[36:39], s46 offen offset:0
    buffer_load_dwordx4 v[196:199], v229, s[36:39], s46 offen offset:0
    buffer_load_dwordx4 v[200:203], v230, s[36:39], s46 offen offset:1024
    buffer_load_dwordx4 v[204:207], v229, s[36:39], s46 offen offset:1024
    buffer_load_dwordx4 v[208:211], v230, s[36:39], s46 offen offset:2048
    buffer_load_dwordx4 v[212:215], v229, s[36:39], s46 offen offset:2048
    buffer_load_dwordx4 v[216:219], v230, s[36:39], s46 offen offset:3072
    buffer_load_dwordx4 v[220:223], v229, s[36:39], s46 offen offset:3072
    s_add_u32 s85, s85, 8
    s_xor_b32 s46, s85, 0xff
    s_lshl_b32 s46, s46, 24
    s_xor_b32 s86, s86, s46
    s_mov_b32 s82, 4
K1_X3:
K1_X4:
    s_setpc_b64 s[90:91]
K1_WV:
    s_waitcnt vmcnt(25)
    s_cmp_ge_u32 s46, 25
    s_cbranch_scc1 K1_X4
    s_waitcnt vmcnt(24)
    s_cmp_ge_u32 s46, 24
    s_cbranch_scc1 K1_X4
    s_waitcnt vmcnt(17)
    s_cmp_ge_u32 s46, 17
    s_cbranch_scc1 K1_X4
    s_waitcnt vmcnt(16)
    s_cmp_ge_u32 s46, 16
    s_cbranch_scc1 K1_X4
    s_waitcnt vmcnt(9)
    s_cmp_ge_u32 s46, 9
    s_cbranch_scc1 K1_X4
    s_waitcnt vmcnt(8)
    s_cmp_ge_u32 s46, 8
    s_cbranch_scc1 K1_X4
    s_waitcnt vmcnt(1)
    s_cmp_ge_u32 s46, 1
    s_cbranch_scc1 K1_X4
    s_waitcnt vmcnt(0)
    s_setpc_b64 s[90:91]
K1_FC:
    s_mov_b32 s62, 0
K1_FQ:
    ds_read_b32 v251, v246 offset:4
    s_add_u32 s62, s62, 1
    s_cmp_gt_u32 s62, 200000
    s_waitcnt lgkmcnt(0)
    v_cmp_gt_u32 vcc, s46, v251
    s_cbranch_scc1 K1_X4
    s_nop 4
    s_cbranch_vccz K1_X4
    s_branch K1_FQ
K1_FIX0:
    v_max3_f32 v148, v128, v129, 0
    v_max3_f32 v149, v136, v137, 0
    v_max3_f32 v148, v130, v131, v148
    v_max3_f32 v149, v138, v139, v149
    v_max3_f32 v148, v132, v133, v148
    v_max3_f32 v149, v140, v141, v149
    v_max3_f32 v148, v134, v135, v148
    v_max3_f32 v149, v142, v143, v149
    v_mov_b32 v156, v148
    v_mov_b32 v157, v149
    s_nop 0
    v_permlane32_swap_b32 v148, v156
    v_permlane32_swap_b32 v149, v157
    v_max_f32 v148, v148, v156
    v_max_f32 v149, v149, v157
    v_mov_b32 v156, v148
    v_mov_b32 v157, v149
    s_nop 0
    v_permlane16_swap_b32 v148, v156
    v_permlane16_swap_b32 v149, v157
    v_max_f32 v148, v148, v156
    v_max_f32 v149, v149, v157
    v_ceil_f32 v148, v148
    v_ceil_f32 v149, v149
    v_exp_f32 v156, -v148
    v_exp_f32 v157, -v149
    v_sub_f32 v128, v128, v148
    v_sub_f32 v129, v129, v148
    v_sub_f32 v130, v130, v148
    v_sub_f32 v131, v131, v148
    v_sub_f32 v132, v132, v148
    v_sub_f32 v133, v133, v148
    v_sub_f32 v134, v134, v148
    v_sub_f32 v135, v135, v148
    v_sub_f32 v224, v224, v148
    v_sub_f32 v225, v225, v148
    v_sub_f32 v226, v226, v148
    v_sub_f32 v227, v227, v148
    v_sub_f32 v136, v136, v149
    v_sub_f32 v137, v137, v149
    v_sub_f32 v138, v138, v149
    v_sub_f32 v139, v139, v149
    v_sub_f32 v140, v140, v149
    v_sub_f32 v141, v141, v149
    v_sub_f32 v142, v142, v149
    v_sub_f32 v143, v143, v149
    v_sub_f32 v228, v228, v149
    v_sub_f32 v229, v229, v149
    v_sub_f32 v230, v230, v149
    v_sub_f32 v231, v231, v149
    v_and_b32 v116, 0xffff0000, v112
    v_lshlrev_b32 v112, 16, v112
    v_mul_f32 v116, v156, v116
    v_mul_f32 v112, v156, v112
    v_cvt_pk_bf16_f32 v112, v112, v116
    v_and_b32 v117, 0xffff0000, v113
    v_lshlrev_b32 v113, 16, v113
    v_mul_f32 v117, v156, v117
    v_mul_f32 v113, v156, v113
    v_cvt_pk_bf16_f32 v113, v113, v117
    v_and_b32 v118, 0xffff0000, v114
    v_lshlrev_b32 v114, 16, v114
    v_mul_f32 v118, v156, v118
    v_mul_f32 v114, v156, v114
    v_cvt_pk_bf16_f32 v114, v114, v118
    v_and_b32 v119, 0xffff0000, v115
    v_lshlrev_b32 v115, 16, v115
    v_mul_f32 v119, v156, v119
    v_mul_f32 v115, v156, v115
    v_cvt_pk_bf16_f32 v115, v115, v119
    v_and_b32 v124, 0xffff0000, v120
    v_lshlrev_b32 v120, 16, v120
    v_mul_f32 v124, v157, v124
    v_mul_f32 v120, v157, v120
    v_cvt_pk_bf16_f32 v120, v120, v124
    v_and_b32 v125, 0xffff0000, v121
    v_lshlrev_b32 v121, 16, v121
    v_mul_f32 v125, v157, v125
    v_mul_f32 v121, v157, v121
    v_cvt_pk_bf16_f32 v121, v121, v125
    v_and_b32 v126, 0xffff0000, v122
    v_lshlrev_b32 v122, 16, v122
    v_mul_f32 v126, v157, v126
    v_mul_f32 v122, v157, v122
    v_cvt_pk_bf16_f32 v122, v122, v126
    v_and_b32 v127, 0xffff0000, v123
    v_lshlrev_b32 v123, 16, v123
    v_mul_f32 v127, v157, v127
    v_mul_f32 v123, v157, v123
    v_cvt_pk_bf16_f32 v123, v123, v127
    v_mul_f32 v236, v156, v236
    v_mul_f32 v237, v156, v237
    v_mul_f32 v238, v156, v238
    v_mul_f32 v239, v156, v239
    v_mul_f32 v0, v156, v0
    v_mul_f32 v1, v156, v1
    v_mul_f32 v2, v156, v2
    v_mul_f32 v3, v156, v3
    v_mul_f32 v8, v156, v8
    v_mul_f32 v9, v156, v9
    v_mul_f32 v10, v156, v10
    v_mul_f32 v11, v156, v11
    v_mul_f32 v16, v156, v16
    v_mul_f32 v17, v156, v17
    v_mul_f32 v18, v156, v18
    v_mul_f32 v19, v156, v19
    v_mul_f32 v24, v156, v24
    v_mul_f32 v25, v156, v25
    v_mul_f32 v26, v156, v26
    v_mul_f32 v27, v156, v27
    v_mul_f32 v32, v156, v32
    v_mul_f32 v33, v156, v33
    v_mul_f32 v34, v156, v34
    v_mul_f32 v35, v156, v35
    v_mul_f32 v40, v156, v40
    v_mul_f32 v41, v156, v41
    v_mul_f32 v42, v156, v42
    v_mul_f32 v43, v156, v43
    v_mul_f32 v48, v156, v48
    v_mul_f32 v49, v156, v49
    v_mul_f32 v50, v156, v50
    v_mul_f32 v51, v156, v51
    v_mul_f32 v56, v156, v56
    v_mul_f32 v57, v156, v57
    v_mul_f32 v58, v156, v58
    v_mul_f32 v59, v156, v59
    v_mul_f32 v232, v157, v232
    v_mul_f32 v233, v157, v233
    v_mul_f32 v234, v157, v234
    v_mul_f32 v235, v157, v235
    v_mul_f32 v4, v157, v4
    v_mul_f32 v5, v157, v5
    v_mul_f32 v6, v157, v6
    v_mul_f32 v7, v157, v7
    v_mul_f32 v12, v157, v12
    v_mul_f32 v13, v157, v13
    v_mul_f32 v14, v157, v14
    v_mul_f32 v15, v157, v15
    v_mul_f32 v20, v157, v20
    v_mul_f32 v21, v157, v21
    v_mul_f32 v22, v157, v22
    v_mul_f32 v23, v157, v23
    v_mul_f32 v28, v157, v28
    v_mul_f32 v29, v157, v29
    v_mul_f32 v30, v157, v30
    v_mul_f32 v31, v157, v31
    v_mul_f32 v36, v157, v36
    v_mul_f32 v37, v157, v37
    v_mul_f32 v38, v157, v38
    v_mul_f32 v39, v157, v39
    v_mul_f32 v44, v157, v44
    v_mul_f32 v45, v157, v45
    v_mul_f32 v46, v157, v46
    v_mul_f32 v47, v157, v47
    v_mul_f32 v52, v157, v52
    v_mul_f32 v53, v157, v53
    v_mul_f32 v54, v157, v54
    v_mul_f32 v55, v157, v55
    v_mul_f32 v60, v157, v60
    v_mul_f32 v61, v157, v61
    v_mul_f32 v62, v157, v62
    v_mul_f32 v63, v157, v63
    s_nop 3
    s_setpc_b64 s[90:91]
K1_FIX2:
    v_max3_f32 v116, v96, v97, 0
    v_max3_f32 v117, v104, v105, 0
    v_max3_f32 v116, v98, v99, v116
    v_max3_f32 v117, v106, v107, v117
    v_max3_f32 v116, v100, v101, v116
    v_max3_f32 v117, v108, v109, v117
    v_max3_f32 v116, v102, v103, v116
    v_max3_f32 v117, v110, v111, v117
    v_mov_b32 v124, v116
    v_mov_b32 v125, v117
    s_nop 0
    v_permlane32_swap_b32 v116, v124
    v_permlane32_swap_b32 v117, v125
    v_max_f32 v116, v116, v124
    v_max_f32 v117, v117, v125
    v_mov_b32 v124, v116
    v_mov_b32 v125, v117
    s_nop 0
    v_permlane16_swap_b32 v116, v124
    v_permlane16_swap_b32 v117, v125
    v_max_f32 v116, v116, v124
    v_max_f32 v117, v117, v125
    v_ceil_f32 v116, v116
    v_ceil_f32 v117, v117
    v_exp_f32 v124, -v116
    v_exp_f32 v125, -v117
    v_sub_f32 v96, v96, v116
    v_sub_f32 v97, v97, v116
    v_sub_f32 v98, v98, v116
    v_sub_f32 v99, v99, v116
    v_sub_f32 v100, v100, v116
    v_sub_f32 v101, v101, v116
    v_sub_f32 v102, v102, v116
    v_sub_f32 v103, v103, v116
    v_sub_f32 v224, v224, v116
    v_sub_f32 v225, v225, v116
    v_sub_f32 v226, v226, v116
    v_sub_f32 v227, v227, v116
    v_sub_f32 v104, v104, v117
    v_sub_f32 v105, v105, v117
    v_sub_f32 v106, v106, v117
    v_sub_f32 v107, v107, v117
    v_sub_f32 v108, v108, v117
    v_sub_f32 v109, v109, v117
    v_sub_f32 v110, v110, v117
    v_sub_f32 v111, v111, v117
    v_sub_f32 v228, v228, v117
    v_sub_f32 v229, v229, v117
    v_sub_f32 v230, v230, v117
    v_sub_f32 v231, v231, v117
    v_and_b32 v148, 0xffff0000, v144
    v_lshlrev_b32 v144, 16, v144
    v_mul_f32 v148, v124, v148
    v_mul_f32 v144, v124, v144
    v_cvt_pk_bf16_f32 v144, v144, v148
    v_and_b32 v149, 0xffff0000, v145
    v_lshlrev_b32 v145, 16, v145
    v_mul_f32 v149, v124, v149
    v_mul_f32 v145, v124, v145
    v_cvt_pk_bf16_f32 v145, v145, v149
    v_and_b32 v150, 0xffff0000, v146
    v_lshlrev_b32 v146, 16, v146
    v_mul_f32 v150, v124, v150
    v_mul_f32 v146, v124, v146
    v_cvt_pk_bf16_f32 v146, v146, v150
    v_and_b32 v151, 0xffff0000, v147
    v_lshlrev_b32 v147, 16, v147
    v_mul_f32 v151, v124, v151
    v_mul_f32 v147, v124, v147
    v_cvt_pk_bf16_f32 v147, v147, v151
    v_and_b32 v156, 0xffff0000, v152
    v_lshlrev_b32 v152, 16, v152
    v_mul_f32 v156, v125, v156
    v_mul_f32 v152, v125, v152
    v_cvt_pk_bf16_f32 v152, v152, v156
    v_and_b32 v157, 0xffff0000, v153
    v_lshlrev_b32 v153, 16, v153
    v_mul_f32 v157, v125, v157
    v_mul_f32 v153, v125, v153
    v_cvt_pk_bf16_f32 v153, v153, v157
    v_and_b32 v158, 0xffff0000, v154
    v_lshlrev_b32 v154, 16, v154
    v_mul_f32 v158, v125, v158
    v_mul_f32 v154, v125, v154
    v_cvt_pk_bf16_f32 v154, v154, v158
    v_and_b32 v159, 0xffff0000, v155
    v_lshlrev_b32 v155, 16, v155
    v_mul_f32 v159, v125, v159
    v_mul_f32 v155, v125, v155
    v_cvt_pk_bf16_f32 v155, v155, v159
    v_mul_f32 v236, v124, v236
    v_mul_f32 v237, v124, v237
    v_mul_f32 v238, v124, v238
    v_mul_f32 v239, v124, v239
    v_mul_f32 v0, v124, v0
    v_mul_f32 v1, v124, v1
    v_mul_f32 v2, v124, v2
    v_mul_f32 v3, v124, v3
    v_mul_f32 v8, v124, v8
    v_mul_f32 v9, v124, v9
    v_mul_f32 v10, v124, v10
    v_mul_f32 v11, v124, v11
    v_mul_f32 v16, v124, v16
    v_mul_f32 v17, v124, v17
    v_mul_f32 v18, v124, v18
    v_mul_f32 v19, v124, v19
    v_mul_f32 v24, v124, v24
    v_mul_f32 v25, v124, v25
    v_mul_f32 v26, v124, v26
    v_mul_f32 v27, v124, v27
    v_mul_f32 v32, v124, v32
    v_mul_f32 v33, v124, v33
    v_mul_f32 v34, v124, v34
    v_mul_f32 v35, v124, v35
    v_mul_f32 v40, v124, v40
    v_mul_f32 v41, v124, v41
    v_mul_f32 v42, v124, v42
    v_mul_f32 v43, v124, v43
    v_mul_f32 v48, v124, v48
    v_mul_f32 v49, v124, v49
    v_mul_f32 v50, v124, v50
    v_mul_f32 v51, v124, v51
    v_mul_f32 v56, v124, v56
    v_mul_f32 v57, v124, v57
    v_mul_f32 v58, v124, v58
    v_mul_f32 v59, v124, v59
    v_mul_f32 v232, v125, v232
    v_mul_f32 v233, v125, v233
    v_mul_f32 v234, v125, v234
    v_mul_f32 v235, v125, v235
    v_mul_f32 v4, v125, v4
    v_mul_f32 v5, v125, v5
    v_mul_f32 v6, v125, v6
    v_mul_f32 v7, v125, v7
    v_mul_f32 v12, v125, v12
    v_mul_f32 v13, v125, v13
    v_mul_f32 v14, v125, v14
    v_mul_f32 v15, v125, v15
    v_mul_f32 v20, v125, v20
    v_mul_f32 v21, v125, v21
    v_mul_f32 v22, v125, v22
    v_mul_f32 v23, v125, v23
    v_mul_f32 v28, v125, v28
    v_mul_f32 v29, v125, v29
    v_mul_f32 v30, v125, v30
    v_mul_f32 v31, v125, v31
    v_mul_f32 v36, v125, v36
    v_mul_f32 v37, v125, v37
    v_mul_f32 v38, v125, v38
    v_mul_f32 v39, v125, v39
    v_mul_f32 v44, v125, v44
    v_mul_f32 v45, v125, v45
    v_mul_f32 v46, v125, v46
    v_mul_f32 v47, v125, v47
    v_mul_f32 v52, v125, v52
    v_mul_f32 v53, v125, v53
    v_mul_f32 v54, v125, v54
    v_mul_f32 v55, v125, v55
    v_mul_f32 v60, v125, v60
    v_mul_f32 v61, v125, v61
    v_mul_f32 v62, v125, v62
    v_mul_f32 v63, v125, v63
    s_nop 3
    s_setpc_b64 s[90:91]
K1_WR0:
    s_mov_b32 s52, 0
K1_WQ0:
    ds_read_b32 v102, v254
    s_add_u32 s52, s52, 1
    s_cmp_gt_u32 s52, 200000
    s_waitcnt lgkmcnt(0)
    v_cmp_gt_u32 vcc, s44, v102
    s_cbranch_scc1 K1_WX0
    s_nop 4
    s_cbranch_vccz K1_WX0
    s_branch K1_WQ0
K1_WX0:
    s_setpc_b64 s[90:91]
K1_FIX1:
    v_max3_f32 v100, v144, v145, 0
    v_max3_f32 v101, v152, v153, 0
    v_max3_f32 v100, v146, v147, v100
    v_max3_f32 v101, v154, v155, v101
    v_max3_f32 v100, v148, v149, v100
    v_max3_f32 v101, v156, v157, v101
    v_max3_f32 v100, v150, v151, v100
    v_max3_f32 v101, v158, v159, v101
    v_mov_b32 v108, v100
    v_mov_b32 v109, v101
    s_nop 0
    v_permlane32_swap_b32 v100, v108
    v_permlane32_swap_b32 v101, v109
    v_max_f32 v100, v100, v108
    v_max_f32 v101, v101, v109
    v_mov_b32 v108, v100
    v_mov_b32 v109, v101
    s_nop 0
    v_permlane16_swap_b32 v100, v108
    v_permlane16_swap_b32 v101, v109
    v_max_f32 v100, v100, v108
    v_max_f32 v101, v101, v109
    v_ceil_f32 v100, v100
    v_ceil_f32 v101, v101
    v_exp_f32 v108, -v100
    v_exp_f32 v109, -v101
    v_sub_f32 v144, v144, v100
    v_sub_f32 v145, v145, v100
    v_sub_f32 v146, v146, v100
    v_sub_f32 v147, v147, v100
    v_sub_f32 v148, v148, v100
    v_sub_f32 v149, v149, v100
    v_sub_f32 v150, v150, v100
    v_sub_f32 v151, v151, v100
    v_sub_f32 v224, v224, v100
    v_sub_f32 v225, v225, v100
    v_sub_f32 v226, v226, v100
    v_sub_f32 v227, v227, v100
    v_sub_f32 v152, v152, v101
    v_sub_f32 v153, v153, v101
    v_sub_f32 v154, v154, v101
    v_sub_f32 v155, v155, v101
    v_sub_f32 v156, v156, v101
    v_sub_f32 v157, v157, v101
    v_sub_f32 v158, v158, v101
    v_sub_f32 v159, v159, v101
    v_sub_f32 v228, v228, v101
    v_sub_f32 v229, v229, v101
    v_sub_f32 v230, v230, v101
    v_sub_f32 v231, v231, v101
    v_and_b32 v132, 0xffff0000, v128
    v_lshlrev_b32 v128, 16, v128
    v_mul_f32 v132, v108, v132
    v_mul_f32 v128, v108, v128
    v_cvt_pk_bf16_f32 v128, v128, v132
    v_and_b32 v133, 0xffff0000, v129
    v_lshlrev_b32 v129, 16, v129
    v_mul_f32 v133, v108, v133
    v_mul_f32 v129, v108, v129
    v_cvt_pk_bf16_f32 v129, v129, v133
    v_and_b32 v134, 0xffff0000, v130
    v_lshlrev_b32 v130, 16, v130
    v_mul_f32 v134, v108, v134
    v_mul_f32 v130, v108, v130
    v_cvt_pk_bf16_f32 v130, v130, v134
    v_and_b32 v135, 0xffff0000, v131
    v_lshlrev_b32 v131, 16, v131
    v_mul_f32 v135, v108, v135
    v_mul_f32 v131, v108, v131
    v_cvt_pk_bf16_f32 v131, v131, v135
    v_and_b32 v140, 0xffff0000, v136
    v_lshlrev_b32 v136, 16, v136
    v_mul_f32 v140, v109, v140
    v_mul_f32 v136, v109, v136
    v_cvt_pk_bf16_f32 v136, v136, v140
    v_and_b32 v141, 0xffff0000, v137
    v_lshlrev_b32 v137, 16, v137
    v_mul_f32 v141, v109, v141
    v_mul_f32 v137, v109, v137
    v_cvt_pk_bf16_f32 v137, v137, v141
    v_and_b32 v142, 0xffff0000, v138
    v_lshlrev_b32 v138, 16, v138
    v_mul_f32 v142, v109, v142
    v_mul_f32 v138, v109, v138
    v_cvt_pk_bf16_f32 v138, v138, v142
    v_and_b32 v143, 0xffff0000, v139
    v_lshlrev_b32 v139, 16, v139
    v_mul_f32 v143, v109, v143
    v_mul_f32 v139, v109, v139
    v_cvt_pk_bf16_f32 v139, v139, v143
    v_mul_f32 v236, v108, v236
    v_mul_f32 v237, v108, v237
    v_mul_f32 v238, v108, v238
    v_mul_f32 v239, v108, v239
    v_mul_f32 v0, v108, v0
    v_mul_f32 v1, v108, v1
    v_mul_f32 v2, v108, v2
    v_mul_f32 v3, v108, v3
    v_mul_f32 v8, v108, v8
    v_mul_f32 v9, v108, v9
    v_mul_f32 v10, v108, v10
    v_mul_f32 v11, v108, v11
    v_mul_f32 v16, v108, v16
    v_mul_f32 v17, v108, v17
    v_mul_f32 v18, v108, v18
    v_mul_f32 v19, v108, v19
    v_mul_f32 v24, v108, v24
    v_mul_f32 v25, v108, v25
    v_mul_f32 v26, v108, v26
    v_mul_f32 v27, v108, v27
    v_mul_f32 v32, v108, v32
    v_mul_f32 v33, v108, v33
    v_mul_f32 v34, v108, v34
    v_mul_f32 v35, v108, v35
    v_mul_f32 v40, v108, v40
    v_mul_f32 v41, v108, v41
    v_mul_f32 v42, v108, v42
    v_mul_f32 v43, v108, v43
    v_mul_f32 v48, v108, v48
    v_mul_f32 v49, v108, v49
    v_mul_f32 v50, v108, v50
    v_mul_f32 v51, v108, v51
    v_mul_f32 v56, v108, v56
    v_mul_f32 v57, v108, v57
    v_mul_f32 v58, v108, v58
    v_mul_f32 v59, v108, v59
    v_mul_f32 v232, v109, v232
    v_mul_f32 v233, v109, v233
    v_mul_f32 v234, v109, v234
    v_mul_f32 v235, v109, v235
    v_mul_f32 v4, v109, v4
    v_mul_f32 v5, v109, v5
    v_mul_f32 v6, v109, v6
    v_mul_f32 v7, v109, v7
    v_mul_f32 v12, v109, v12
    v_mul_f32 v13, v109, v13
    v_mul_f32 v14, v109, v14
    v_mul_f32 v15, v109, v15
    v_mul_f32 v20, v109, v20
    v_mul_f32 v21, v109, v21
    v_mul_f32 v22, v109, v22
    v_mul_f32 v23, v109, v23
    v_mul_f32 v28, v109, v28
    v_mul_f32 v29, v109, v29
    v_mul_f32 v30, v109, v30
    v_mul_f32 v31, v109, v31
    v_mul_f32 v36, v109, v36
    v_mul_f32 v37, v109, v37
    v_mul_f32 v38, v109, v38
    v_mul_f32 v39, v109, v39
    v_mul_f32 v44, v109, v44
    v_mul_f32 v45, v109, v45
    v_mul_f32 v46, v109, v46
    v_mul_f32 v47, v109, v47
    v_mul_f32 v52, v109, v52
    v_mul_f32 v53, v109, v53
    v_mul_f32 v54, v109, v54
    v_mul_f32 v55, v109, v55
    v_mul_f32 v60, v109, v60
    v_mul_f32 v61, v109, v61
    v_mul_f32 v62, v109, v62
    v_mul_f32 v63, v109, v63
    s_nop 3
    s_setpc_b64 s[90:91]
K1_FIX3:
    v_max3_f32 v132, v112, v113, 0
    v_max3_f32 v133, v120, v121, 0
    v_max3_f32 v132, v114, v115, v132
    v_max3_f32 v133, v122, v123, v133
    v_max3_f32 v132, v116, v117, v132
    v_max3_f32 v133, v124, v125, v133
    v_max3_f32 v132, v118, v119, v132
    v_max3_f32 v133, v126, v127, v133
    v_mov_b32 v140, v132
    v_mov_b32 v141, v133
    s_nop 0
    v_permlane32_swap_b32 v132, v140
    v_permlane32_swap_b32 v133, v141
    v_max_f32 v132, v132, v140
    v_max_f32 v133, v133, v141
    v_mov_b32 v140, v132
    v_mov_b32 v141, v133
    s_nop 0
    v_permlane16_swap_b32 v132, v140
    v_permlane16_swap_b32 v133, v141
    v_max_f32 v132, v132, v140
    v_max_f32 v133, v133, v141
    v_ceil_f32 v132, v132
    v_ceil_f32 v133, v133
    v_exp_f32 v140, -v132
    v_exp_f32 v141, -v133
    v_sub_f32 v112, v112, v132
    v_sub_f32 v113, v113, v132
    v_sub_f32 v114, v114, v132
    v_sub_f32 v115, v115, v132
    v_sub_f32 v116, v116, v132
    v_sub_f32 v117, v117, v132
    v_sub_f32 v118, v118, v132
    v_sub_f32 v119, v119, v132
    v_sub_f32 v224, v224, v132
    v_sub_f32 v225, v225, v132
    v_sub_f32 v226, v226, v132
    v_sub_f32 v227, v227, v132
    v_sub_f32 v120, v120, v133
    v_sub_f32 v121, v121, v133
    v_sub_f32 v122, v122, v133
    v_sub_f32 v123, v123, v133
    v_sub_f32 v124, v124, v133
    v_sub_f32 v125, v125, v133
    v_sub_f32 v126, v126, v133
    v_sub_f32 v127, v127, v133
    v_sub_f32 v228, v228, v133
    v_sub_f32 v229, v229, v133
    v_sub_f32 v230, v230, v133
    v_sub_f32 v231, v231, v133
    v_and_b32 v100, 0xffff0000, v96
    v_lshlrev_b32 v96, 16, v96
    v_mul_f32 v100, v140, v100
    v_mul_f32 v96, v140, v96
    v_cvt_pk_bf16_f32 v96, v96, v100
    v_and_b32 v101, 0xffff0000, v97
    v_lshlrev_b32 v97, 16, v97
    v_mul_f32 v101, v140, v101
    v_mul_f32 v97, v140, v97
    v_cvt_pk_bf16_f32 v97, v97, v101
    v_and_b32 v102, 0xffff0000, v98
    v_lshlrev_b32 v98, 16, v98
    v_mul_f32 v102, v140, v102
    v_mul_f32 v98, v140, v98
    v_cvt_pk_bf16_f32 v98, v98, v102
    v_and_b32 v103, 0xffff0000, v99
    v_lshlrev_b32 v99, 16, v99
    v_mul_f32 v103, v140, v103
    v_mul_f32 v99, v140, v99
    v_cvt_pk_bf16_f32 v99, v99, v103
    v_and_b32 v108, 0xffff0000, v104
    v_lshlrev_b32 v104, 16, v104
    v_mul_f32 v108, v141, v108
    v_mul_f32 v104, v141, v104
    v_cvt_pk_bf16_f32 v104, v104, v108
    v_and_b32 v109, 0xffff0000, v105
    v_lshlrev_b32 v105, 16, v105
    v_mul_f32 v109, v141, v109
    v_mul_f32 v105, v141, v105
    v_cvt_pk_bf16_f32 v105, v105, v109
    v_and_b32 v110, 0xffff0000, v106
    v_lshlrev_b32 v106, 16, v106
    v_mul_f32 v110, v141, v110
    v_mul_f32 v106, v141, v106
    v_cvt_pk_bf16_f32 v106, v106, v110
    v_and_b32 v111, 0xffff0000, v107
    v_lshlrev_b32 v107, 16, v107
    v_mul_f32 v111, v141, v111
    v_mul_f32 v107, v141, v107
    v_cvt_pk_bf16_f32 v107, v107, v111
    v_mul_f32 v236, v140, v236
    v_mul_f32 v237, v140, v237
    v_mul_f32 v238, v140, v238
    v_mul_f32 v239, v140, v239
    v_mul_f32 v0, v140, v0
    v_mul_f32 v1, v140, v1
    v_mul_f32 v2, v140, v2
    v_mul_f32 v3, v140, v3
    v_mul_f32 v8, v140, v8
    v_mul_f32 v9, v140, v9
    v_mul_f32 v10, v140, v10
    v_mul_f32 v11, v140, v11
    v_mul_f32 v16, v140, v16
    v_mul_f32 v17, v140, v17
    v_mul_f32 v18, v140, v18
    v_mul_f32 v19, v140, v19
    v_mul_f32 v24, v140, v24
    v_mul_f32 v25, v140, v25
    v_mul_f32 v26, v140, v26
    v_mul_f32 v27, v140, v27
    v_mul_f32 v32, v140, v32
    v_mul_f32 v33, v140, v33
    v_mul_f32 v34, v140, v34
    v_mul_f32 v35, v140, v35
    v_mul_f32 v40, v140, v40
    v_mul_f32 v41, v140, v41
    v_mul_f32 v42, v140, v42
    v_mul_f32 v43, v140, v43
    v_mul_f32 v48, v140, v48
    v_mul_f32 v49, v140, v49
    v_mul_f32 v50, v140, v50
    v_mul_f32 v51, v140, v51
    v_mul_f32 v56, v140, v56
    v_mul_f32 v57, v140, v57
    v_mul_f32 v58, v140, v58
    v_mul_f32 v59, v140, v59
    v_mul_f32 v232, v141, v232
    v_mul_f32 v233, v141, v233
    v_mul_f32 v234, v141, v234
    v_mul_f32 v235, v141, v235
    v_mul_f32 v4, v141, v4
    v_mul_f32 v5, v141, v5
    v_mul_f32 v6, v141, v6
    v_mul_f32 v7, v141, v7
    v_mul_f32 v12, v141, v12
    v_mul_f32 v13, v141, v13
    v_mul_f32 v14, v141, v14
    v_mul_f32 v15, v141, v15
    v_mul_f32 v20, v141, v20
    v_mul_f32 v21, v141, v21
    v_mul_f32 v22, v141, v22
    v_mul_f32 v23, v141, v23
    v_mul_f32 v28, v141, v28
    v_mul_f32 v29, v141, v29
    v_mul_f32 v30, v141, v30
    v_mul_f32 v31, v141, v31
    v_mul_f32 v36, v141, v36
    v_mul_f32 v37, v141, v37
    v_mul_f32 v38, v141, v38
    v_mul_f32 v39, v141, v39
    v_mul_f32 v44, v141, v44
    v_mul_f32 v45, v141, v45
    v_mul_f32 v46, v141, v46
    v_mul_f32 v47, v141, v47
    v_mul_f32 v52, v141, v52
    v_mul_f32 v53, v141, v53
    v_mul_f32 v54, v141, v54
    v_mul_f32 v55, v141, v55
    v_mul_f32 v60, v141, v60
    v_mul_f32 v61, v141, v61
    v_mul_f32 v62, v141, v62
    v_mul_f32 v63, v141, v63
    s_nop 3
    s_setpc_b64 s[90:91]
K1_WR1:
    s_mov_b32 s52, 0
K1_WQ1:
    ds_read_b32 v134, v254
    s_add_u32 s52, s52, 1
    s_cmp_gt_u32 s52, 200000
    s_waitcnt lgkmcnt(0)
    v_cmp_gt_u32 vcc, s44, v134
    s_cbranch_scc1 K1_WX1
    s_nop 4
    s_cbranch_vccz K1_WX1
    s_branch K1_WQ1
K1_WX1:
    s_setpc_b64 s[90:91]
K1_END:
    s_endpgm
.section .rodata,"a"
.p2align 6
.amdhsa_kernel attn_kernel
  .amdhsa_next_free_vgpr 256
  .amdhsa_next_free_sgpr 102
  .amdhsa_accum_offset 256
  .amdhsa_group_segment_fixed_size 0
  .amdhsa_kernarg_size 64
  .amdhsa_user_sgpr_count 2
  .amdhsa_user_sgpr_kernarg_segment_ptr 1
  .amdhsa_system_sgpr_workgroup_id_x 1
.end_amdhsa_kernel
```
